```python
import torch

def _softmax(x, axis=-1):
    return torch.softmax(x, dim=axis)
def _gelu(x):
    return torch.nn.functional.gelu(x, approximate="tanh")
def _silu(x):
    return torch.nn.functional.silu(x)
def _sigmoid(x):
    return torch.sigmoid(x)
def _layernorm(x, axis=-1, eps=1e-5):
    m = x.mean(dim=axis, keepdim=True)
    v = x.var(dim=axis, keepdim=True, unbiased=False)
    return (x - m) / torch.sqrt(v + eps)
def _scatter_add(tgt, idx, src, axis=0):
    return tgt.clone().index_add_(axis, idx, src)
def _segment_sum(src, seg, n):
    out = torch.zeros((n,) + src.shape[1:], dtype=src.dtype)
    return out.index_add_(0, seg, src)
def _pad(x, pw):
    flat = tuple(v for pair in reversed(pw) for v in pair)
    return torch.nn.functional.pad(x, flat)

kernel_name = 'parallel_sum__linear_attn_block__mixer_channel_mlp__prompt'

def setup_inputs():

    _w = (lambda a: (lambda t: t.to(torch.bfloat16) if t.is_floating_point() else t)(torch.as_tensor(a)))
    def _A_setup():
        B, S, D = 1, 2048, 640
        return {
            "x": _w((lambda *s: torch.randn(*s, dtype=torch.bfloat16) * 0.05)(B, S, D)),
            "wqkv": _w((lambda *s: torch.randn(*s, dtype=torch.bfloat16) * 0.1)(D, 3 * D)),
            "wo": _w((lambda *s: torch.randn(*s, dtype=torch.bfloat16) * 0.05)(D, D)),
        }
    _A_in = _A_setup()

    def _B_setup():
        B, S, D, F = 1, 2048, 640, 1536
        return {
            "x": _w((lambda *s: torch.randn(*s, dtype=torch.bfloat16) * 0.05)(B, S, D)),
            "w1": _w((lambda *s: torch.randn(*s, dtype=torch.bfloat16) * 1.6)(D, F) * (D ** -0.5)),
            "b1": _w((lambda *s: torch.randn(*s, dtype=torch.bfloat16) * 0.8)(F)),
            "w2": _w((lambda *s: torch.randn(*s, dtype=torch.bfloat16) * 0.05)(F, D) * (F ** -0.5)),
            "b2": _w((lambda *s: torch.randn(*s, dtype=torch.bfloat16) * 0.05)(D)),
        }
    _B_in = _B_setup()

    return {
        "A_x": _A_in["x"],
        "A_wqkv": _A_in["wqkv"],
        "A_wo": _A_in["wo"],
        "B_x": _B_in["x"],
        "B_w1": _B_in["w1"],
        "B_b1": _B_in["b1"],
        "B_w2": _B_in["w2"],
        "B_b2": _B_in["b2"],
    }

def reference(A_x, A_wqkv, A_wo, B_x, B_w1, B_b1, B_w2, B_b2):
    def _A_ref(x, wqkv, wo):
        B, S, D = x.shape
        H = 32; Dh = D // H
        qkv = (lambda x, *d: x.permute(*d))((x @ wqkv).reshape(B, S, 3, H, Dh), 2, 0, 3, 1, 4)
        q, k, v = qkv[0], qkv[1], qkv[2]
        phi = lambda t: torch.where(t > 0, t + 1, torch.exp(t)) + 1e-6
        pq, pk = phi(q), phi(k)
        kv = torch.einsum("bhsd,bhse->bhde", pk, v)
        z = torch.einsum("bhsd->bhd", pk)
        num = torch.einsum("bhqd,bhde->bhqe", pq, kv)
        den = torch.einsum("bhqd,bhd->bhq", pq, z)[..., None] + 1e-6
        o = num / den
        return (lambda x, *d: x.permute(*d))(o, 0, 2, 1, 3).reshape(B, S, D) @ wo

    def _B_ref(x, w1, b1, w2, b2):
        y = _layernorm(x, axis=-1)
        h = _gelu(torch.einsum("bsd,df->bsf", y, w1) + b1)
        return torch.einsum("bsf,fd->bsd", h, w2) + b2

    x = A_x
    xn = _layernorm(x, axis=-1)
    return x + _A_ref(xn, A_wqkv, A_wo) + _B_ref(xn, B_w1, B_b1, B_w2, B_b2)
```

```asm
; @launch kernel=k1_kernel grid=(256,1,1) block=(512,1,1) lds=163840
; @launch kernel=k2_kernel grid=(256,1,1) block=(512,1,1) lds=163840
.amdgcn_target "amdgcn-amd-amdhsa--gfx950"
.text
.globl k1_kernel
.p2align 8
.type k1_kernel,@function
k1_kernel:
    s_cmp_ge_u32 s2, 256
    s_cbranch_scc1 K1_END
    s_load_dwordx4 s[4:7], s[0:1], 0
    s_load_dwordx4 s[12:15], s[0:1], 32
    s_load_dwordx2 s[8:9], s[0:1], 16
    s_load_dwordx2 s[18:19], s[0:1], 48
    s_load_dwordx4 s[64:67], s[0:1], 72
    v_and_b32 v1, 63, v0
    v_lshrrev_b32 v2, 6, v0
    v_lshlrev_b32 v0, 4, v1
    v_readfirstlane_b32 s40, v2
    s_getpc_b64 s[62:63]
K1_PC:
    s_mov_b32 s60, K1_SETUP-K1_PC
    s_cmp_ge_u32 s2, 128
    s_cselect_b32 s60, K1_G-K1_PC, s60
    s_mul_i32 s61, s40, 2304
    s_add_u32 s60, s60, s61
    v_min_u32 v241, 17, v1
    v_lshl_add_u32 v241, v241, 7, s60
    s_lshl_b32 s61, s40, 11
    v_and_b32 v242, 15, v1
    s_add_u32 s61, s61, k2_kernel-K1_PC
    s_mov_b32 s60, K2_END-K1_PC
    v_lshl_add_u32 v242, v242, 7, s61
    v_min_u32 v242, s60, v242
    v_cmp_gt_u32 vcc, 32, v1
    s_nop 1
    v_cndmask_b32 v241, v242, v241, vcc
    global_load_dword v243, v241, s[62:63]
    s_and_b32 s60, s2, 3
    s_lshl_b32 s48, s60, 1
    s_bfe_u32 s60, s2, 0x10003
    s_add_u32 s48, s48, s60
    s_bfe_u32 s60, s2, 0x10002
    s_lshl_b32 s49, s60, 3
    s_bfe_u32 s60, s2, 0x30004
    s_add_u32 s49, s49, s60
    s_and_b32 s50, s40, 3
    s_lshr_b32 s51, s40, 2
    s_lshl_b32 s60, s49, 7
    s_lshl_b32 s61, s40, 4
    s_add_u32 s60, s60, s61
    v_lshrrev_b32 v2, 3, v1
    v_and_b32 v3, 7, v1
    v_xor_b32 v4, v3, v2
    v_add_u32 v5, s60, v2
    v_mul_u32_u24 v10, 1280, v5
    v_lshl_add_u32 v10, v4, 4, v10
    s_lshl_b32 s47, s40, 11
    s_lshl_b32 s44, s40, 10
    s_lshl_b32 s61, s40, 3
    v_add_u32 v5, s61, v2
    v_and_b32 v4, 6, v2
    v_xor_b32 v3, v3, v4
    v_and_b32 v6, 0xffffffe3, v5
    v_bfe_u32 v4, v5, 4, 1
    v_lshl_or_b32 v6, v4, 2, v6
    v_bfe_u32 v4, v5, 2, 2
    v_lshl_or_b32 v6, v4, 3, v6
    s_cmp_ge_u32 s2, 128
    s_cbranch_scc1 K1_G_PRO
    s_lshl_b32 s60, s48, 7
    v_mul_u32_u24 v13, 3840, v6
    v_lshl_add_u32 v3, v3, 4, s60
    v_add_u32 v13, v13, v3
    v_mul_u32_u24 v2, 26, v1
    v_lshrrev_b32 v2, 8, v2
    v_mul_u32_u24 v3, 10, v2
    v_sub_u32 v3, v1, v3
    v_mov_b32 v9, v3
    s_mul_i32 s60, s48, 160
    s_mul_i32 s61, s51, 1280
    s_add_u32 s60, s60, s61
    s_add_u32 s60, s60, 1280
    s_lshr_b32 s61, s50, 1
    s_lshl_b32 s61, s61, 5
    s_and_b32 s62, s50, 1
    s_lshl_b32 s62, s62, 2
    s_add_u32 s61, s61, s62
    s_mul_i32 s61, s61, 3840
    s_add_u32 s60, s60, s61
    v_lshl_add_u32 v3, v3, 4, s60
    v_and_b32 v4, 4, v2
    v_add_u32 v4, v4, v2
    v_mul_u32_u24 v11, 3840, v4
    v_add_u32 v11, v11, v3
    v_and_b32 v4, 1, v2
    v_bfe_u32 v5, v2, 1, 1
    v_lshl_add_u32 v4, v5, 4, v4
    v_add_u32 v4, 10, v4
    v_mul_u32_u24 v12, 3840, v4
    v_add_u32 v12, v12, v3
    s_mul_i32 s46, s50, 5120
    s_mul_i32 s60, s51, 2560
    s_add_u32 s46, s46, s60
    s_add_u32 s46, s46, 65536
    s_mov_b32 s54, -1
    s_mov_b32 s55, 0x0fffffff
    s_mov_b32 s52, -1
    s_mov_b32 s53, 0xff
    s_waitcnt lgkmcnt(0)
    s_mov_b32 s20, s4
    s_mov_b32 s21, s5
    s_mov_b32 s22, 0x280000
    s_mov_b32 s23, 0x00020000
    s_mov_b32 s24, s6
    s_mov_b32 s25, s7
    s_mov_b32 s26, 0x258000
    s_mov_b32 s27, 0x00020000
    s_add_u32 m0, s47, 0
    s_mov_b32 s45, 0
    buffer_load_dwordx4 v10, s[20:23], s45 offen lds
    s_add_u32 m0, s47, 1024
    s_mov_b32 s45, 10240
    buffer_load_dwordx4 v10, s[20:23], s45 offen lds
    s_add_u32 m0, s46, 0
    s_mov_b32 s45, 0
    s_mov_b64 exec, s[54:55]
    buffer_load_dwordx4 v11, s[24:27], s45 offen lds
    s_mov_b64 exec, -1
    s_add_u32 m0, s46, 960
    s_mov_b32 s45, 0
    s_mov_b64 exec, s[52:53]
    buffer_load_dwordx4 v12, s[24:27], s45 offen lds
    s_mov_b64 exec, -1
    s_add_u32 m0, s46, 1600
    s_mov_b32 s45, 61440
    s_mov_b64 exec, s[54:55]
    buffer_load_dwordx4 v11, s[24:27], s45 offen lds
    s_mov_b64 exec, -1
    v_lshrrev_b32 v2, 2, v1
    v_cmp_le_u32 vcc, 8, v2
    v_cmp_le_u32 s[60:61], 14, v2
    v_add_u32 v3, 2, v2
    v_subrev_u32 v4, 6, v2
    v_cndmask_b32 v2, v2, v3, vcc
    v_cndmask_b32 v2, v2, v4, s[60:61]
    v_mul_u32_u24 v2, 160, v2
    v_and_b32 v3, 3, v1
    v_lshl_add_u32 v2, v3, 3, v2
    s_mul_i32 s60, s51, 2560
    s_add_u32 s60, s60, 65536
    v_add_u32 v2, s60, v2
    v_add_u32 v6, 128, v2
    s_add_u32 s60, s50, 0
    s_and_b32 s60, s60, 3
    v_lshl_add_u32 v5, s60, 5, v2
    s_add_u32 s60, s50, 1
    s_and_b32 s60, s60, 3
    v_lshl_add_u32 v7, s60, 5, v2
    s_add_u32 s60, s50, 2
    s_and_b32 s60, s60, 3
    v_lshl_add_u32 v8, s60, 5, v2
    s_add_u32 s60, s50, 3
    s_and_b32 s60, s60, 3
    v_lshl_add_u32 v9, s60, 5, v2
    s_lshl_b32 s60, s51, 1
    s_xor_b32 s15, s50, s60
    s_mul_i32 s43, s51, 768
    s_lshl_b32 s58, s50, 6
    s_add_u32 s43, s43, s58
    s_add_u32 s43, s43, 149504
    s_lshl_b32 s57, s51, 10
    s_lshl_b32 s60, s40, 2
    s_lshr_b32 s62, 0x32143210, s60
    s_and_b32 s62, s62, 15
    s_lshr_b32 s63, 0x43232101, s60
    s_and_b32 s63, s63, 15
    s_lshr_b32 s3, 0xfff43210, s60
    s_and_b32 s3, s3, 15
    s_lshr_b32 s61, 0x988809, s60
    s_and_b32 s18, s61, 1
    s_mul_i32 s18, s18, 15
    s_bitcmp1_b32 s61, 3
    s_cselect_b32 s18, s18, 99
    s_mul_i32 s19, s50, 10256
    s_mul_i32 s60, s51, 5120
    s_add_u32 s19, s19, s60
    s_add_u32 s19, s19, 65536
    s_mul_i32 s42, s48, 7168
    s_lshl_b32 s77, s48, 4
    s_cmp_eq_u32 s40, 0
    s_cselect_b32 s77, s77, 0x7ffffff0
    s_cselect_b32 s10, 1, 0
    s_mov_b32 s11, 0
    s_lshl_b32 s91, s48, 3
    s_mov_b64 s[16:17], s[66:67]
    s_mov_b32 s36, s64
    s_mov_b32 s37, s65
    s_mov_b32 s38, 0x100
    s_mov_b32 s39, 0x00020000
    s_add_u32 s92, s16, 0xd00000
    s_addc_u32 s93, s17, 0
    s_mov_b32 s94, 0xe000
    s_mov_b32 s95, 0x00020000
    v_mov_b32 v248, 0
    v_mov_b32 v249, 0
    v_mov_b32 v250, 0
    v_mov_b32 v251, 0
    v_mov_b32 v252, 1
    s_branch K1_SETUP
K1_G_PRO:
    s_mul_i32 s60, s48, 384
    v_mul_u32_u24 v13, 3072, v6
    v_lshl_add_u32 v3, v3, 4, s60
    v_add_u32 v13, v13, v3
    v_bfe_u32 v2, v1, 1, 3
    s_lshl_b32 s61, s40, 3
    v_add_u32 v5, s61, v2
    v_and_b32 v6, 0xffffffe3, v5
    v_bfe_u32 v4, v5, 4, 1
    v_lshl_or_b32 v6, v4, 2, v6
    v_bfe_u32 v4, v5, 2, 2
    v_lshl_or_b32 v6, v4, 3, v6
    s_lshl_b32 s60, s48, 5
    s_add_u32 s60, s60, 1024
    v_mul_u32_u24 v12, 3840, v6
    v_and_b32 v3, 1, v1
    v_lshl_add_u32 v3, v3, 4, s60
    v_add_u32 v12, v12, v3
    s_lshl_b32 s46, s40, 8
    s_add_u32 s46, s46, 81920
    v_lshl_add_u32 v61, s40, 6, v1
    v_min_u32 v61, 191, v61
    v_lshlrev_b32 v61, 1, v61
    s_mul_i32 s61, s48, 384
    s_waitcnt lgkmcnt(0)
    s_mov_b32 s20, s4
    s_mov_b32 s21, s5
    s_mov_b32 s22, 0x280000
    s_mov_b32 s23, 0x00020000
    s_mov_b32 s24, s6
    s_mov_b32 s25, s7
    s_mov_b32 s26, 0x258000
    s_mov_b32 s27, 0x00020000
    s_mov_b32 s28, s12
    s_mov_b32 s29, s13
    s_mov_b32 s30, 0x1e0000
    s_mov_b32 s31, 0x00020000
    s_mov_b32 s96, s14
    s_mov_b32 s97, s15
    s_mov_b32 s98, 0xc00
    s_mov_b32 s99, 0x00020000
    s_add_u32 m0, s47, 0
    s_mov_b32 s45, 0
    buffer_load_dwordx4 v10, s[20:23], s45 offen lds
    s_add_u32 m0, s47, 1024
    s_mov_b32 s45, 10240
    buffer_load_dwordx4 v10, s[20:23], s45 offen lds
    s_add_u32 m0, s44, 65536
    s_mov_b32 s45, 0
    buffer_load_dwordx4 v13, s[28:31], s45 offen lds
    s_add_u32 m0, s44, 73728
    s_mov_b32 s45, 128
    buffer_load_dwordx4 v13, s[28:31], s45 offen lds
    s_add_u32 m0, s46, 0
    s_mov_b32 s45, 0
    s_mov_b64 exec, 0xffff
    buffer_load_dwordx4 v12, s[24:27], s45 offen lds
    s_mov_b64 exec, -1
    buffer_load_ushort v60, v61, s[96:99], s61 offen
    v_lshrrev_b32 v2, 2, v1
    v_and_b32 v3, 3, v1
    v_lshlrev_b32 v2, 7, v2
    v_lshl_add_u32 v2, v3, 3, v2
    v_bfe_u32 v3, v1, 3, 2
    v_lshl_add_u32 v2, v3, 5, v2
    s_lshl_b32 s60, s50, 5
    s_lshl_b32 s61, s51, 13
    s_add_u32 s60, s60, s61
    s_add_u32 s60, s60, 65536
    v_xor_b32 v5, s60, v2
    v_xor_b32 v7, 32, v5
    v_xor_b32 v8, 64, v5
    v_xor_b32 v9, 96, v5
    v_lshlrev_b32 v6, 3, v1
    v_add_u32 v6, 81920, v6
    s_cmp_eq_u32 s51, 1
    s_cselect_b32 s15, s50, 99
    s_movk_i32 s58, 768
    s_cselect_b32 s58, 256, s58
    s_lshl_b32 s43, s51, 8
    s_lshl_b32 s60, s50, 6
    s_add_u32 s43, s43, s60
    s_add_u32 s43, s43, 149504
    s_mul_i32 s57, s48, 6
    s_lshl_b32 s60, s51, 1
    s_add_u32 s57, s57, s60
    s_add_u32 s54, s51, 4
    s_mul_i32 s60, s48, 6
    s_add_u32 s54, s54, s60
    s_lshl_b32 s54, s54, 10
    s_lshr_b32 s60, s50, 1
    s_add_u32 s57, s57, s60
    s_lshl_b32 s57, s57, 10
    s_cmp_eq_u32 s60, 1
    s_cselect_b64 s[52:53], -1, 0
    s_bitcmp1_b32 s50, 0
    s_cselect_b64 s[100:101], -1, 0
    s_lshl_b32 s91, s48, 1
    s_add_u32 s91, s91, 64
    s_mov_b64 s[16:17], s[66:67]
    s_mov_b32 s64, s18
    s_mov_b32 s65, s19
    s_mov_b32 s66, 0x1e0000
    s_mov_b32 s67, 0x00020000
    s_add_u32 s68, s16, 0x900000
    s_addc_u32 s69, s17, 0
    s_mov_b32 s70, 0x2a8000
    s_mov_b32 s71, 0x00020000
    s_mov_b32 s88, s8
    s_mov_b32 s89, s9
    s_mov_b32 s90, 0xc8000
    s_lshl_b32 s19, s40, 12
    s_add_u32 s19, s19, 65536
K1_SETUP:
    s_mov_b32 s32, s16
    s_mov_b32 s33, s17
    s_mov_b32 s34, 0x880000
    s_mov_b32 s35, 0x00020000
    s_mov_b32 s59, 147456
    v_lshrrev_b32 v2, 4, v1
    v_and_b32 v3, 7, v1
    v_xor_b32 v2, v2, v3
    v_and_b32 v3, 15, v1
    v_lshlrev_b32 v3, 7, v3
    v_lshl_add_u32 v3, v2, 4, v3
    s_lshl_b32 s60, s50, 1
    s_add_u32 s60, s60, s51
    s_lshl_b32 s56, s60, 6
    s_add_u32 s56, s56, s59
    s_lshl_b32 s61, s60, 11
    v_add_u32 v1, s61, v3
    v_xor_b32 v2, 64, v1
    v_xor_b32 v3, 0x800, v1
    v_xor_b32 v4, 0x840, v1
    s_lshl_b32 s61, s49, 3
    s_add_u32 s60, s60, s61
    s_mul_i32 s96, s60, 69632
    s_xor_b32 s60, s60, 1
    s_mul_i32 s97, s60, 69632
    v_mov_b32 v16, 0x3f803f80
    v_mov_b32 v17, 0x3f803f80
    v_mov_b32 v18, 0x3f803f80
    v_mov_b32 v19, 0x3f803f80
    s_lshl_b32 s14, s51, 1
    s_lshr_b32 s60, s50, 1
    s_add_u32 s14, s14, s60
    s_lshl_b32 s14, s14, 5
    s_mov_b32 s4, 0x22222222
    s_mov_b32 s5, 0x22222222
    s_mov_b32 s6, 0x44444444
    s_mov_b32 s7, 0x44444444
    s_mov_b32 s8, 0x88888888
    s_mov_b32 s9, 0x88888888
    s_mov_b32 s12, 0x00f0000f
    s_mov_b32 s13, 0xf0000f00
    s_mov_b32 s82, 0x35c1a2a0
    s_mov_b32 s83, 0x35c1a2a0
    s_mov_b32 s84, 0x3f317218
    s_mov_b32 s85, 0x3f317218
    s_mov_b32 s86, 0x409d30fc
    s_mov_b32 s87, 0x409d30fc
    s_mov_b32 s98, 0x3eeff558
    s_mov_b32 s99, 0x3eeff558
    s_cmp_ge_u32 s2, 128
    s_cbranch_scc1 K1_G
    s_add_u32 s96, s96, 49152
    s_add_u32 s97, s97, 49152
    s_add_u32 m0, s47, 16384
    s_mov_b32 s45, 128
    buffer_load_dwordx4 v10, s[20:23], s45 offen lds
    s_add_u32 m0, s47, 17408
    s_mov_b32 s45, 10368
    buffer_load_dwordx4 v10, s[20:23], s45 offen lds
    s_add_u32 m0, s46, 20480
    s_mov_b32 s45, 245760
    s_mov_b64 exec, s[54:55]
    buffer_load_dwordx4 v11, s[24:27], s45 offen lds
    s_mov_b64 exec, -1
    s_add_u32 m0, s46, 21440
    s_mov_b32 s45, 245760
    s_mov_b64 exec, s[52:53]
    buffer_load_dwordx4 v12, s[24:27], s45 offen lds
    s_mov_b64 exec, -1
    s_add_u32 m0, s46, 22080
    s_mov_b32 s45, 307200
    s_mov_b64 exec, s[54:55]
    buffer_load_dwordx4 v11, s[24:27], s45 offen lds
    s_mov_b64 exec, -1
    s_add_u32 m0, s47, 32768
    s_mov_b32 s45, 256
    buffer_load_dwordx4 v10, s[20:23], s45 offen lds
    s_add_u32 m0, s47, 33792
    s_mov_b32 s45, 10496
    buffer_load_dwordx4 v10, s[20:23], s45 offen lds
    s_add_u32 m0, s46, 40960
    s_mov_b32 s45, 491520
    s_mov_b64 exec, s[54:55]
    buffer_load_dwordx4 v11, s[24:27], s45 offen lds
    s_mov_b64 exec, -1
    s_add_u32 m0, s46, 41920
    s_mov_b32 s45, 491520
    s_mov_b64 exec, s[52:53]
    buffer_load_dwordx4 v12, s[24:27], s45 offen lds
    s_mov_b64 exec, -1
    s_add_u32 m0, s46, 42560
    s_mov_b32 s45, 552960
    s_mov_b64 exec, s[54:55]
    buffer_load_dwordx4 v11, s[24:27], s45 offen lds
    s_mov_b64 exec, -1
    v_lshrrev_b32 v240, 4, v0
    s_and_b32 s60, s49, 15
    s_lshl_b32 s60, s60, 2
    s_add_u32 s60, s60, s50
    s_cmp_eq_u32 s51, 1
    s_cbranch_scc1 K1_K_PS1
    s_lshl_b32 s61, s48, 4
    s_lshl_b32 s45, s49, 7
    s_add_u32 s61, s61, s45
    s_lshl_b32 s45, s50, 1
    s_add_u32 s61, s61, s45
    s_add_u32 s61, s61, 0
    v_bfe_u32 v241, v240, 2, 1
    v_add_u32 v241, s61, v241
    v_mul_u32_u24 v241, 1280, v241
    v_and_b32 v242, 3, v240
    v_lshl_add_u32 v241, v242, 7, v241
    s_branch K1_K_PSE
K1_K_PS1:
    s_lshl_b32 s61, s60, 2
    v_bfe_u32 v241, v240, 2, 2
    v_add_u32 v241, s61, v241
    v_mul_u32_u24 v241, 3840, v241
    s_mul_i32 s45, s48, 160
    s_add_u32 s45, s45, 1280
    v_bfe_u32 v242, v240, 1, 1
    v_mul_u32_u24 v242, 1280, v242
    v_add3_u32 v241, v241, v242, s45
    v_and_b32 v242, 1, v240
    v_mul_u32_u24 v242, 156, v242
    v_add_u32 v241, v241, v242
K1_K_PSE:
    s_and_b32 s60, s49, 15
    s_lshl_b32 s60, s60, 3
    s_add_u32 s60, s60, s40
    s_mul_i32 s61, s60, 3
    s_lshl_b32 s45, s48, 7
    v_min_u32 v244, 2, v240
    v_add_u32 v244, s61, v244
    v_min_u32 v244, 319, v244
    v_mul_u32_u24 v244, 3840, v244
    v_add_u32 v244, s45, v244
    s_mov_b64 exec, 1
    buffer_atomic_add v252, off, s[36:39], s77 sc0 sc1
    s_mov_b64 exec, -1
    s_cmp_eq_u32 s51, 1
    s_cselect_b64 vcc, -1, 0
    s_waitcnt vmcnt(11)
    s_barrier
    s_cbranch_vccz K1_K_P0
    s_setprio 1
K1_K_P0:
    ds_read_b128 v[96:99], v1 offset:0
    ds_read_b128 v[176:179], v3 offset:0
    ds_read_b64_tr_b16 v[36:37], v5 offset:0
    ds_read_b64_tr_b16 v[38:39], v5 offset:5120
    ds_read_b64_tr_b16 v[40:41], v6 offset:0
    ds_read_b64_tr_b16 v[42:43], v6 offset:5120
    ds_read_b64_tr_b16 v[44:45], v7 offset:0
    ds_read_b64_tr_b16 v[46:47], v7 offset:5120
    ds_read_b64_tr_b16 v[48:49], v8 offset:0
    ds_read_b64_tr_b16 v[50:51], v8 offset:5120
    ds_read_b64_tr_b16 v[52:53], v9 offset:0
    ds_read_b64_tr_b16 v[54:55], v9 offset:5120
    s_waitcnt lgkmcnt(11)
    s_waitcnt lgkmcnt(10)
    s_waitcnt lgkmcnt(8)
    v_mfma_f32_16x16x32_bf16 v[56:59], v[96:99], v[36:39], 0
    ds_read_b128 v[100:103], v2 offset:0
    v_mfma_f32_16x16x32_bf16 v[60:63], v[176:179], v[36:39], 0
    ds_read_b128 v[180:183], v4 offset:0
    v_mfma_f32_16x16x32_bf16 v[20:23], v[16:19], v[36:39], 0
    s_waitcnt lgkmcnt(8)
    v_mfma_f32_16x16x32_bf16 v[64:67], v[96:99], v[40:43], 0
    ds_read_b64_tr_b16 v[36:37], v5 offset:10240
    s_mov_b64 exec, 0xffff
    s_cbranch_vccnz K1_K_PB0
    buffer_load_dword v243, v241, s[20:23], 0 offen offset:384
    s_branch K1_K_PC0
K1_K_PB0:
    s_mov_b32 s45, 737280
    buffer_load_dword v243, v241, s[24:27], s45 offen
K1_K_PC0:
    s_mov_b32 s45, 0
    buffer_load_dword v245, v244, s[24:27], s45 offen
    s_mov_b64 exec, -1
    v_mfma_f32_16x16x32_bf16 v[68:71], v[176:179], v[40:43], 0
    ds_read_b64_tr_b16 v[38:39], v5 offset:15360
    s_cmp_lg_u32 s15, 0
    s_cbranch_scc1 K1_K_C0
    v_mfma_f32_16x16x32_bf16 v[24:27], v[16:19], v[40:43], 0
K1_K_C0:
    s_waitcnt lgkmcnt(8)
    v_mfma_f32_16x16x32_bf16 v[72:75], v[96:99], v[44:47], 0
    ds_read_b64_tr_b16 v[40:41], v6 offset:10240
    v_mfma_f32_16x16x32_bf16 v[76:79], v[176:179], v[44:47], 0
    ds_read_b64_tr_b16 v[42:43], v6 offset:15360
    s_waitcnt lgkmcnt(8)
    v_mfma_f32_16x16x32_bf16 v[80:83], v[96:99], v[48:51], 0
    ds_read_b64_tr_b16 v[44:45], v7 offset:10240
    s_add_u32 m0, s47, 49152
    s_mov_b32 s45, 384
    buffer_load_dwordx4 v10, s[20:23], s45 offen lds
    v_mfma_f32_16x16x32_bf16 v[84:87], v[176:179], v[48:51], 0
    ds_read_b64_tr_b16 v[46:47], v7 offset:15360
    s_waitcnt lgkmcnt(8)
    v_mfma_f32_16x16x32_bf16 v[88:91], v[96:99], v[52:55], 0
    ds_read_b64_tr_b16 v[48:49], v8 offset:10240
    v_mfma_f32_16x16x32_bf16 v[92:95], v[176:179], v[52:55], 0
    ds_read_b64_tr_b16 v[50:51], v8 offset:15360
    v_mfma_f32_16x16x32_bf16 v[28:31], v[96:99], v[96:99], 0
    ds_read_b64_tr_b16 v[52:53], v9 offset:10240
    s_add_u32 m0, s47, 50176
    s_mov_b32 s45, 10624
    buffer_load_dwordx4 v10, s[20:23], s45 offen lds
    v_mfma_f32_16x16x32_bf16 v[32:35], v[96:99], v[16:19], 0
    ds_read_b64_tr_b16 v[54:55], v9 offset:15360
    s_setprio 0
    s_waitcnt lgkmcnt(11)
    s_waitcnt lgkmcnt(10)
    s_waitcnt lgkmcnt(8)
    v_mfma_f32_16x16x32_bf16 v[56:59], v[100:103], v[36:39], v[56:59]
    s_add_u32 s28, s16, 0x1400000
    s_addc_u32 s29, s17, 0
    s_mov_b32 s30, 0x2a0000
    v_mfma_f32_16x16x32_bf16 v[60:63], v[180:183], v[36:39], v[60:63]
    s_mov_b32 s31, 0x00020000
    s_lshl_b32 s10, s2, 3
    v_mfma_f32_16x16x32_bf16 v[20:23], v[16:19], v[36:39], v[20:23]
    s_add_u32 m0, s46, 61440
    s_mov_b32 s45, 737280
    s_mov_b64 exec, s[54:55]
    buffer_load_dwordx4 v11, s[24:27], s45 offen lds
    s_mov_b64 exec, -1
    s_add_u32 s10, s10, s40
    s_mul_i32 s10, s10, 1344
    s_waitcnt lgkmcnt(6)
    v_mfma_f32_16x16x32_bf16 v[64:67], v[100:103], v[40:43], v[64:67]
    v_mfma_f32_16x16x32_bf16 v[68:71], v[180:183], v[40:43], v[68:71]
    s_cmp_lg_u32 s15, 1
    s_cbranch_scc1 K1_K_C1
    v_mfma_f32_16x16x32_bf16 v[24:27], v[16:19], v[40:43], 0
K1_K_C1:
    s_add_u32 m0, s46, 62400
    s_mov_b32 s45, 737280
    s_mov_b64 exec, s[52:53]
    buffer_load_dwordx4 v12, s[24:27], s45 offen lds
    s_mov_b64 exec, -1
    s_add_u32 m0, s46, 63040
    s_mov_b32 s45, 798720
    s_mov_b64 exec, s[54:55]
    buffer_load_dwordx4 v11, s[24:27], s45 offen lds
    s_mov_b64 exec, -1
    s_waitcnt vmcnt(13)
    s_waitcnt lgkmcnt(0)
    s_barrier
    s_cbranch_vccz K1_K_P1
    s_setprio 1
K1_K_P1:
    v_mfma_f32_16x16x32_bf16 v[72:75], v[100:103], v[44:47], v[72:75]
    ds_read_b64_tr_b16 v[36:37], v5 offset:20480
    ds_read_b64_tr_b16 v[38:39], v5 offset:25600
    v_mfma_f32_16x16x32_bf16 v[76:79], v[180:183], v[44:47], v[76:79]
    ds_read_b128 v[104:107], v1 offset:16384
    v_mfma_f32_16x16x32_bf16 v[80:83], v[100:103], v[48:51], v[80:83]
    ds_read_b128 v[184:187], v3 offset:16384
    ds_read_b64_tr_b16 v[40:41], v6 offset:20480
    v_mfma_f32_16x16x32_bf16 v[84:87], v[180:183], v[48:51], v[84:87]
    ds_read_b64_tr_b16 v[42:43], v6 offset:25600
    s_mov_b64 exec, 0xffff
    s_cbranch_vccnz K1_K_PB1
    buffer_load_dword v243, v241, s[20:23], 0 offen offset:768
    s_branch K1_K_PC1
K1_K_PB1:
    s_mov_b32 s45, 1474560
    buffer_load_dword v243, v241, s[24:27], s45 offen
K1_K_PC1:
    s_mov_b32 s45, 1228800
    buffer_load_dword v245, v244, s[24:27], s45 offen
    s_mov_b64 exec, -1
    v_mfma_f32_16x16x32_bf16 v[88:91], v[100:103], v[52:55], v[88:91]
    ds_read_b64_tr_b16 v[44:45], v7 offset:20480
    v_mfma_f32_16x16x32_bf16 v[92:95], v[180:183], v[52:55], v[92:95]
    ds_read_b64_tr_b16 v[46:47], v7 offset:25600
    v_mfma_f32_16x16x32_bf16 v[28:31], v[100:103], v[100:103], v[28:31]
    ds_read_b64_tr_b16 v[48:49], v8 offset:20480
    v_mfma_f32_16x16x32_bf16 v[32:35], v[100:103], v[16:19], v[32:35]
    ds_read_b64_tr_b16 v[50:51], v8 offset:25600
    s_add_u32 m0, s47, 0
    s_mov_b32 s45, 512
    buffer_load_dwordx4 v10, s[20:23], s45 offen lds
    s_waitcnt lgkmcnt(7)
    s_waitcnt lgkmcnt(6)
    v_mfma_f32_16x16x32_bf16 v[56:59], v[104:107], v[36:39], v[56:59]
    ds_read_b64_tr_b16 v[52:53], v9 offset:20480
    v_mfma_f32_16x16x32_bf16 v[60:63], v[184:187], v[36:39], v[60:63]
    ds_read_b64_tr_b16 v[54:55], v9 offset:25600
    v_mfma_f32_16x16x32_bf16 v[20:23], v[16:19], v[36:39], v[20:23]
    ds_read_b128 v[108:111], v2 offset:16384
    s_waitcnt lgkmcnt(7)
    v_mfma_f32_16x16x32_bf16 v[64:67], v[104:107], v[40:43], v[64:67]
    ds_read_b128 v[188:191], v4 offset:16384
    s_add_u32 m0, s47, 1024
    s_mov_b32 s45, 10752
    buffer_load_dwordx4 v10, s[20:23], s45 offen lds
    v_mfma_f32_16x16x32_bf16 v[68:71], v[184:187], v[40:43], v[68:71]
    ds_read_b64_tr_b16 v[36:37], v5 offset:30720
    s_setprio 0
    s_cmp_lg_u32 s15, 2
    s_cbranch_scc1 K1_K_C2
    v_mfma_f32_16x16x32_bf16 v[24:27], v[16:19], v[40:43], 0
K1_K_C2:
    s_waitcnt lgkmcnt(7)
    v_mfma_f32_16x16x32_bf16 v[72:75], v[104:107], v[44:47], v[72:75]
    ds_read_b64_tr_b16 v[38:39], v5 offset:35840
    v_mfma_f32_16x16x32_bf16 v[76:79], v[184:187], v[44:47], v[76:79]
    ds_read_b64_tr_b16 v[40:41], v6 offset:30720
    s_waitcnt lgkmcnt(7)
    v_mfma_f32_16x16x32_bf16 v[80:83], v[104:107], v[48:51], v[80:83]
    ds_read_b64_tr_b16 v[42:43], v6 offset:35840
    s_add_u32 m0, s46, 0
    s_mov_b32 s45, 983040
    s_mov_b64 exec, s[54:55]
    buffer_load_dwordx4 v11, s[24:27], s45 offen lds
    s_mov_b64 exec, -1
    v_mfma_f32_16x16x32_bf16 v[84:87], v[184:187], v[48:51], v[84:87]
    ds_read_b64_tr_b16 v[44:45], v7 offset:30720
    s_waitcnt lgkmcnt(7)
    v_mfma_f32_16x16x32_bf16 v[88:91], v[104:107], v[52:55], v[88:91]
    ds_read_b64_tr_b16 v[46:47], v7 offset:35840
    v_mfma_f32_16x16x32_bf16 v[92:95], v[184:187], v[52:55], v[92:95]
    ds_read_b64_tr_b16 v[48:49], v8 offset:30720
    v_mfma_f32_16x16x32_bf16 v[28:31], v[104:107], v[104:107], v[28:31]
    ds_read_b64_tr_b16 v[50:51], v8 offset:35840
    s_add_u32 m0, s46, 960
    s_mov_b32 s45, 983040
    s_mov_b64 exec, s[52:53]
    buffer_load_dwordx4 v12, s[24:27], s45 offen lds
    s_mov_b64 exec, -1
    v_mfma_f32_16x16x32_bf16 v[32:35], v[104:107], v[16:19], v[32:35]
    ds_read_b64_tr_b16 v[52:53], v9 offset:30720
    s_waitcnt lgkmcnt(10)
    s_waitcnt lgkmcnt(9)
    s_waitcnt lgkmcnt(7)
    v_mfma_f32_16x16x32_bf16 v[56:59], v[108:111], v[36:39], v[56:59]
    ds_read_b64_tr_b16 v[54:55], v9 offset:35840
    v_mfma_f32_16x16x32_bf16 v[60:63], v[188:191], v[36:39], v[60:63]
    v_mfma_f32_16x16x32_bf16 v[20:23], v[16:19], v[36:39], v[20:23]
    s_add_u32 m0, s46, 1600
    s_mov_b32 s45, 1044480
    s_mov_b64 exec, s[54:55]
    buffer_load_dwordx4 v11, s[24:27], s45 offen lds
    s_mov_b64 exec, -1
    s_waitcnt lgkmcnt(6)
    v_mfma_f32_16x16x32_bf16 v[64:67], v[108:111], v[40:43], v[64:67]
    v_mfma_f32_16x16x32_bf16 v[68:71], v[188:191], v[40:43], v[68:71]
    s_cmp_lg_u32 s15, 3
    s_cbranch_scc1 K1_K_C3
    v_mfma_f32_16x16x32_bf16 v[24:27], v[16:19], v[40:43], 0
K1_K_C3:
    s_waitcnt vmcnt(15)
    s_waitcnt lgkmcnt(0)
    s_barrier
    s_cbranch_vccz K1_K_P2
    s_setprio 1
K1_K_P2:
    v_add_u32 v5, 0xa000, v5
    v_add_u32 v6, 0xa000, v6
    v_add_u32 v7, 0xa000, v7
    v_add_u32 v8, 0xa000, v8
    v_add_u32 v9, 0xa000, v9
    v_mfma_f32_16x16x32_bf16 v[72:75], v[108:111], v[44:47], v[72:75]
    ds_read_b64_tr_b16 v[36:37], v5 offset:0
    ds_read_b64_tr_b16 v[38:39], v5 offset:5120
    v_mfma_f32_16x16x32_bf16 v[76:79], v[188:191], v[44:47], v[76:79]
    ds_read_b128 v[112:115], v1 offset:32768
    v_mfma_f32_16x16x32_bf16 v[80:83], v[108:111], v[48:51], v[80:83]
    ds_read_b128 v[192:195], v3 offset:32768
    ds_read_b64_tr_b16 v[40:41], v6 offset:0
    v_mfma_f32_16x16x32_bf16 v[84:87], v[188:191], v[48:51], v[84:87]
    ds_read_b64_tr_b16 v[42:43], v6 offset:5120
    s_add_u32 m0, s47, 16384
    s_mov_b32 s45, 640
    buffer_load_dwordx4 v10, s[20:23], s45 offen lds
    v_mfma_f32_16x16x32_bf16 v[88:91], v[108:111], v[52:55], v[88:91]
    ds_read_b64_tr_b16 v[44:45], v7 offset:0
    v_mfma_f32_16x16x32_bf16 v[92:95], v[188:191], v[52:55], v[92:95]
    ds_read_b64_tr_b16 v[46:47], v7 offset:5120
    v_mfma_f32_16x16x32_bf16 v[28:31], v[108:111], v[108:111], v[28:31]
    ds_read_b64_tr_b16 v[48:49], v8 offset:0
    v_mfma_f32_16x16x32_bf16 v[32:35], v[108:111], v[16:19], v[32:35]
    ds_read_b64_tr_b16 v[50:51], v8 offset:5120
    s_add_u32 m0, s47, 17408
    s_mov_b32 s45, 10880
    buffer_load_dwordx4 v10, s[20:23], s45 offen lds
    s_waitcnt lgkmcnt(7)
    s_waitcnt lgkmcnt(6)
    v_mfma_f32_16x16x32_bf16 v[56:59], v[112:115], v[36:39], v[56:59]
    ds_read_b64_tr_b16 v[52:53], v9 offset:0
    v_mfma_f32_16x16x32_bf16 v[60:63], v[192:195], v[36:39], v[60:63]
    ds_read_b64_tr_b16 v[54:55], v9 offset:5120
    v_mfma_f32_16x16x32_bf16 v[20:23], v[16:19], v[36:39], v[20:23]
    ds_read_b128 v[116:119], v2 offset:32768
    s_waitcnt lgkmcnt(7)
    v_mfma_f32_16x16x32_bf16 v[64:67], v[112:115], v[40:43], v[64:67]
    ds_read_b128 v[196:199], v4 offset:32768
    s_add_u32 m0, s46, 20480
    s_mov_b32 s45, 1228800
    s_mov_b64 exec, s[54:55]
    buffer_load_dwordx4 v11, s[24:27], s45 offen lds
    s_mov_b64 exec, -1
    v_mfma_f32_16x16x32_bf16 v[68:71], v[192:195], v[40:43], v[68:71]
    ds_read_b64_tr_b16 v[36:37], v5 offset:10240
    s_setprio 0
    s_cmp_lg_u32 s15, 0
    s_cbranch_scc1 K1_K_C4
    v_mfma_f32_16x16x32_bf16 v[24:27], v[16:19], v[40:43], v[24:27]
K1_K_C4:
    s_waitcnt lgkmcnt(7)
    v_mfma_f32_16x16x32_bf16 v[72:75], v[112:115], v[44:47], v[72:75]
    ds_read_b64_tr_b16 v[38:39], v5 offset:15360
    v_mfma_f32_16x16x32_bf16 v[76:79], v[192:195], v[44:47], v[76:79]
    ds_read_b64_tr_b16 v[40:41], v6 offset:10240
    s_waitcnt lgkmcnt(7)
    v_mfma_f32_16x16x32_bf16 v[80:83], v[112:115], v[48:51], v[80:83]
    ds_read_b64_tr_b16 v[42:43], v6 offset:15360
    s_add_u32 m0, s46, 21440
    s_mov_b32 s45, 1228800
    s_mov_b64 exec, s[52:53]
    buffer_load_dwordx4 v12, s[24:27], s45 offen lds
    s_mov_b64 exec, -1
    v_mfma_f32_16x16x32_bf16 v[84:87], v[192:195], v[48:51], v[84:87]
    ds_read_b64_tr_b16 v[44:45], v7 offset:10240
    s_waitcnt lgkmcnt(7)
    v_mfma_f32_16x16x32_bf16 v[88:91], v[112:115], v[52:55], v[88:91]
    ds_read_b64_tr_b16 v[46:47], v7 offset:15360
    v_mfma_f32_16x16x32_bf16 v[92:95], v[192:195], v[52:55], v[92:95]
    ds_read_b64_tr_b16 v[48:49], v8 offset:10240
    v_mfma_f32_16x16x32_bf16 v[28:31], v[112:115], v[112:115], v[28:31]
    ds_read_b64_tr_b16 v[50:51], v8 offset:15360
    s_add_u32 m0, s46, 22080
    s_mov_b32 s45, 1290240
    s_mov_b64 exec, s[54:55]
    buffer_load_dwordx4 v11, s[24:27], s45 offen lds
    s_mov_b64 exec, -1
    v_mfma_f32_16x16x32_bf16 v[32:35], v[112:115], v[16:19], v[32:35]
    ds_read_b64_tr_b16 v[52:53], v9 offset:10240
    s_waitcnt lgkmcnt(10)
    s_waitcnt lgkmcnt(9)
    s_waitcnt lgkmcnt(7)
    v_mfma_f32_16x16x32_bf16 v[56:59], v[116:119], v[36:39], v[56:59]
    ds_read_b64_tr_b16 v[54:55], v9 offset:15360
    v_mfma_f32_16x16x32_bf16 v[60:63], v[196:199], v[36:39], v[60:63]
    v_mfma_f32_16x16x32_bf16 v[20:23], v[16:19], v[36:39], v[20:23]
    s_waitcnt lgkmcnt(6)
    v_mfma_f32_16x16x32_bf16 v[64:67], v[116:119], v[40:43], v[64:67]
    v_mfma_f32_16x16x32_bf16 v[68:71], v[196:199], v[40:43], v[68:71]
    s_cmp_lg_u32 s15, 1
    s_cbranch_scc1 K1_K_C5
    v_mfma_f32_16x16x32_bf16 v[24:27], v[16:19], v[40:43], v[24:27]
K1_K_C5:
    s_waitcnt vmcnt(12)
    s_waitcnt lgkmcnt(0)
    s_barrier
    s_cbranch_vccz K1_K_P3
    s_setprio 1
K1_K_P3:
    v_readfirstlane_b32 s41, v252
    s_or_b32 s41, s41, s40
    s_cbranch_scc0 K1_ZF
K1_ZFR:
    v_mfma_f32_16x16x32_bf16 v[72:75], v[116:119], v[44:47], v[72:75]
    ds_read_b64_tr_b16 v[36:37], v5 offset:20480
    ds_read_b64_tr_b16 v[38:39], v5 offset:25600
    v_mfma_f32_16x16x32_bf16 v[76:79], v[196:199], v[44:47], v[76:79]
    ds_read_b128 v[120:123], v1 offset:49152
    v_mfma_f32_16x16x32_bf16 v[80:83], v[116:119], v[48:51], v[80:83]
    ds_read_b128 v[200:203], v3 offset:49152
    ds_read_b64_tr_b16 v[40:41], v6 offset:20480
    v_mfma_f32_16x16x32_bf16 v[84:87], v[196:199], v[48:51], v[84:87]
    ds_read_b64_tr_b16 v[42:43], v6 offset:25600
    s_add_u32 m0, s47, 32768
    s_mov_b32 s45, 768
    buffer_load_dwordx4 v10, s[20:23], s45 offen lds
    v_mfma_f32_16x16x32_bf16 v[88:91], v[116:119], v[52:55], v[88:91]
    ds_read_b64_tr_b16 v[44:45], v7 offset:20480
    v_mfma_f32_16x16x32_bf16 v[92:95], v[196:199], v[52:55], v[92:95]
    ds_read_b64_tr_b16 v[46:47], v7 offset:25600
    v_mfma_f32_16x16x32_bf16 v[28:31], v[116:119], v[116:119], v[28:31]
    ds_read_b64_tr_b16 v[48:49], v8 offset:20480
    v_mfma_f32_16x16x32_bf16 v[32:35], v[116:119], v[16:19], v[32:35]
    ds_read_b64_tr_b16 v[50:51], v8 offset:25600
    s_add_u32 m0, s47, 33792
    s_mov_b32 s45, 11008
    buffer_load_dwordx4 v10, s[20:23], s45 offen lds
    s_waitcnt lgkmcnt(7)
    s_waitcnt lgkmcnt(6)
    v_mfma_f32_16x16x32_bf16 v[56:59], v[120:123], v[36:39], v[56:59]
    ds_read_b64_tr_b16 v[52:53], v9 offset:20480
    v_mfma_f32_16x16x32_bf16 v[60:63], v[200:203], v[36:39], v[60:63]
    ds_read_b64_tr_b16 v[54:55], v9 offset:25600
    v_mfma_f32_16x16x32_bf16 v[20:23], v[16:19], v[36:39], v[20:23]
    ds_read_b128 v[124:127], v2 offset:49152
    s_waitcnt lgkmcnt(7)
    v_mfma_f32_16x16x32_bf16 v[64:67], v[120:123], v[40:43], v[64:67]
    ds_read_b128 v[204:207], v4 offset:49152
    s_add_u32 m0, s46, 40960
    s_mov_b32 s45, 1474560
    s_mov_b64 exec, s[54:55]
    buffer_load_dwordx4 v11, s[24:27], s45 offen lds
    s_mov_b64 exec, -1
    v_mfma_f32_16x16x32_bf16 v[68:71], v[200:203], v[40:43], v[68:71]
    ds_read_b64_tr_b16 v[36:37], v5 offset:30720
    s_setprio 0
    s_cmp_lg_u32 s15, 2
    s_cbranch_scc1 K1_K_C6
    v_mfma_f32_16x16x32_bf16 v[24:27], v[16:19], v[40:43], v[24:27]
K1_K_C6:
    s_waitcnt lgkmcnt(7)
    v_mfma_f32_16x16x32_bf16 v[72:75], v[120:123], v[44:47], v[72:75]
    ds_read_b64_tr_b16 v[38:39], v5 offset:35840
    v_mfma_f32_16x16x32_bf16 v[76:79], v[200:203], v[44:47], v[76:79]
    ds_read_b64_tr_b16 v[40:41], v6 offset:30720
    s_waitcnt lgkmcnt(7)
    v_mfma_f32_16x16x32_bf16 v[80:83], v[120:123], v[48:51], v[80:83]
    ds_read_b64_tr_b16 v[42:43], v6 offset:35840
    s_add_u32 m0, s46, 41920
    s_mov_b32 s45, 1474560
    s_mov_b64 exec, s[52:53]
    buffer_load_dwordx4 v12, s[24:27], s45 offen lds
    s_mov_b64 exec, -1
    v_mfma_f32_16x16x32_bf16 v[84:87], v[200:203], v[48:51], v[84:87]
    ds_read_b64_tr_b16 v[44:45], v7 offset:30720
    s_waitcnt lgkmcnt(7)
    v_mfma_f32_16x16x32_bf16 v[88:91], v[120:123], v[52:55], v[88:91]
    ds_read_b64_tr_b16 v[46:47], v7 offset:35840
    v_mfma_f32_16x16x32_bf16 v[92:95], v[200:203], v[52:55], v[92:95]
    ds_read_b64_tr_b16 v[48:49], v8 offset:30720
    v_mfma_f32_16x16x32_bf16 v[28:31], v[120:123], v[120:123], v[28:31]
    ds_read_b64_tr_b16 v[50:51], v8 offset:35840
    s_add_u32 m0, s46, 42560
    s_mov_b32 s45, 1536000
    s_mov_b64 exec, s[54:55]
    buffer_load_dwordx4 v11, s[24:27], s45 offen lds
    s_mov_b64 exec, -1
    v_mfma_f32_16x16x32_bf16 v[32:35], v[120:123], v[16:19], v[32:35]
    ds_read_b64_tr_b16 v[52:53], v9 offset:30720
    s_waitcnt lgkmcnt(10)
    s_waitcnt lgkmcnt(9)
    s_waitcnt lgkmcnt(7)
    v_mfma_f32_16x16x32_bf16 v[56:59], v[124:127], v[36:39], v[56:59]
    ds_read_b64_tr_b16 v[54:55], v9 offset:35840
    v_mfma_f32_16x16x32_bf16 v[60:63], v[204:207], v[36:39], v[60:63]
    v_mfma_f32_16x16x32_bf16 v[20:23], v[16:19], v[36:39], v[20:23]
    s_waitcnt lgkmcnt(6)
    v_mfma_f32_16x16x32_bf16 v[64:67], v[124:127], v[40:43], v[64:67]
    v_mfma_f32_16x16x32_bf16 v[68:71], v[204:207], v[40:43], v[68:71]
    s_cmp_lg_u32 s15, 3
    s_cbranch_scc1 K1_K_C7
    v_mfma_f32_16x16x32_bf16 v[24:27], v[16:19], v[40:43], v[24:27]
K1_K_C7:
    s_waitcnt vmcnt(10)
    s_waitcnt lgkmcnt(0)
    s_barrier
    s_cbranch_vccz K1_K_P4
    s_setprio 1
K1_K_P4:
    v_add_u32 v5, 0xffff6000, v5
    v_add_u32 v6, 0xffff6000, v6
    v_add_u32 v7, 0xffff6000, v7
    v_add_u32 v8, 0xffff6000, v8
    v_add_u32 v9, 0xffff6000, v9
    v_mfma_f32_16x16x32_bf16 v[72:75], v[124:127], v[44:47], v[72:75]
    ds_read_b64_tr_b16 v[36:37], v5 offset:0
    ds_read_b64_tr_b16 v[38:39], v5 offset:5120
    v_mfma_f32_16x16x32_bf16 v[76:79], v[204:207], v[44:47], v[76:79]
    ds_read_b128 v[128:131], v1 offset:0
    v_mfma_f32_16x16x32_bf16 v[80:83], v[124:127], v[48:51], v[80:83]
    ds_read_b128 v[208:211], v3 offset:0
    ds_read_b64_tr_b16 v[40:41], v6 offset:0
    v_mfma_f32_16x16x32_bf16 v[84:87], v[204:207], v[48:51], v[84:87]
    ds_read_b64_tr_b16 v[42:43], v6 offset:5120
    s_add_u32 m0, s47, 49152
    s_mov_b32 s45, 896
    buffer_load_dwordx4 v10, s[20:23], s45 offen lds
    v_mfma_f32_16x16x32_bf16 v[88:91], v[124:127], v[52:55], v[88:91]
    ds_read_b64_tr_b16 v[44:45], v7 offset:0
    v_mfma_f32_16x16x32_bf16 v[92:95], v[204:207], v[52:55], v[92:95]
    ds_read_b64_tr_b16 v[46:47], v7 offset:5120
    v_mfma_f32_16x16x32_bf16 v[28:31], v[124:127], v[124:127], v[28:31]
    ds_read_b64_tr_b16 v[48:49], v8 offset:0
    v_mfma_f32_16x16x32_bf16 v[32:35], v[124:127], v[16:19], v[32:35]
    ds_read_b64_tr_b16 v[50:51], v8 offset:5120
    s_add_u32 m0, s47, 50176
    s_mov_b32 s45, 11136
    buffer_load_dwordx4 v10, s[20:23], s45 offen lds
    s_waitcnt lgkmcnt(7)
    s_waitcnt lgkmcnt(6)
    v_mfma_f32_16x16x32_bf16 v[56:59], v[128:131], v[36:39], v[56:59]
    ds_read_b64_tr_b16 v[52:53], v9 offset:0
    v_mfma_f32_16x16x32_bf16 v[60:63], v[208:211], v[36:39], v[60:63]
    ds_read_b64_tr_b16 v[54:55], v9 offset:5120
    v_mfma_f32_16x16x32_bf16 v[20:23], v[16:19], v[36:39], v[20:23]
    ds_read_b128 v[132:135], v2 offset:0
    s_waitcnt lgkmcnt(7)
    v_mfma_f32_16x16x32_bf16 v[64:67], v[128:131], v[40:43], v[64:67]
    ds_read_b128 v[212:215], v4 offset:0
    s_add_u32 m0, s46, 61440
    s_mov_b32 s45, 1720320
    s_mov_b64 exec, s[54:55]
    buffer_load_dwordx4 v11, s[24:27], s45 offen lds
    s_mov_b64 exec, -1
    v_mfma_f32_16x16x32_bf16 v[68:71], v[208:211], v[40:43], v[68:71]
    ds_read_b64_tr_b16 v[36:37], v5 offset:10240
    s_setprio 0
    s_cmp_lg_u32 s15, 0
    s_cbranch_scc1 K1_K_C8
    v_mfma_f32_16x16x32_bf16 v[24:27], v[16:19], v[40:43], v[24:27]
K1_K_C8:
    s_waitcnt lgkmcnt(7)
    v_mfma_f32_16x16x32_bf16 v[72:75], v[128:131], v[44:47], v[72:75]
    ds_read_b64_tr_b16 v[38:39], v5 offset:15360
    v_mfma_f32_16x16x32_bf16 v[76:79], v[208:211], v[44:47], v[76:79]
    ds_read_b64_tr_b16 v[40:41], v6 offset:10240
    s_waitcnt lgkmcnt(7)
    v_mfma_f32_16x16x32_bf16 v[80:83], v[128:131], v[48:51], v[80:83]
    ds_read_b64_tr_b16 v[42:43], v6 offset:15360
    s_add_u32 m0, s46, 62400
    s_mov_b32 s45, 1720320
    s_mov_b64 exec, s[52:53]
    buffer_load_dwordx4 v12, s[24:27], s45 offen lds
    s_mov_b64 exec, -1
    v_mfma_f32_16x16x32_bf16 v[84:87], v[208:211], v[48:51], v[84:87]
    ds_read_b64_tr_b16 v[44:45], v7 offset:10240
    s_waitcnt lgkmcnt(7)
    v_mfma_f32_16x16x32_bf16 v[88:91], v[128:131], v[52:55], v[88:91]
    ds_read_b64_tr_b16 v[46:47], v7 offset:15360
    v_mfma_f32_16x16x32_bf16 v[92:95], v[208:211], v[52:55], v[92:95]
    ds_read_b64_tr_b16 v[48:49], v8 offset:10240
    v_mfma_f32_16x16x32_bf16 v[28:31], v[128:131], v[128:131], v[28:31]
    ds_read_b64_tr_b16 v[50:51], v8 offset:15360
    s_add_u32 m0, s46, 63040
    s_mov_b32 s45, 1781760
    s_mov_b64 exec, s[54:55]
    buffer_load_dwordx4 v11, s[24:27], s45 offen lds
    s_mov_b64 exec, -1
    v_mfma_f32_16x16x32_bf16 v[32:35], v[128:131], v[16:19], v[32:35]
    ds_read_b64_tr_b16 v[52:53], v9 offset:10240
    s_waitcnt lgkmcnt(10)
    s_waitcnt lgkmcnt(9)
    s_waitcnt lgkmcnt(7)
    v_mfma_f32_16x16x32_bf16 v[56:59], v[132:135], v[36:39], v[56:59]
    ds_read_b64_tr_b16 v[54:55], v9 offset:15360
    v_mfma_f32_16x16x32_bf16 v[60:63], v[212:215], v[36:39], v[60:63]
    v_mfma_f32_16x16x32_bf16 v[20:23], v[16:19], v[36:39], v[20:23]
    s_waitcnt lgkmcnt(6)
    v_mfma_f32_16x16x32_bf16 v[64:67], v[132:135], v[40:43], v[64:67]
    v_mfma_f32_16x16x32_bf16 v[68:71], v[212:215], v[40:43], v[68:71]
    s_cmp_lg_u32 s15, 1
    s_cbranch_scc1 K1_K_C9
    v_mfma_f32_16x16x32_bf16 v[24:27], v[16:19], v[40:43], v[24:27]
K1_K_C9:
    s_waitcnt vmcnt(10)
    s_waitcnt lgkmcnt(0)
    s_barrier
    s_cbranch_vccz K1_K_P5
    s_setprio 1
K1_K_P5:
    v_mfma_f32_16x16x32_bf16 v[72:75], v[132:135], v[44:47], v[72:75]
    ds_read_b64_tr_b16 v[36:37], v5 offset:20480
    ds_read_b64_tr_b16 v[38:39], v5 offset:25600
    v_mfma_f32_16x16x32_bf16 v[76:79], v[212:215], v[44:47], v[76:79]
    ds_read_b128 v[136:139], v1 offset:16384
    v_mfma_f32_16x16x32_bf16 v[80:83], v[132:135], v[48:51], v[80:83]
    ds_read_b128 v[216:219], v3 offset:16384
    ds_read_b64_tr_b16 v[40:41], v6 offset:20480
    v_mfma_f32_16x16x32_bf16 v[84:87], v[212:215], v[48:51], v[84:87]
    ds_read_b64_tr_b16 v[42:43], v6 offset:25600
    s_add_u32 m0, s47, 0
    s_mov_b32 s45, 1024
    buffer_load_dwordx4 v10, s[20:23], s45 offen lds
    v_mfma_f32_16x16x32_bf16 v[88:91], v[132:135], v[52:55], v[88:91]
    ds_read_b64_tr_b16 v[44:45], v7 offset:20480
    v_mfma_f32_16x16x32_bf16 v[92:95], v[212:215], v[52:55], v[92:95]
    ds_read_b64_tr_b16 v[46:47], v7 offset:25600
    v_mfma_f32_16x16x32_bf16 v[28:31], v[132:135], v[132:135], v[28:31]
    ds_read_b64_tr_b16 v[48:49], v8 offset:20480
    v_mfma_f32_16x16x32_bf16 v[32:35], v[132:135], v[16:19], v[32:35]
    ds_read_b64_tr_b16 v[50:51], v8 offset:25600
    s_add_u32 m0, s47, 1024
    s_mov_b32 s45, 11264
    buffer_load_dwordx4 v10, s[20:23], s45 offen lds
    s_waitcnt lgkmcnt(7)
    s_waitcnt lgkmcnt(6)
    v_mfma_f32_16x16x32_bf16 v[56:59], v[136:139], v[36:39], v[56:59]
    ds_read_b64_tr_b16 v[52:53], v9 offset:20480
    v_mfma_f32_16x16x32_bf16 v[60:63], v[216:219], v[36:39], v[60:63]
    ds_read_b64_tr_b16 v[54:55], v9 offset:25600
    v_mfma_f32_16x16x32_bf16 v[20:23], v[16:19], v[36:39], v[20:23]
    ds_read_b128 v[140:143], v2 offset:16384
    s_waitcnt lgkmcnt(7)
    v_mfma_f32_16x16x32_bf16 v[64:67], v[136:139], v[40:43], v[64:67]
    ds_read_b128 v[220:223], v4 offset:16384
    s_add_u32 m0, s46, 0
    s_mov_b32 s45, 1966080
    s_mov_b64 exec, s[54:55]
    buffer_load_dwordx4 v11, s[24:27], s45 offen lds
    s_mov_b64 exec, -1
    v_mfma_f32_16x16x32_bf16 v[68:71], v[216:219], v[40:43], v[68:71]
    ds_read_b64_tr_b16 v[36:37], v5 offset:30720
    s_setprio 0
    s_cmp_lg_u32 s15, 2
    s_cbranch_scc1 K1_K_C10
    v_mfma_f32_16x16x32_bf16 v[24:27], v[16:19], v[40:43], v[24:27]
K1_K_C10:
    s_waitcnt lgkmcnt(7)
    v_mfma_f32_16x16x32_bf16 v[72:75], v[136:139], v[44:47], v[72:75]
    ds_read_b64_tr_b16 v[38:39], v5 offset:35840
    v_mfma_f32_16x16x32_bf16 v[76:79], v[216:219], v[44:47], v[76:79]
    ds_read_b64_tr_b16 v[40:41], v6 offset:30720
    s_waitcnt lgkmcnt(7)
    v_mfma_f32_16x16x32_bf16 v[80:83], v[136:139], v[48:51], v[80:83]
    ds_read_b64_tr_b16 v[42:43], v6 offset:35840
    s_add_u32 m0, s46, 960
    s_mov_b32 s45, 1966080
    s_mov_b64 exec, s[52:53]
    buffer_load_dwordx4 v12, s[24:27], s45 offen lds
    s_mov_b64 exec, -1
    v_mfma_f32_16x16x32_bf16 v[84:87], v[216:219], v[48:51], v[84:87]
    ds_read_b64_tr_b16 v[44:45], v7 offset:30720
    s_waitcnt lgkmcnt(7)
    v_mfma_f32_16x16x32_bf16 v[88:91], v[136:139], v[52:55], v[88:91]
    ds_read_b64_tr_b16 v[46:47], v7 offset:35840
    v_mfma_f32_16x16x32_bf16 v[92:95], v[216:219], v[52:55], v[92:95]
    ds_read_b64_tr_b16 v[48:49], v8 offset:30720
    v_mfma_f32_16x16x32_bf16 v[28:31], v[136:139], v[136:139], v[28:31]
    ds_read_b64_tr_b16 v[50:51], v8 offset:35840
    s_add_u32 m0, s46, 1600
    s_mov_b32 s45, 2027520
    s_mov_b64 exec, s[54:55]
    buffer_load_dwordx4 v11, s[24:27], s45 offen lds
    s_mov_b64 exec, -1
    v_mfma_f32_16x16x32_bf16 v[32:35], v[136:139], v[16:19], v[32:35]
    ds_read_b64_tr_b16 v[52:53], v9 offset:30720
    s_waitcnt lgkmcnt(10)
    s_waitcnt lgkmcnt(9)
    s_waitcnt lgkmcnt(7)
    v_mfma_f32_16x16x32_bf16 v[56:59], v[140:143], v[36:39], v[56:59]
    ds_read_b64_tr_b16 v[54:55], v9 offset:35840
    v_mfma_f32_16x16x32_bf16 v[60:63], v[220:223], v[36:39], v[60:63]
    v_mfma_f32_16x16x32_bf16 v[20:23], v[16:19], v[36:39], v[20:23]
    s_waitcnt lgkmcnt(6)
    v_mfma_f32_16x16x32_bf16 v[64:67], v[140:143], v[40:43], v[64:67]
    v_mfma_f32_16x16x32_bf16 v[68:71], v[220:223], v[40:43], v[68:71]
    s_cmp_lg_u32 s15, 3
    s_cbranch_scc1 K1_K_C11
    v_mfma_f32_16x16x32_bf16 v[24:27], v[16:19], v[40:43], v[24:27]
K1_K_C11:
    s_waitcnt vmcnt(10)
    s_waitcnt lgkmcnt(0)
    s_barrier
    s_cbranch_vccz K1_K_P6
    s_setprio 1
K1_K_P6:
    s_cmp_eq_u32 s41, 0
    s_cbranch_scc1 K1_ZG
K1_ZGR:
    v_add_u32 v5, 0xa000, v5
    v_add_u32 v6, 0xa000, v6
    v_add_u32 v7, 0xa000, v7
    v_add_u32 v8, 0xa000, v8
    v_add_u32 v9, 0xa000, v9
    v_mfma_f32_16x16x32_bf16 v[72:75], v[140:143], v[44:47], v[72:75]
    ds_read_b64_tr_b16 v[36:37], v5 offset:0
    ds_read_b64_tr_b16 v[38:39], v5 offset:5120
    v_mfma_f32_16x16x32_bf16 v[76:79], v[220:223], v[44:47], v[76:79]
    ds_read_b128 v[144:147], v1 offset:32768
    v_mfma_f32_16x16x32_bf16 v[80:83], v[140:143], v[48:51], v[80:83]
    ds_read_b128 v[224:227], v3 offset:32768
    ds_read_b64_tr_b16 v[40:41], v6 offset:0
    v_mfma_f32_16x16x32_bf16 v[84:87], v[220:223], v[48:51], v[84:87]
    ds_read_b64_tr_b16 v[42:43], v6 offset:5120
    s_add_u32 m0, s47, 16384
    s_mov_b32 s45, 1152
    buffer_load_dwordx4 v10, s[20:23], s45 offen lds
    v_mfma_f32_16x16x32_bf16 v[88:91], v[140:143], v[52:55], v[88:91]
    ds_read_b64_tr_b16 v[44:45], v7 offset:0
    v_mfma_f32_16x16x32_bf16 v[92:95], v[220:223], v[52:55], v[92:95]
    ds_read_b64_tr_b16 v[46:47], v7 offset:5120
    v_mfma_f32_16x16x32_bf16 v[28:31], v[140:143], v[140:143], v[28:31]
    ds_read_b64_tr_b16 v[48:49], v8 offset:0
    v_mfma_f32_16x16x32_bf16 v[32:35], v[140:143], v[16:19], v[32:35]
    ds_read_b64_tr_b16 v[50:51], v8 offset:5120
    s_add_u32 m0, s47, 17408
    s_mov_b32 s45, 11392
    buffer_load_dwordx4 v10, s[20:23], s45 offen lds
    s_waitcnt lgkmcnt(7)
    s_waitcnt lgkmcnt(6)
    v_mfma_f32_16x16x32_bf16 v[56:59], v[144:147], v[36:39], v[56:59]
    ds_read_b64_tr_b16 v[52:53], v9 offset:0
    v_mfma_f32_16x16x32_bf16 v[60:63], v[224:227], v[36:39], v[60:63]
    ds_read_b64_tr_b16 v[54:55], v9 offset:5120
    v_mfma_f32_16x16x32_bf16 v[20:23], v[16:19], v[36:39], v[20:23]
    ds_read_b128 v[148:151], v2 offset:32768
    s_waitcnt lgkmcnt(7)
    v_mfma_f32_16x16x32_bf16 v[64:67], v[144:147], v[40:43], v[64:67]
    ds_read_b128 v[228:231], v4 offset:32768
    s_add_u32 m0, s46, 20480
    s_mov_b32 s45, 2211840
    s_mov_b64 exec, s[54:55]
    buffer_load_dwordx4 v11, s[24:27], s45 offen lds
    s_mov_b64 exec, -1
    v_mfma_f32_16x16x32_bf16 v[68:71], v[224:227], v[40:43], v[68:71]
    ds_read_b64_tr_b16 v[36:37], v5 offset:10240
    s_setprio 0
    s_cmp_lg_u32 s15, 0
    s_cbranch_scc1 K1_K_C12
    v_mfma_f32_16x16x32_bf16 v[24:27], v[16:19], v[40:43], v[24:27]
K1_K_C12:
    s_waitcnt lgkmcnt(7)
    v_mfma_f32_16x16x32_bf16 v[72:75], v[144:147], v[44:47], v[72:75]
    ds_read_b64_tr_b16 v[38:39], v5 offset:15360
    v_mfma_f32_16x16x32_bf16 v[76:79], v[224:227], v[44:47], v[76:79]
    ds_read_b64_tr_b16 v[40:41], v6 offset:10240
    s_waitcnt lgkmcnt(7)
    v_mfma_f32_16x16x32_bf16 v[80:83], v[144:147], v[48:51], v[80:83]
    ds_read_b64_tr_b16 v[42:43], v6 offset:15360
    s_add_u32 m0, s46, 21440
    s_mov_b32 s45, 2211840
    s_mov_b64 exec, s[52:53]
    buffer_load_dwordx4 v12, s[24:27], s45 offen lds
    s_mov_b64 exec, -1
    v_mfma_f32_16x16x32_bf16 v[84:87], v[224:227], v[48:51], v[84:87]
    ds_read_b64_tr_b16 v[44:45], v7 offset:10240
    s_waitcnt lgkmcnt(7)
    v_mfma_f32_16x16x32_bf16 v[88:91], v[144:147], v[52:55], v[88:91]
    ds_read_b64_tr_b16 v[46:47], v7 offset:15360
    v_mfma_f32_16x16x32_bf16 v[92:95], v[224:227], v[52:55], v[92:95]
    ds_read_b64_tr_b16 v[48:49], v8 offset:10240
    v_mfma_f32_16x16x32_bf16 v[28:31], v[144:147], v[144:147], v[28:31]
    ds_read_b64_tr_b16 v[50:51], v8 offset:15360
    s_add_u32 m0, s46, 22080
    s_mov_b32 s45, 2273280
    s_mov_b64 exec, s[54:55]
    buffer_load_dwordx4 v11, s[24:27], s45 offen lds
    s_mov_b64 exec, -1
    v_mfma_f32_16x16x32_bf16 v[32:35], v[144:147], v[16:19], v[32:35]
    ds_read_b64_tr_b16 v[52:53], v9 offset:10240
    s_waitcnt lgkmcnt(10)
    s_waitcnt lgkmcnt(9)
    s_waitcnt lgkmcnt(7)
    v_mfma_f32_16x16x32_bf16 v[56:59], v[148:151], v[36:39], v[56:59]
    ds_read_b64_tr_b16 v[54:55], v9 offset:15360
    v_mfma_f32_16x16x32_bf16 v[60:63], v[228:231], v[36:39], v[60:63]
    v_mfma_f32_16x16x32_bf16 v[20:23], v[16:19], v[36:39], v[20:23]
    s_waitcnt lgkmcnt(6)
    v_mfma_f32_16x16x32_bf16 v[64:67], v[148:151], v[40:43], v[64:67]
    v_mfma_f32_16x16x32_bf16 v[68:71], v[228:231], v[40:43], v[68:71]
    s_cmp_lg_u32 s15, 1
    s_cbranch_scc1 K1_K_C13
    v_mfma_f32_16x16x32_bf16 v[24:27], v[16:19], v[40:43], v[24:27]
K1_K_C13:
    s_waitcnt vmcnt(10)
    s_waitcnt lgkmcnt(0)
    s_barrier
    s_cbranch_vccz K1_K_P7
    s_setprio 1
K1_K_P7:
    v_mov_b32 v248, -1
    v_mov_b32 v249, -1
    v_mov_b32 v250, -1
    v_mov_b32 v251, -1
    v_mfma_f32_16x16x32_bf16 v[72:75], v[148:151], v[44:47], v[72:75]
    ds_read_b64_tr_b16 v[36:37], v5 offset:20480
    ds_read_b64_tr_b16 v[38:39], v5 offset:25600
    v_mfma_f32_16x16x32_bf16 v[76:79], v[228:231], v[44:47], v[76:79]
    ds_read_b128 v[152:155], v1 offset:49152
    v_mfma_f32_16x16x32_bf16 v[80:83], v[148:151], v[48:51], v[80:83]
    ds_read_b128 v[232:235], v3 offset:49152
    ds_read_b64_tr_b16 v[40:41], v6 offset:20480
    v_mfma_f32_16x16x32_bf16 v[84:87], v[228:231], v[48:51], v[84:87]
    ds_read_b64_tr_b16 v[42:43], v6 offset:25600
    s_add_u32 m0, s44, 32768
    s_mov_b32 s45, 0
    buffer_load_dwordx4 v13, s[24:27], s45 offen lds
    v_mfma_f32_16x16x32_bf16 v[88:91], v[148:151], v[52:55], v[88:91]
    ds_read_b64_tr_b16 v[44:45], v7 offset:20480
    v_mfma_f32_16x16x32_bf16 v[92:95], v[228:231], v[52:55], v[92:95]
    ds_read_b64_tr_b16 v[46:47], v7 offset:25600
    v_mfma_f32_16x16x32_bf16 v[28:31], v[148:151], v[148:151], v[28:31]
    ds_read_b64_tr_b16 v[48:49], v8 offset:20480
    v_mfma_f32_16x16x32_bf16 v[32:35], v[148:151], v[16:19], v[32:35]
    ds_read_b64_tr_b16 v[50:51], v8 offset:25600
    s_add_u32 m0, s44, 40960
    s_mov_b32 s45, 245760
    buffer_load_dwordx4 v13, s[24:27], s45 offen lds
    s_waitcnt lgkmcnt(7)
    s_waitcnt lgkmcnt(6)
    v_mfma_f32_16x16x32_bf16 v[56:59], v[152:155], v[36:39], v[56:59]
    ds_read_b64_tr_b16 v[52:53], v9 offset:20480
    v_mfma_f32_16x16x32_bf16 v[60:63], v[232:235], v[36:39], v[60:63]
    ds_read_b64_tr_b16 v[54:55], v9 offset:25600
    v_mfma_f32_16x16x32_bf16 v[20:23], v[16:19], v[36:39], v[20:23]
    ds_read_b128 v[156:159], v2 offset:49152
    s_waitcnt lgkmcnt(7)
    v_mfma_f32_16x16x32_bf16 v[64:67], v[152:155], v[40:43], v[64:67]
    ds_read_b128 v[236:239], v4 offset:49152
    s_add_u32 m0, s44, 110592
    s_mov_b32 s45, 491520
    buffer_load_dwordx4 v13, s[24:27], s45 offen lds
    v_mfma_f32_16x16x32_bf16 v[68:71], v[232:235], v[40:43], v[68:71]
    ds_read_b64_tr_b16 v[36:37], v5 offset:30720
    s_setprio 0
    s_cmp_lg_u32 s15, 2
    s_cbranch_scc1 K1_K_C14
    v_mfma_f32_16x16x32_bf16 v[24:27], v[16:19], v[40:43], v[24:27]
K1_K_C14:
    s_waitcnt lgkmcnt(7)
    v_mfma_f32_16x16x32_bf16 v[72:75], v[152:155], v[44:47], v[72:75]
    ds_read_b64_tr_b16 v[38:39], v5 offset:35840
    v_mfma_f32_16x16x32_bf16 v[76:79], v[232:235], v[44:47], v[76:79]
    ds_read_b64_tr_b16 v[40:41], v6 offset:30720
    s_waitcnt lgkmcnt(7)
    v_mfma_f32_16x16x32_bf16 v[80:83], v[152:155], v[48:51], v[80:83]
    ds_read_b64_tr_b16 v[42:43], v6 offset:35840
    s_add_u32 m0, s44, 118784
    s_mov_b32 s45, 737280
    buffer_load_dwordx4 v13, s[24:27], s45 offen lds
    v_mfma_f32_16x16x32_bf16 v[84:87], v[232:235], v[48:51], v[84:87]
    ds_read_b64_tr_b16 v[44:45], v7 offset:30720
    s_waitcnt lgkmcnt(7)
    v_mfma_f32_16x16x32_bf16 v[88:91], v[152:155], v[52:55], v[88:91]
    ds_read_b64_tr_b16 v[46:47], v7 offset:35840
    v_mfma_f32_16x16x32_bf16 v[92:95], v[232:235], v[52:55], v[92:95]
    ds_read_b64_tr_b16 v[48:49], v8 offset:30720
    v_mfma_f32_16x16x32_bf16 v[28:31], v[152:155], v[152:155], v[28:31]
    ds_read_b64_tr_b16 v[50:51], v8 offset:35840
    buffer_store_dwordx4 v[248:251], v0, s[28:31], s10 offen sc1
    v_mfma_f32_16x16x32_bf16 v[32:35], v[152:155], v[16:19], v[32:35]
    ds_read_b64_tr_b16 v[52:53], v9 offset:30720
    s_waitcnt lgkmcnt(10)
    s_waitcnt lgkmcnt(9)
    s_waitcnt lgkmcnt(7)
    v_mfma_f32_16x16x32_bf16 v[56:59], v[156:159], v[36:39], v[56:59]
    ds_read_b64_tr_b16 v[54:55], v9 offset:35840
    v_mfma_f32_16x16x32_bf16 v[60:63], v[236:239], v[36:39], v[60:63]
    v_mfma_f32_16x16x32_bf16 v[20:23], v[16:19], v[36:39], v[20:23]
    s_mov_b64 exec, 0xfffff
    buffer_store_dwordx4 v[248:251], v0, s[28:31], s10 offen offset:1024 sc1
    s_mov_b64 exec, -1
    s_waitcnt lgkmcnt(6)
    v_mfma_f32_16x16x32_bf16 v[64:67], v[156:159], v[40:43], v[64:67]
    v_mfma_f32_16x16x32_bf16 v[68:71], v[236:239], v[40:43], v[68:71]
    s_cmp_lg_u32 s15, 3
    s_cbranch_scc1 K1_K_C15
    v_mfma_f32_16x16x32_bf16 v[24:27], v[16:19], v[40:43], v[24:27]
K1_K_C15:
    s_waitcnt vmcnt(11)
    s_waitcnt vmcnt(9)
    s_waitcnt lgkmcnt(0)
    s_barrier
    s_cbranch_vccz K1_K_P8
    s_setprio 1
K1_K_P8:
    s_lshl_b32 s45, s48, 4
    buffer_load_dword v12, off, s[36:39], s45 offset:4 sc1
    v_add_u32 v5, 0xffff6000, v5
    v_add_u32 v6, 0xffff6000, v6
    v_add_u32 v7, 0xffff6000, v7
    v_add_u32 v8, 0xffff6000, v8
    v_add_u32 v9, 0xffff6000, v9
    v_mfma_f32_16x16x32_bf16 v[72:75], v[156:159], v[44:47], v[72:75]
    ds_read_b64_tr_b16 v[36:37], v5 offset:0
    ds_read_b64_tr_b16 v[38:39], v5 offset:5120
    v_mfma_f32_16x16x32_bf16 v[76:79], v[236:239], v[44:47], v[76:79]
    ds_read_b128 v[160:163], v1 offset:0
    ds_read_b128 v[240:243], v3 offset:0
    v_mfma_f32_16x16x32_bf16 v[80:83], v[156:159], v[48:51], v[80:83]
    ds_read_b64_tr_b16 v[40:41], v6 offset:0
    ds_read_b64_tr_b16 v[42:43], v6 offset:5120
    v_mfma_f32_16x16x32_bf16 v[84:87], v[236:239], v[48:51], v[84:87]
    ds_read_b128 v[164:167], v2 offset:0
    s_add_u32 m0, s44, 49152
    s_mov_b32 s45, 983040
    buffer_load_dwordx4 v13, s[24:27], s45 offen lds
    v_mfma_f32_16x16x32_bf16 v[88:91], v[156:159], v[52:55], v[88:91]
    ds_read_b64_tr_b16 v[44:45], v7 offset:0
    ds_read_b64_tr_b16 v[46:47], v7 offset:5120
    v_mfma_f32_16x16x32_bf16 v[92:95], v[236:239], v[52:55], v[92:95]
    ds_read_b128 v[168:171], v1 offset:16384
    v_mfma_f32_16x16x32_bf16 v[28:31], v[156:159], v[156:159], v[28:31]
    ds_read_b64_tr_b16 v[48:49], v8 offset:0
    ds_read_b64_tr_b16 v[50:51], v8 offset:5120
    v_mfma_f32_16x16x32_bf16 v[32:35], v[156:159], v[16:19], v[32:35]
    ds_read_b128 v[172:175], v2 offset:16384
    s_add_u32 m0, s44, 57344
    s_mov_b32 s45, 1228800
    buffer_load_dwordx4 v13, s[24:27], s45 offen lds
    s_waitcnt lgkmcnt(10)
    s_waitcnt lgkmcnt(9)
    v_mfma_f32_16x16x32_bf16 v[56:59], v[160:163], v[36:39], v[56:59]
    ds_read_b64_tr_b16 v[52:53], v9 offset:0
    v_mfma_f32_16x16x32_bf16 v[60:63], v[240:243], v[36:39], v[60:63]
    ds_read_b64_tr_b16 v[54:55], v9 offset:5120
    v_mfma_f32_16x16x32_bf16 v[20:23], v[16:19], v[36:39], v[20:23]
    ds_read_b128 v[244:247], v4 offset:0
    s_waitcnt lgkmcnt(10)
    v_mfma_f32_16x16x32_bf16 v[64:67], v[160:163], v[40:43], v[64:67]
    ds_read_b64_tr_b16 v[36:37], v5 offset:10240
    s_add_u32 m0, s44, 126976
    s_mov_b32 s45, 1474560
    buffer_load_dwordx4 v13, s[24:27], s45 offen lds
    v_mfma_f32_16x16x32_bf16 v[68:71], v[240:243], v[40:43], v[68:71]
    ds_read_b64_tr_b16 v[38:39], v5 offset:15360
    s_setprio 0
    s_cmp_lg_u32 s15, 0
    s_cbranch_scc1 K1_K_C16
    v_mfma_f32_16x16x32_bf16 v[24:27], v[16:19], v[40:43], v[24:27]
K1_K_C16:
    s_waitcnt lgkmcnt(9)
    v_mfma_f32_16x16x32_bf16 v[72:75], v[160:163], v[44:47], v[72:75]
    ds_read_b64_tr_b16 v[40:41], v6 offset:10240
    v_mfma_f32_16x16x32_bf16 v[76:79], v[240:243], v[44:47], v[76:79]
    ds_read_b64_tr_b16 v[42:43], v6 offset:15360
    s_waitcnt lgkmcnt(8)
    v_mfma_f32_16x16x32_bf16 v[80:83], v[160:163], v[48:51], v[80:83]
    ds_read_b128 v[248:251], v3 offset:16384
    s_add_u32 m0, s44, 135168
    s_mov_b32 s45, 1720320
    buffer_load_dwordx4 v13, s[24:27], s45 offen lds
    v_mfma_f32_16x16x32_bf16 v[84:87], v[240:243], v[48:51], v[84:87]
    ds_read_b64_tr_b16 v[44:45], v7 offset:10240
    s_waitcnt lgkmcnt(7)
    v_mfma_f32_16x16x32_bf16 v[88:91], v[160:163], v[52:55], v[88:91]
    ds_read_b64_tr_b16 v[46:47], v7 offset:15360
    v_mfma_f32_16x16x32_bf16 v[92:95], v[240:243], v[52:55], v[92:95]
    ds_read_b128 v[252:255], v4 offset:16384
    v_mfma_f32_16x16x32_bf16 v[28:31], v[160:163], v[160:163], v[28:31]
    ds_read_b64_tr_b16 v[48:49], v8 offset:10240
    v_mfma_f32_16x16x32_bf16 v[32:35], v[160:163], v[16:19], v[32:35]
    ds_read_b64_tr_b16 v[50:51], v8 offset:15360
    v_mfma_f32_16x16x32_bf16 v[28:31], v[164:167], v[164:167], v[28:31]
    ds_read_b64_tr_b16 v[52:53], v9 offset:10240
    v_mfma_f32_16x16x32_bf16 v[32:35], v[164:167], v[16:19], v[32:35]
    ds_read_b64_tr_b16 v[54:55], v9 offset:15360
    s_waitcnt lgkmcnt(12)
    s_waitcnt lgkmcnt(10)
    v_mfma_f32_16x16x32_bf16 v[56:59], v[164:167], v[36:39], v[56:59]
    v_mfma_f32_16x16x32_bf16 v[60:63], v[244:247], v[36:39], v[60:63]
    v_mfma_f32_16x16x32_bf16 v[20:23], v[16:19], v[36:39], v[20:23]
    s_waitcnt lgkmcnt(8)
    v_mfma_f32_16x16x32_bf16 v[64:67], v[164:167], v[40:43], v[64:67]
    v_mfma_f32_16x16x32_bf16 v[68:71], v[244:247], v[40:43], v[68:71]
    s_cmp_lg_u32 s15, 1
    s_cbranch_scc1 K1_K_C17
    v_mfma_f32_16x16x32_bf16 v[24:27], v[16:19], v[40:43], v[24:27]
K1_K_C17:
    s_waitcnt vmcnt(11)
    s_waitcnt lgkmcnt(0)
    s_barrier
    s_cbranch_vccz K1_K_P9
    s_setprio 1
K1_K_P9:
    v_mfma_f32_16x16x32_bf16 v[72:75], v[164:167], v[44:47], v[72:75]
    ds_read_b64_tr_b16 v[36:37], v5 offset:20480
    ds_read_b64_tr_b16 v[38:39], v5 offset:25600
    v_mfma_f32_16x16x32_bf16 v[76:79], v[244:247], v[44:47], v[76:79]
    ds_read_b128 v[168:171], v1 offset:16384
    v_mfma_f32_16x16x32_bf16 v[80:83], v[164:167], v[48:51], v[80:83]
    ds_read_b128 v[248:251], v3 offset:16384
    ds_read_b64_tr_b16 v[40:41], v6 offset:20480
    v_mfma_f32_16x16x32_bf16 v[84:87], v[244:247], v[48:51], v[84:87]
    ds_read_b64_tr_b16 v[42:43], v6 offset:25600
    s_add_u32 m0, s44, 0
    s_mov_b32 s45, 1966080
    buffer_load_dwordx4 v13, s[24:27], s45 offen lds
    v_mfma_f32_16x16x32_bf16 v[88:91], v[164:167], v[52:55], v[88:91]
    ds_read_b64_tr_b16 v[44:45], v7 offset:20480
    v_mfma_f32_16x16x32_bf16 v[92:95], v[244:247], v[52:55], v[92:95]
    ds_read_b64_tr_b16 v[46:47], v7 offset:25600
    s_waitcnt lgkmcnt(5)
    v_mfma_f32_16x16x32_bf16 v[28:31], v[168:171], v[168:171], v[28:31]
    ds_read_b64_tr_b16 v[48:49], v8 offset:20480
    v_mfma_f32_16x16x32_bf16 v[32:35], v[168:171], v[16:19], v[32:35]
    ds_read_b64_tr_b16 v[50:51], v8 offset:25600
    s_add_u32 m0, s44, 8192
    s_mov_b32 s45, 2211840
    buffer_load_dwordx4 v13, s[24:27], s45 offen lds
    v_mfma_f32_16x16x32_bf16 v[28:31], v[172:175], v[172:175], v[28:31]
    ds_read_b64_tr_b16 v[52:53], v9 offset:20480
    v_mfma_f32_16x16x32_bf16 v[32:35], v[172:175], v[16:19], v[32:35]
    ds_read_b64_tr_b16 v[54:55], v9 offset:25600
    s_waitcnt lgkmcnt(8)
    v_mfma_f32_16x16x32_bf16 v[56:59], v[168:171], v[36:39], v[56:59]
    v_bfe_u32 v15, v0, 4, 4
    v_lshl_add_u32 v14, v15, 2, s43
    v_mfma_f32_16x16x32_bf16 v[60:63], v[248:251], v[36:39], v[60:63]
    v_subrev_u32 v10, s58, v14
    v_lshrrev_b32 v1, 8, v0
    v_mfma_f32_16x16x32_bf16 v[20:23], v[16:19], v[36:39], v[20:23]
    v_lshl_add_u32 v1, v1, 4, s56
    v_add_u32 v1, s57, v1
    s_setprio 0
    s_waitcnt lgkmcnt(6)
    v_mfma_f32_16x16x32_bf16 v[64:67], v[168:171], v[40:43], v[64:67]
    ds_read_b64_tr_b16 v[36:37], v5 offset:30720
    v_xor_b32 v2, 64, v1
    v_lshl_add_u32 v15, v15, 2, s56
    v_mfma_f32_16x16x32_bf16 v[68:71], v[248:251], v[40:43], v[68:71]
    ds_read_b64_tr_b16 v[38:39], v5 offset:35840
    v_cndmask_b32 v28, v28, v29, s[4:5]
    v_cndmask_b32 v28, v28, v30, s[6:7]
    s_cmp_lg_u32 s15, 2
    s_cbranch_scc1 K1_K_C18
    v_mfma_f32_16x16x32_bf16 v[24:27], v[16:19], v[40:43], v[24:27]
K1_K_C18:
    s_waitcnt lgkmcnt(6)
    v_mfma_f32_16x16x32_bf16 v[72:75], v[168:171], v[44:47], v[72:75]
    ds_read_b64_tr_b16 v[40:41], v6 offset:30720
    v_cndmask_b32 v28, v28, v31, s[8:9]
    v_cndmask_b32 v32, v32, v33, s[4:5]
    v_mfma_f32_16x16x32_bf16 v[76:79], v[248:251], v[44:47], v[76:79]
    ds_read_b64_tr_b16 v[42:43], v6 offset:35840
    v_cndmask_b32 v32, v32, v34, s[6:7]
    v_cndmask_b32 v32, v32, v35, s[8:9]
    s_waitcnt lgkmcnt(6)
    v_mfma_f32_16x16x32_bf16 v[80:83], v[168:171], v[48:51], v[80:83]
    ds_read_b64_tr_b16 v[44:45], v7 offset:30720
    v_mul_f32 v32, 0x3acccccd, v32
    v_mul_f32 v28, 0x3acccccd, v28
    v_mfma_f32_16x16x32_bf16 v[84:87], v[248:251], v[48:51], v[84:87]
    ds_read_b64_tr_b16 v[46:47], v7 offset:35840
    v_fma_f32 v28, -v32, v32, v28
    v_max_f32 v28, 0, v28
    s_waitcnt lgkmcnt(6)
    v_mfma_f32_16x16x32_bf16 v[88:91], v[168:171], v[52:55], v[88:91]
    ds_read_b64_tr_b16 v[48:49], v8 offset:30720
    v_cvt_pk_bf16_f32 v35, v32, v28
    v_lshlrev_b32 v31, 16, v35
    v_mfma_f32_16x16x32_bf16 v[92:95], v[248:251], v[52:55], v[92:95]
    ds_read_b64_tr_b16 v[50:51], v8 offset:35840
    v_and_b32 v33, 0xffff0000, v35
    v_add_f32 v33, 0x3727c5ac, v33
    s_waitcnt lgkmcnt(6)
    v_mfma_f32_16x16x32_bf16 v[56:59], v[172:175], v[36:39], v[56:59]
    ds_read_b64_tr_b16 v[52:53], v9 offset:30720
    v_cvt_pk_bf16_f32 v35, v33, v33
    v_lshlrev_b32 v33, 16, v35
    v_mfma_f32_16x16x32_bf16 v[60:63], v[252:255], v[36:39], v[60:63]
    ds_read_b64_tr_b16 v[54:55], v9 offset:35840
    v_sqrt_f32 v33, v33
    s_nop 0
    v_cvt_pk_bf16_f32 v35, v33, v33
    v_mfma_f32_16x16x32_bf16 v[20:23], v[16:19], v[36:39], v[20:23]
    v_lshlrev_b32 v33, 16, v35
    v_rcp_f32 v34, v33
    s_nop 0
    s_waitcnt lgkmcnt(6)
    v_mfma_f32_16x16x32_bf16 v[64:67], v[172:175], v[40:43], v[64:67]
    v_mul_f32 v31, v31, v34
    v_mul_f32 v32, 0x3fb8aa3b, v34
    v_mfma_f32_16x16x32_bf16 v[68:71], v[252:255], v[40:43], v[68:71]
    v_mul_f32 v28, 0x3fb8aa3b, v31
    s_mov_b64 exec, s[12:13]
    ds_write2st64_b32 v15, v32, v28 offset0:0 offset1:2
    s_mov_b64 exec, -1
    s_cmp_lg_u32 s15, 3
    s_cbranch_scc1 K1_K_C19
    v_mfma_f32_16x16x32_bf16 v[24:27], v[16:19], v[40:43], v[24:27]
K1_K_C19:
    s_waitcnt lgkmcnt(5)
    v_mfma_f32_16x16x32_bf16 v[72:75], v[172:175], v[44:47], v[72:75]
    s_mov_b64 exec, s[12:13]
    ds_write2st64_b32 v15, v34, v31 offset0:4 offset1:6
    s_mov_b64 exec, -1
    v_mfma_f32_16x16x32_bf16 v[76:79], v[252:255], v[44:47], v[76:79]
    s_nop 3
    ds_write2_b32 v14, v20, v20 offset0:0 offset1:64
    ds_write_b32 v14, v24 offset:512
    s_waitcnt vmcnt(2)
    s_waitcnt lgkmcnt(0)
    s_barrier
    v_readfirstlane_b32 s64, v12
    s_setprio 0
    s_cmp_eq_u32 s51, 1
    s_cbranch_scc1 K1_K_B
    ds_read2_b32 v[20:21], v14 offset0:0 offset1:16
    ds_read2_b32 v[22:23], v14 offset0:32 offset1:48
    ds_read_b128 v[36:39], v1
    v_mfma_f32_16x16x32_bf16 v[80:83], v[172:175], v[48:51], v[80:83]
    ds_read_b128 v[40:43], v1 offset:512
    ds_read2_b32 v[24:25], v10 offset0:128 offset1:144
    v_mfma_f32_16x16x32_bf16 v[84:87], v[252:255], v[48:51], v[84:87]
    ds_read2_b32 v[26:27], v10 offset0:160 offset1:176
    ds_read_b128 v[44:47], v2
    v_mfma_f32_16x16x32_bf16 v[88:91], v[172:175], v[52:55], v[88:91]
    ds_read_b128 v[28:31], v2 offset:512
    v_mfma_f32_16x16x32_bf16 v[92:95], v[252:255], v[52:55], v[92:95]
    s_waitcnt lgkmcnt(0)
    v_add_f32 v24, v24, v25
    v_add_f32 v26, v26, v27
    v_add_u32 v3, s19, v0
    v_add_f32 v24, v24, v26
    v_pk_fma_f32 v[32:33], v[40:41], v[20:21], s[82:83] op_sel:[0,0,0] op_sel_hi:[1,0,1] neg_lo:[0,1,0] neg_hi:[0,1,0]
    v_pk_fma_f32 v[34:35], v[42:43], v[20:21], s[82:83] op_sel:[0,0,0] op_sel_hi:[1,0,1] neg_lo:[0,1,0] neg_hi:[0,1,0]
    v_pk_fma_f32 v[56:57], v[56:57], v[36:37], v[32:33]
    v_pk_fma_f32 v[58:59], v[58:59], v[38:39], v[34:35]
    v_exp_f32_e64 v32, v56 clamp
    v_exp_f32_e64 v33, v57 clamp
    v_max_f32 v56, s82, v56
    v_max_f32 v57, s82, v57
    v_pk_fma_f32 v[56:57], v[56:57], s[84:85], v[32:33]
    v_exp_f32_e64 v34, v58 clamp
    v_exp_f32_e64 v35, v59 clamp
    v_max_f32 v58, s82, v58
    v_max_f32 v59, s82, v59
    v_pk_fma_f32 v[58:59], v[58:59], s[84:85], v[34:35]
    v_cvt_pk_bf16_f32 v56, v56, v57
    v_cvt_pk_bf16_f32 v57, v58, v59
    v_pk_fma_f32 v[32:33], v[28:29], v[20:21], s[82:83] op_sel:[0,0,0] op_sel_hi:[1,0,1] neg_lo:[0,1,0] neg_hi:[0,1,0]
    v_pk_fma_f32 v[34:35], v[30:31], v[20:21], s[82:83] op_sel:[0,0,0] op_sel_hi:[1,0,1] neg_lo:[0,1,0] neg_hi:[0,1,0]
    v_pk_fma_f32 v[60:61], v[60:61], v[44:45], v[32:33]
    v_pk_fma_f32 v[62:63], v[62:63], v[46:47], v[34:35]
    v_exp_f32_e64 v32, v60 clamp
    v_exp_f32_e64 v33, v61 clamp
    v_max_f32 v60, s82, v60
    v_max_f32 v61, s82, v61
    v_pk_fma_f32 v[60:61], v[60:61], s[84:85], v[32:33]
    v_exp_f32_e64 v34, v62 clamp
    v_exp_f32_e64 v35, v63 clamp
    v_max_f32 v62, s82, v62
    v_max_f32 v63, s82, v63
    v_pk_fma_f32 v[62:63], v[62:63], s[84:85], v[34:35]
    v_cvt_pk_bf16_f32 v58, v60, v61
    v_cvt_pk_bf16_f32 v59, v62, v63
    s_add_u32 s60, s50, 0
    s_and_b32 s60, s60, 3
    s_lshl_b32 s60, s60, 10
    v_add_u32 v4, s60, v3
    ds_write_b128 v4, v[56:59]
    v_fma_f32 v32, v40, -v24, s82
    v_fma_f32 v33, v41, -v24, s83
    v_fma_f32 v34, v42, -v24, s82
    v_fma_f32 v35, v43, -v24, s83
    v_fma_f32 v64, v64, v36, v32
    v_fma_f32 v65, v65, v37, v33
    v_fma_f32 v66, v66, v38, v34
    v_fma_f32 v67, v67, v39, v35
    v_exp_f32_e64 v32, v64 clamp
    v_exp_f32_e64 v33, v65 clamp
    v_max_f32 v64, s82, v64
    v_max_f32 v65, s82, v65
    v_fma_f32 v64, v64, s84, v32
    v_fma_f32 v65, v65, s85, v33
    v_exp_f32_e64 v34, v66 clamp
    v_exp_f32_e64 v35, v67 clamp
    v_max_f32 v66, s82, v66
    v_max_f32 v67, s82, v67
    v_fma_f32 v66, v66, s84, v34
    v_fma_f32 v67, v67, s85, v35
    v_cvt_pk_bf16_f32 v64, v64, v65
    v_cvt_pk_bf16_f32 v65, v66, v67
    v_fma_f32 v32, v28, -v24, s82
    v_fma_f32 v33, v29, -v24, s83
    v_fma_f32 v34, v30, -v24, s82
    v_fma_f32 v35, v31, -v24, s83
    v_fma_f32 v68, v68, v44, v32
    v_fma_f32 v69, v69, v45, v33
    v_fma_f32 v70, v70, v46, v34
    v_fma_f32 v71, v71, v47, v35
    v_exp_f32_e64 v32, v68 clamp
    v_exp_f32_e64 v33, v69 clamp
    v_max_f32 v68, s82, v68
    v_max_f32 v69, s82, v69
    v_fma_f32 v68, v68, s84, v32
    v_fma_f32 v69, v69, s85, v33
    v_exp_f32_e64 v34, v70 clamp
    v_exp_f32_e64 v35, v71 clamp
    v_max_f32 v70, s82, v70
    v_max_f32 v71, s82, v71
    v_fma_f32 v70, v70, s84, v34
    v_fma_f32 v71, v71, s85, v35
    v_cvt_pk_bf16_f32 v66, v68, v69
    v_cvt_pk_bf16_f32 v67, v70, v71
    ds_write_b128 v3, v[64:67] offset:4096
    v_mov_b32 v26, v21
    v_pk_fma_f32 v[32:33], v[40:41], v[26:27], s[82:83] op_sel:[0,0,0] op_sel_hi:[1,0,1] neg_lo:[0,1,0] neg_hi:[0,1,0]
    v_pk_fma_f32 v[34:35], v[42:43], v[26:27], s[82:83] op_sel:[0,0,0] op_sel_hi:[1,0,1] neg_lo:[0,1,0] neg_hi:[0,1,0]
    v_pk_fma_f32 v[72:73], v[72:73], v[36:37], v[32:33]
    v_pk_fma_f32 v[74:75], v[74:75], v[38:39], v[34:35]
    v_exp_f32_e64 v32, v72 clamp
    v_exp_f32_e64 v33, v73 clamp
    v_max_f32 v72, s82, v72
    v_max_f32 v73, s82, v73
    v_pk_fma_f32 v[72:73], v[72:73], s[84:85], v[32:33]
    v_exp_f32_e64 v34, v74 clamp
    v_exp_f32_e64 v35, v75 clamp
    v_max_f32 v74, s82, v74
    v_max_f32 v75, s82, v75
    v_pk_fma_f32 v[74:75], v[74:75], s[84:85], v[34:35]
    v_cvt_pk_bf16_f32 v72, v72, v73
    v_cvt_pk_bf16_f32 v73, v74, v75
    v_pk_fma_f32 v[32:33], v[28:29], v[26:27], s[82:83] op_sel:[0,0,0] op_sel_hi:[1,0,1] neg_lo:[0,1,0] neg_hi:[0,1,0]
    v_pk_fma_f32 v[34:35], v[30:31], v[26:27], s[82:83] op_sel:[0,0,0] op_sel_hi:[1,0,1] neg_lo:[0,1,0] neg_hi:[0,1,0]
    v_pk_fma_f32 v[76:77], v[76:77], v[44:45], v[32:33]
    v_pk_fma_f32 v[78:79], v[78:79], v[46:47], v[34:35]
    v_exp_f32_e64 v32, v76 clamp
    v_exp_f32_e64 v33, v77 clamp
    v_max_f32 v76, s82, v76
    v_max_f32 v77, s82, v77
    v_pk_fma_f32 v[76:77], v[76:77], s[84:85], v[32:33]
    v_exp_f32_e64 v34, v78 clamp
    v_exp_f32_e64 v35, v79 clamp
    v_max_f32 v78, s82, v78
    v_max_f32 v79, s82, v79
    v_pk_fma_f32 v[78:79], v[78:79], s[84:85], v[34:35]
    v_cvt_pk_bf16_f32 v74, v76, v77
    v_cvt_pk_bf16_f32 v75, v78, v79
    s_add_u32 s60, s50, 1
    s_and_b32 s60, s60, 3
    s_lshl_b32 s60, s60, 10
    v_add_u32 v4, s60, v3
    ds_write_b128 v4, v[72:75]
    v_pk_fma_f32 v[32:33], v[40:41], v[22:23], s[82:83] op_sel:[0,0,0] op_sel_hi:[1,0,1] neg_lo:[0,1,0] neg_hi:[0,1,0]
    v_pk_fma_f32 v[34:35], v[42:43], v[22:23], s[82:83] op_sel:[0,0,0] op_sel_hi:[1,0,1] neg_lo:[0,1,0] neg_hi:[0,1,0]
    v_pk_fma_f32 v[80:81], v[80:81], v[36:37], v[32:33]
    v_pk_fma_f32 v[82:83], v[82:83], v[38:39], v[34:35]
    v_exp_f32_e64 v32, v80 clamp
    v_exp_f32_e64 v33, v81 clamp
    v_max_f32 v80, s82, v80
    v_max_f32 v81, s82, v81
    v_pk_fma_f32 v[80:81], v[80:81], s[84:85], v[32:33]
    v_exp_f32_e64 v34, v82 clamp
    v_exp_f32_e64 v35, v83 clamp
    v_max_f32 v82, s82, v82
    v_max_f32 v83, s82, v83
    v_pk_fma_f32 v[82:83], v[82:83], s[84:85], v[34:35]
    v_cvt_pk_bf16_f32 v80, v80, v81
    v_cvt_pk_bf16_f32 v81, v82, v83
    v_pk_fma_f32 v[32:33], v[28:29], v[22:23], s[82:83] op_sel:[0,0,0] op_sel_hi:[1,0,1] neg_lo:[0,1,0] neg_hi:[0,1,0]
    v_pk_fma_f32 v[34:35], v[30:31], v[22:23], s[82:83] op_sel:[0,0,0] op_sel_hi:[1,0,1] neg_lo:[0,1,0] neg_hi:[0,1,0]
    v_pk_fma_f32 v[84:85], v[84:85], v[44:45], v[32:33]
    v_pk_fma_f32 v[86:87], v[86:87], v[46:47], v[34:35]
    v_exp_f32_e64 v32, v84 clamp
    v_exp_f32_e64 v33, v85 clamp
    v_max_f32 v84, s82, v84
    v_max_f32 v85, s82, v85
    v_pk_fma_f32 v[84:85], v[84:85], s[84:85], v[32:33]
    v_exp_f32_e64 v34, v86 clamp
    v_exp_f32_e64 v35, v87 clamp
    v_max_f32 v86, s82, v86
    v_max_f32 v87, s82, v87
    v_pk_fma_f32 v[86:87], v[86:87], s[84:85], v[34:35]
    v_cvt_pk_bf16_f32 v82, v84, v85
    v_cvt_pk_bf16_f32 v83, v86, v87
    s_add_u32 s60, s50, 2
    s_and_b32 s60, s60, 3
    s_lshl_b32 s60, s60, 10
    v_add_u32 v4, s60, v3
    ds_write_b128 v4, v[80:83]
    v_mov_b32 v26, v23
    v_pk_fma_f32 v[32:33], v[40:41], v[26:27], s[82:83] op_sel:[0,0,0] op_sel_hi:[1,0,1] neg_lo:[0,1,0] neg_hi:[0,1,0]
    v_pk_fma_f32 v[34:35], v[42:43], v[26:27], s[82:83] op_sel:[0,0,0] op_sel_hi:[1,0,1] neg_lo:[0,1,0] neg_hi:[0,1,0]
    v_pk_fma_f32 v[88:89], v[88:89], v[36:37], v[32:33]
    v_pk_fma_f32 v[90:91], v[90:91], v[38:39], v[34:35]
    v_exp_f32_e64 v32, v88 clamp
    v_exp_f32_e64 v33, v89 clamp
    v_max_f32 v88, s82, v88
    v_max_f32 v89, s82, v89
    v_pk_fma_f32 v[88:89], v[88:89], s[84:85], v[32:33]
    v_exp_f32_e64 v34, v90 clamp
    v_exp_f32_e64 v35, v91 clamp
    v_max_f32 v90, s82, v90
    v_max_f32 v91, s82, v91
    v_pk_fma_f32 v[90:91], v[90:91], s[84:85], v[34:35]
    v_cvt_pk_bf16_f32 v88, v88, v89
    v_cvt_pk_bf16_f32 v89, v90, v91
    v_pk_fma_f32 v[32:33], v[28:29], v[26:27], s[82:83] op_sel:[0,0,0] op_sel_hi:[1,0,1] neg_lo:[0,1,0] neg_hi:[0,1,0]
    v_pk_fma_f32 v[34:35], v[30:31], v[26:27], s[82:83] op_sel:[0,0,0] op_sel_hi:[1,0,1] neg_lo:[0,1,0] neg_hi:[0,1,0]
    v_pk_fma_f32 v[92:93], v[92:93], v[44:45], v[32:33]
    v_pk_fma_f32 v[94:95], v[94:95], v[46:47], v[34:35]
    v_exp_f32_e64 v32, v92 clamp
    v_exp_f32_e64 v33, v93 clamp
    v_max_f32 v92, s82, v92
    v_max_f32 v93, s82, v93
    v_pk_fma_f32 v[92:93], v[92:93], s[84:85], v[32:33]
    v_exp_f32_e64 v34, v94 clamp
    v_exp_f32_e64 v35, v95 clamp
    v_max_f32 v94, s82, v94
    v_max_f32 v95, s82, v95
    v_pk_fma_f32 v[94:95], v[94:95], s[84:85], v[34:35]
    v_cvt_pk_bf16_f32 v90, v92, v93
    v_cvt_pk_bf16_f32 v91, v94, v95
    s_add_u32 s60, s50, 3
    s_and_b32 s60, s60, 3
    s_lshl_b32 s60, s60, 10
    v_add_u32 v4, s60, v3
    ds_write_b128 v4, v[88:91]
    v_lshl_add_u32 v1, s62, 10, v0
    v_add_u32 v1, 65536, v1
    v_lshl_add_u32 v2, s63, 10, v0
    v_add_u32 v2, 70656, v2
    v_lshl_add_u32 v3, s3, 10, v0
    v_add_u32 v3, 70656, v3
    v_bfe_u32 v9, v0, 4, 4
    v_cmp_eq_u32 vcc, s18, v9
    v_mov_b32 v4, 75776
    s_nop 0
    v_cndmask_b32 v2, v2, v4, vcc
    v_lshrrev_b32 v5, 6, v0
    v_lshlrev_b32 v5, 7, v5
    v_bfe_u32 v6, v0, 4, 2
    v_lshl_add_u32 v5, v6, 3, v5
    v_bfe_u32 v6, v0, 7, 2
    v_lshl_add_u32 v5, v6, 5, v5
    v_xor_b32 v5, s14, v5
    v_xor_b32 v6, 32, v5
    v_add_u32 v7, 81920, v5
    v_add_u32 v8, 81920, v6
    s_waitcnt vmcnt(0)
    s_waitcnt lgkmcnt(0)
    s_barrier
    ds_read_b128 v[80:83], v1 offset:0
    ds_read_b128 v[84:87], v2 offset:0
    ds_read_b128 v[88:91], v3 offset:0
    ds_read_b128 v[92:95], v1 offset:10256
    ds_read_b128 v[28:31], v2 offset:10256
    ds_read_b128 v[32:35], v3 offset:10256
    ds_read_b128 v[36:39], v1 offset:20512
    ds_read_b128 v[56:59], v2 offset:20512
    ds_read_b128 v[60:63], v3 offset:20512
    s_cmp_eq_u32 s64, 0
    s_cbranch_scc1 K1_ZP0
K1_ZPR0:
    v_lshl_add_u32 v10, s62, 4, v9
    v_mul_u32_u24 v14, 205, v10
    v_lshrrev_b32 v14, 12, v14
    v_lshlrev_b32 v10, 2, v10
    v_lshrrev_b32 v13, 8, v0
    v_mad_i32_i24 v12, v14, -5, v13
    v_lshl_add_u32 v11, s63, 2, v12
    v_lshl_add_u32 v12, s3, 2, v12
    v_cmp_gt_u32 vcc, 5, v11
    v_cmp_gt_u32 s[100:101], 5, v12
    v_lshl_add_u32 v11, s63, 2, v13
    v_lshl_add_u32 v12, s3, 2, v13
    s_movk_i32 s60, 320
    v_mad_u32_u24 v11, v11, s60, v10
    v_mad_u32_u24 v12, v12, s60, v10
    s_movk_i32 s60, 1600
    v_mad_u32_u24 v14, v14, s60, v10
    v_mov_b32 v10, 0x7ffffff0
    v_cndmask_b32 v11, v10, v11, vcc
    v_cndmask_b32 v12, v10, v12, s[100:101]
    v_mul_u32_u24 v13, 5, v13
    v_add_u32 v10, 1600, v14
    v_cmp_eq_u32 vcc, s18, v13
    v_add_u32 v14, 1360, v14
    s_cmp_eq_u32 s18, 0
    s_cselect_b64 s[60:61], vcc, 0
    s_cselect_b64 s[100:101], 0, vcc
    v_cndmask_b32 v10, v11, v10, s[60:61]
    v_cndmask_b32 v13, v11, v14, s[100:101]
    s_waitcnt lgkmcnt(6)
    v_mfma_f32_16x16x32_bf16 v[20:23], v[84:87], v[80:83], 0
    ds_read_b128 v[64:67], v1 offset:30768
    ds_read_b128 v[68:71], v2 offset:30768
    v_mfma_f32_16x16x32_bf16 v[24:27], v[88:91], v[80:83], 0
    ds_read_b128 v[72:75], v3 offset:30768
    ds_read_b64_tr_b16 v[76:77], v5 offset:32768
    s_waitcnt lgkmcnt(7)
    v_mfma_f32_16x16x32_bf16 v[20:23], v[28:31], v[92:95], v[20:23]
    ds_read_b64_tr_b16 v[78:79], v5 offset:34816
    ds_read_b64_tr_b16 v[80:81], v5 offset:36864
    v_mfma_f32_16x16x32_bf16 v[24:27], v[32:35], v[92:95], v[24:27]
    ds_read_b64_tr_b16 v[82:83], v5 offset:38912
    ds_read_b64_tr_b16 v[84:85], v5 offset:40960
    s_waitcnt lgkmcnt(8)
    v_mfma_f32_16x16x32_bf16 v[20:23], v[56:59], v[36:39], v[20:23]
    ds_read_b64_tr_b16 v[86:87], v5 offset:43008
    ds_read_b64_tr_b16 v[88:89], v5 offset:45056
    v_mfma_f32_16x16x32_bf16 v[24:27], v[60:63], v[36:39], v[24:27]
    ds_read_b64_tr_b16 v[90:91], v5 offset:47104
    ds_read_b64_tr_b16 v[92:93], v7 offset:28672
    s_waitcnt lgkmcnt(9)
    v_mfma_f32_16x16x32_bf16 v[20:23], v[68:71], v[64:67], v[20:23]
    ds_read_b64_tr_b16 v[94:95], v7 offset:30720
    ds_read_b64_tr_b16 v[28:29], v7 offset:32768
    v_mfma_f32_16x16x32_bf16 v[24:27], v[72:75], v[64:67], v[24:27]
    ds_read_b64_tr_b16 v[30:31], v7 offset:34816
    ds_read_b64_tr_b16 v[32:33], v7 offset:36864
    s_waitcnt lgkmcnt(11)
    v_mfma_f32_16x16x32_bf16 v[40:43], v[76:79], v[96:99], 0
    ds_read_b64_tr_b16 v[34:35], v7 offset:38912
    v_mfma_f32_16x16x32_bf16 v[44:47], v[76:79], v[176:179], 0
    ds_read_b64_tr_b16 v[56:57], v7 offset:40960
    buffer_atomic_add_f32 v20, v10, s[92:95], s42 offen offset:0
    buffer_atomic_add_f32 v21, v11, s[92:95], s42 offen offset:80
    s_waitcnt lgkmcnt(11)
    v_mfma_f32_16x16x32_bf16 v[40:43], v[80:83], v[100:103], v[40:43]
    ds_read_b64_tr_b16 v[58:59], v7 offset:43008
    buffer_atomic_add_f32 v22, v11, s[92:95], s42 offen offset:160
    buffer_atomic_add_f32 v23, v13, s[92:95], s42 offen offset:240
    v_mfma_f32_16x16x32_bf16 v[44:47], v[80:83], v[180:183], v[44:47]
    ds_read_b64_tr_b16 v[60:61], v5 offset:49152
    buffer_atomic_add_f32 v24, v12, s[92:95], s42 offen offset:0
    buffer_atomic_add_f32 v25, v12, s[92:95], s42 offen offset:80
    s_waitcnt lgkmcnt(11)
    v_mfma_f32_16x16x32_bf16 v[40:43], v[84:87], v[104:107], v[40:43]
    ds_read_b64_tr_b16 v[62:63], v5 offset:51200
    buffer_atomic_add_f32 v26, v12, s[92:95], s42 offen offset:160
    buffer_atomic_add_f32 v27, v12, s[92:95], s42 offen offset:240
    v_mfma_f32_16x16x32_bf16 v[44:47], v[84:87], v[184:187], v[44:47]
    ds_read_b64_tr_b16 v[64:65], v5 offset:53248
    v_bfe_u32 v4, v0, 4, 4
    s_waitcnt lgkmcnt(11)
    v_mfma_f32_16x16x32_bf16 v[40:43], v[88:91], v[108:111], v[40:43]
    ds_read_b64_tr_b16 v[66:67], v5 offset:55296
    v_lshl_add_u32 v1, v4, 2, s56
    v_xor_b32 v2, 64, v1
    v_mfma_f32_16x16x32_bf16 v[44:47], v[88:91], v[188:191], v[44:47]
    ds_read_b64_tr_b16 v[68:69], v5 offset:57344
    v_lshrrev_b32 v3, 8, v0
    s_lshl_b32 s60, s14, 2
    s_waitcnt lgkmcnt(11)
    v_mfma_f32_16x16x32_bf16 v[40:43], v[92:95], v[112:115], v[40:43]
    ds_read_b64_tr_b16 v[70:71], v5 offset:59392
    s_add_u32 s60, s60, s59
    v_lshl_add_u32 v3, v3, 4, s60
    v_mfma_f32_16x16x32_bf16 v[44:47], v[92:95], v[192:195], v[44:47]
    ds_read_b64_tr_b16 v[72:73], v5 offset:61440
    v_xor_b32 v4, 128, v3
    s_lshr_b32 s60, s14, 4
    s_waitcnt lgkmcnt(11)
    v_mfma_f32_16x16x32_bf16 v[40:43], v[28:31], v[116:119], v[40:43]
    ds_read_b64_tr_b16 v[74:75], v5 offset:63488
    s_add_u32 s60, s60, s91
    s_xor_b32 s61, s60, 2
    v_mfma_f32_16x16x32_bf16 v[44:47], v[28:31], v[196:199], v[44:47]
    ds_read_b64_tr_b16 v[76:77], v7 offset:45056
    v_lshrrev_b32 v10, 9, v0
    v_add_u32 v10, s60, v10
    s_waitcnt lgkmcnt(11)
    v_mfma_f32_16x16x32_bf16 v[40:43], v[32:35], v[120:123], v[40:43]
    ds_read_b64_tr_b16 v[78:79], v7 offset:47104
    v_mul_u32_u24 v12, 205, v10
    v_lshrrev_b32 v12, 10, v12
    v_mfma_f32_16x16x32_bf16 v[44:47], v[32:35], v[200:203], v[44:47]
    ds_read_b64_tr_b16 v[80:81], v7 offset:49152
    v_mul_u32_u24 v13, 5, v12
    v_sub_u32 v10, v10, v13
    s_waitcnt lgkmcnt(11)
    v_mfma_f32_16x16x32_bf16 v[40:43], v[56:59], v[124:127], v[40:43]
    ds_read_b64_tr_b16 v[82:83], v7 offset:51200
    v_cmp_eq_u32 vcc, 4, v10
    v_and_b32 v13, 3, v12
    v_mfma_f32_16x16x32_bf16 v[44:47], v[56:59], v[204:207], v[44:47]
    ds_read_b64_tr_b16 v[84:85], v7 offset:53248
    s_nop 0
    v_cndmask_b32 v10, v10, v13, vcc
    s_waitcnt lgkmcnt(11)
    v_mfma_f32_16x16x32_bf16 v[40:43], v[60:63], v[128:131], v[40:43]
    ds_read_b64_tr_b16 v[86:87], v7 offset:55296
    v_lshrrev_b32 v13, 2, v12
    v_add_u32 v13, 16, v13
    v_mfma_f32_16x16x32_bf16 v[44:47], v[60:63], v[208:211], v[44:47]
    ds_read_b64_tr_b16 v[88:89], v7 offset:57344
    v_cndmask_b32 v12, v12, v13, vcc
    v_and_b32 v13, 0x1f0, v0
    s_waitcnt lgkmcnt(11)
    v_mfma_f32_16x16x32_bf16 v[40:43], v[64:67], v[132:135], v[40:43]
    ds_read_b64_tr_b16 v[90:91], v7 offset:59392
    v_lshl_add_u32 v12, v12, 10, v13
    v_and_b32 v13, 1, v10
    v_mfma_f32_16x16x32_bf16 v[44:47], v[64:67], v[212:215], v[44:47]
    ds_read_b64_tr_b16 v[92:93], v5 offset:0
    v_lshl_add_u32 v12, v13, 9, v12
    v_lshrrev_b32 v10, 1, v10
    s_waitcnt lgkmcnt(11)
    v_mfma_f32_16x16x32_bf16 v[40:43], v[68:71], v[136:139], v[40:43]
    ds_read_b64_tr_b16 v[94:95], v5 offset:2048
    v_lshl_add_u32 v10, v10, 3, v12
    v_lshrrev_b32 v11, 9, v0
    v_mfma_f32_16x16x32_bf16 v[44:47], v[68:71], v[216:219], v[44:47]
    ds_read_b64_tr_b16 v[56:57], v5 offset:4096
    v_add_u32 v11, s61, v11
    v_mul_u32_u24 v12, 205, v11
    s_waitcnt lgkmcnt(11)
    v_mfma_f32_16x16x32_bf16 v[40:43], v[72:75], v[140:143], v[40:43]
    ds_read_b64_tr_b16 v[58:59], v5 offset:6144
    v_lshrrev_b32 v12, 10, v12
    v_mul_u32_u24 v13, 5, v12
    v_mfma_f32_16x16x32_bf16 v[44:47], v[72:75], v[220:223], v[44:47]
    ds_read_b64_tr_b16 v[60:61], v5 offset:8192
    v_sub_u32 v11, v11, v13
    v_cmp_eq_u32 vcc, 4, v11
    s_waitcnt lgkmcnt(11)
    v_mfma_f32_16x16x32_bf16 v[40:43], v[76:79], v[144:147], v[40:43]
    ds_read_b64_tr_b16 v[62:63], v5 offset:10240
    v_and_b32 v13, 3, v12
    s_nop 0
    v_mfma_f32_16x16x32_bf16 v[44:47], v[76:79], v[224:227], v[44:47]
    ds_read_b64_tr_b16 v[64:65], v5 offset:12288
    v_cndmask_b32 v11, v11, v13, vcc
    v_lshrrev_b32 v13, 2, v12
    s_waitcnt lgkmcnt(11)
    v_mfma_f32_16x16x32_bf16 v[40:43], v[80:83], v[148:151], v[40:43]
    ds_read_b64_tr_b16 v[66:67], v5 offset:14336
    v_add_u32 v13, 16, v13
    v_cndmask_b32 v12, v12, v13, vcc
    v_mfma_f32_16x16x32_bf16 v[44:47], v[80:83], v[228:231], v[44:47]
    ds_read_b64_tr_b16 v[68:69], v6 offset:32768
    v_and_b32 v13, 0x1f0, v0
    v_lshl_add_u32 v12, v12, 10, v13
    s_waitcnt lgkmcnt(11)
    v_mfma_f32_16x16x32_bf16 v[40:43], v[84:87], v[152:155], v[40:43]
    ds_read_b64_tr_b16 v[70:71], v6 offset:34816
    v_and_b32 v13, 1, v11
    v_lshl_add_u32 v12, v13, 9, v12
    v_mfma_f32_16x16x32_bf16 v[44:47], v[84:87], v[232:235], v[44:47]
    ds_read_b64_tr_b16 v[72:73], v6 offset:36864
    v_lshrrev_b32 v11, 1, v11
    v_lshl_add_u32 v11, v11, 3, v12
    s_waitcnt lgkmcnt(11)
    v_mfma_f32_16x16x32_bf16 v[40:43], v[88:91], v[156:159], v[40:43]
    ds_read_b64_tr_b16 v[74:75], v6 offset:38912
    ds_read2st64_b32 v[20:21], v1 offset0:0 offset1:2
    ds_read2st64_b32 v[22:23], v2 offset0:0 offset1:2
    v_mfma_f32_16x16x32_bf16 v[44:47], v[88:91], v[236:239], v[44:47]
    ds_read_b64_tr_b16 v[76:77], v6 offset:40960
    s_waitcnt lgkmcnt(13)
    v_mfma_f32_16x16x32_bf16 v[40:43], v[92:95], v[160:163], v[40:43]
    ds_read_b64_tr_b16 v[78:79], v6 offset:43008
    v_mfma_f32_16x16x32_bf16 v[44:47], v[92:95], v[240:243], v[44:47]
    s_waitcnt lgkmcnt(12)
    v_mfma_f32_16x16x32_bf16 v[40:43], v[56:59], v[164:167], v[40:43]
    v_mfma_f32_16x16x32_bf16 v[44:47], v[56:59], v[244:247], v[44:47]
    ds_read_b64_tr_b16 v[56:57], v6 offset:45056
    ds_read_b64_tr_b16 v[58:59], v6 offset:47104
    s_waitcnt lgkmcnt(0)
    s_barrier
    v_mfma_f32_16x16x32_bf16 v[40:43], v[60:63], v[168:171], v[40:43]
    ds_read_b128 v[80:83], v3 offset:4096
    ds_read_b128 v[84:87], v3 offset:4160
    v_mfma_f32_16x16x32_bf16 v[44:47], v[60:63], v[248:251], v[44:47]
    ds_read_b64_tr_b16 v[60:61], v8 offset:28672
    ds_read_b128 v[88:91], v4 offset:4096
    ds_read_b128 v[92:95], v4 offset:4160
    v_mfma_f32_16x16x32_bf16 v[40:43], v[64:67], v[172:175], v[40:43]
    ds_read_b64_tr_b16 v[62:63], v8 offset:30720
    v_mfma_f32_16x16x32_bf16 v[44:47], v[64:67], v[252:255], v[44:47]
    ds_read_b64_tr_b16 v[64:65], v8 offset:32768
    v_mfma_f32_16x16x32_bf16 v[48:51], v[68:71], v[96:99], 0
    ds_read_b64_tr_b16 v[66:67], v8 offset:34816
    v_mfma_f32_16x16x32_bf16 v[52:55], v[68:71], v[176:179], 0
    ds_read_b64_tr_b16 v[68:69], v8 offset:36864
    ds_read_b64_tr_b16 v[70:71], v8 offset:38912
    s_waitcnt lgkmcnt(8)
    v_add_f32_e64 v80, v80, v84
    v_mfma_f32_16x16x32_bf16 v[48:51], v[72:75], v[100:103], v[48:51]
    ds_read_b64_tr_b16 v[96:97], v8 offset:40960
    v_add_f32_e64 v81, v81, v85
    v_add_f32_e64 v82, v82, v86
    v_mfma_f32_16x16x32_bf16 v[52:55], v[72:75], v[180:183], v[52:55]
    ds_read_b64_tr_b16 v[98:99], v8 offset:43008
    ds_read_b64_tr_b16 v[176:177], v6 offset:49152
    v_add_f32_e64 v83, v83, v87
    v_fma_f32 v28, v80, -v21, s82
    v_mfma_f32_16x16x32_bf16 v[48:51], v[76:79], v[104:107], v[48:51]
    ds_read_b64_tr_b16 v[178:179], v6 offset:51200
    v_fma_f32 v29, v81, -v21, s83
    v_fma_f32 v30, v82, -v21, s82
    v_mfma_f32_16x16x32_bf16 v[52:55], v[76:79], v[184:187], v[52:55]
    ds_read_b64_tr_b16 v[72:73], v6 offset:53248
    v_fma_f32 v31, v83, -v21, s83
    v_fma_f32 v40, v40, v20, v28
    v_mfma_f32_16x16x32_bf16 v[48:51], v[56:59], v[108:111], v[48:51]
    ds_read_b64_tr_b16 v[74:75], v6 offset:55296
    v_fma_f32 v41, v41, v20, v29
    v_fma_f32 v42, v42, v20, v30
    v_mfma_f32_16x16x32_bf16 v[52:55], v[56:59], v[188:191], v[52:55]
    ds_read_b64_tr_b16 v[100:101], v6 offset:57344
    v_fma_f32 v43, v43, v20, v31
    v_exp_f32_e64 v32, v40 clamp
    s_waitcnt lgkmcnt(11)
    v_mfma_f32_16x16x32_bf16 v[48:51], v[60:63], v[112:115], v[48:51]
    ds_read_b64_tr_b16 v[102:103], v6 offset:59392
    v_exp_f32_e64 v33, v41 clamp
    v_max_f32 v40, s82, v40
    v_mfma_f32_16x16x32_bf16 v[52:55], v[60:63], v[192:195], v[52:55]
    ds_read_b64_tr_b16 v[180:181], v6 offset:61440
    v_max_f32 v41, s82, v41
    v_fma_f32 v40, v40, s84, v32
    s_waitcnt lgkmcnt(11)
    v_mfma_f32_16x16x32_bf16 v[48:51], v[64:67], v[116:119], v[48:51]
    ds_read_b64_tr_b16 v[182:183], v6 offset:63488
    v_fma_f32 v41, v41, s85, v33
    v_exp_f32_e64 v34, v42 clamp
    v_mfma_f32_16x16x32_bf16 v[52:55], v[64:67], v[196:199], v[52:55]
    ds_read_b64_tr_b16 v[76:77], v8 offset:45056
    v_exp_f32_e64 v35, v43 clamp
    v_max_f32 v42, s82, v42
    s_waitcnt lgkmcnt(11)
    v_mfma_f32_16x16x32_bf16 v[48:51], v[68:71], v[120:123], v[48:51]
    ds_read_b64_tr_b16 v[78:79], v8 offset:47104
    v_max_f32 v43, s82, v43
    v_fma_f32 v42, v42, s84, v34
    v_mfma_f32_16x16x32_bf16 v[52:55], v[68:71], v[200:203], v[52:55]
    ds_read_b64_tr_b16 v[104:105], v8 offset:49152
    v_fma_f32 v43, v43, s85, v35
    v_cvt_pk_bf16_f32 v40, v40, v41
    s_waitcnt lgkmcnt(11)
    v_mfma_f32_16x16x32_bf16 v[48:51], v[96:99], v[124:127], v[48:51]
    ds_read_b64_tr_b16 v[106:107], v8 offset:51200
    v_cvt_pk_bf16_f32 v41, v42, v43
    buffer_store_dwordx2 v[40:41], v10, s[32:35], s96 offen sc1
    v_mfma_f32_16x16x32_bf16 v[52:55], v[96:99], v[204:207], v[52:55]
    ds_read_b64_tr_b16 v[184:185], v8 offset:53248
    v_fma_f32 v28, v80, -v23, s82
    v_fma_f32 v29, v81, -v23, s83
    s_waitcnt lgkmcnt(11)
    v_mfma_f32_16x16x32_bf16 v[48:51], v[176:179], v[128:131], v[48:51]
    ds_read_b64_tr_b16 v[186:187], v8 offset:55296
    v_fma_f32 v30, v82, -v23, s82
    v_fma_f32 v31, v83, -v23, s83
    v_mfma_f32_16x16x32_bf16 v[52:55], v[176:179], v[208:211], v[52:55]
    ds_read_b64_tr_b16 v[56:57], v8 offset:57344
    v_fma_f32 v44, v44, v22, v28
    v_fma_f32 v45, v45, v22, v29
    s_waitcnt lgkmcnt(11)
    v_mfma_f32_16x16x32_bf16 v[48:51], v[72:75], v[132:135], v[48:51]
    ds_read_b64_tr_b16 v[58:59], v8 offset:59392
    v_fma_f32 v46, v46, v22, v30
    v_fma_f32 v47, v47, v22, v31
    v_mfma_f32_16x16x32_bf16 v[52:55], v[72:75], v[212:215], v[52:55]
    ds_read_b64_tr_b16 v[108:109], v6 offset:0
    v_exp_f32_e64 v32, v44 clamp
    v_exp_f32_e64 v33, v45 clamp
    s_waitcnt lgkmcnt(11)
    v_mfma_f32_16x16x32_bf16 v[48:51], v[100:103], v[136:139], v[48:51]
    ds_read_b64_tr_b16 v[110:111], v6 offset:2048
    v_max_f32 v44, s82, v44
    v_max_f32 v45, s82, v45
    v_mfma_f32_16x16x32_bf16 v[52:55], v[100:103], v[216:219], v[52:55]
    ds_read_b64_tr_b16 v[188:189], v6 offset:4096
    v_fma_f32 v44, v44, s84, v32
    v_fma_f32 v45, v45, s85, v33
    s_waitcnt lgkmcnt(11)
    v_mfma_f32_16x16x32_bf16 v[48:51], v[180:183], v[140:143], v[48:51]
    ds_read_b64_tr_b16 v[190:191], v6 offset:6144
    v_exp_f32_e64 v34, v46 clamp
    v_exp_f32_e64 v35, v47 clamp
    v_mfma_f32_16x16x32_bf16 v[52:55], v[180:183], v[220:223], v[52:55]
    ds_read_b64_tr_b16 v[60:61], v6 offset:8192
    v_max_f32 v46, s82, v46
    v_max_f32 v47, s82, v47
    s_waitcnt lgkmcnt(11)
    v_mfma_f32_16x16x32_bf16 v[48:51], v[76:79], v[144:147], v[48:51]
    ds_read_b64_tr_b16 v[62:63], v6 offset:10240
    v_fma_f32 v46, v46, s84, v34
    v_fma_f32 v47, v47, s85, v35
    v_mfma_f32_16x16x32_bf16 v[52:55], v[76:79], v[224:227], v[52:55]
    ds_read_b64_tr_b16 v[112:113], v6 offset:12288
    v_cvt_pk_bf16_f32 v44, v44, v45
    v_cvt_pk_bf16_f32 v45, v46, v47
    s_waitcnt lgkmcnt(11)
    v_mfma_f32_16x16x32_bf16 v[48:51], v[104:107], v[148:151], v[48:51]
    ds_read_b64_tr_b16 v[114:115], v6 offset:14336
    buffer_store_dwordx2 v[44:45], v10, s[32:35], s97 offen sc1
    v_mfma_f32_16x16x32_bf16 v[52:55], v[104:107], v[228:231], v[52:55]
    s_waitcnt lgkmcnt(10)
    v_mfma_f32_16x16x32_bf16 v[48:51], v[184:187], v[152:155], v[48:51]
    v_mfma_f32_16x16x32_bf16 v[52:55], v[184:187], v[232:235], v[52:55]
    s_waitcnt lgkmcnt(8)
    v_mfma_f32_16x16x32_bf16 v[48:51], v[56:59], v[156:159], v[48:51]
    v_mfma_f32_16x16x32_bf16 v[52:55], v[56:59], v[236:239], v[52:55]
    s_waitcnt lgkmcnt(6)
    v_mfma_f32_16x16x32_bf16 v[48:51], v[108:111], v[160:163], v[48:51]
    v_mfma_f32_16x16x32_bf16 v[52:55], v[108:111], v[240:243], v[52:55]
    s_waitcnt lgkmcnt(4)
    v_mfma_f32_16x16x32_bf16 v[48:51], v[188:191], v[164:167], v[48:51]
    v_mfma_f32_16x16x32_bf16 v[52:55], v[188:191], v[244:247], v[52:55]
    s_waitcnt lgkmcnt(2)
    v_mfma_f32_16x16x32_bf16 v[48:51], v[60:63], v[168:171], v[48:51]
    v_mfma_f32_16x16x32_bf16 v[52:55], v[60:63], v[248:251], v[52:55]
    s_waitcnt lgkmcnt(0)
    v_mfma_f32_16x16x32_bf16 v[48:51], v[112:115], v[172:175], v[48:51]
    v_mfma_f32_16x16x32_bf16 v[52:55], v[112:115], v[252:255], v[52:55]
    v_pk_add_f32 v[88:89], v[88:89], v[92:93]
    v_pk_add_f32 v[90:91], v[90:91], v[94:95]
    v_mov_b32 v32, v21
    v_pk_fma_f32 v[28:29], v[88:89], v[32:33], s[82:83] op_sel:[0,0,0] op_sel_hi:[1,0,1] neg_lo:[0,1,0] neg_hi:[0,1,0]
    v_pk_fma_f32 v[30:31], v[90:91], v[32:33], s[82:83] op_sel:[0,0,0] op_sel_hi:[1,0,1] neg_lo:[0,1,0] neg_hi:[0,1,0]
    s_nop 1
    v_pk_fma_f32 v[48:49], v[48:49], v[20:21], v[28:29] op_sel:[0,0,0] op_sel_hi:[1,0,1]
    v_pk_fma_f32 v[50:51], v[50:51], v[20:21], v[30:31] op_sel:[0,0,0] op_sel_hi:[1,0,1]
    v_exp_f32_e64 v32, v48 clamp
    v_exp_f32_e64 v33, v49 clamp
    v_max_f32 v48, s82, v48
    v_max_f32 v49, s82, v49
    v_pk_fma_f32 v[48:49], v[48:49], s[84:85], v[32:33]
    v_exp_f32_e64 v34, v50 clamp
    v_exp_f32_e64 v35, v51 clamp
    v_max_f32 v50, s82, v50
    v_max_f32 v51, s82, v51
    v_pk_fma_f32 v[50:51], v[50:51], s[84:85], v[34:35]
    v_cvt_pk_bf16_f32 v48, v48, v49
    v_cvt_pk_bf16_f32 v49, v50, v51
    buffer_store_dwordx2 v[48:49], v11, s[32:35], s96 offen sc1
    v_mov_b32 v32, v23
    v_pk_fma_f32 v[28:29], v[88:89], v[32:33], s[82:83] op_sel:[0,0,0] op_sel_hi:[1,0,1] neg_lo:[0,1,0] neg_hi:[0,1,0]
    v_pk_fma_f32 v[30:31], v[90:91], v[32:33], s[82:83] op_sel:[0,0,0] op_sel_hi:[1,0,1] neg_lo:[0,1,0] neg_hi:[0,1,0]
    v_pk_fma_f32 v[52:53], v[52:53], v[22:23], v[28:29] op_sel:[0,0,0] op_sel_hi:[1,0,1]
    v_pk_fma_f32 v[54:55], v[54:55], v[22:23], v[30:31] op_sel:[0,0,0] op_sel_hi:[1,0,1]
    v_exp_f32_e64 v32, v52 clamp
    v_exp_f32_e64 v33, v53 clamp
    v_max_f32 v52, s82, v52
    v_max_f32 v53, s82, v53
    v_pk_fma_f32 v[52:53], v[52:53], s[84:85], v[32:33]
    v_exp_f32_e64 v34, v54 clamp
    v_exp_f32_e64 v35, v55 clamp
    v_max_f32 v54, s82, v54
    v_max_f32 v55, s82, v55
    v_pk_fma_f32 v[54:55], v[54:55], s[84:85], v[34:35]
    v_cvt_pk_bf16_f32 v52, v52, v53
    v_cvt_pk_bf16_f32 v53, v54, v55
    buffer_store_dwordx2 v[52:53], v11, s[32:35], s97 offen sc1
    s_endpgm
K1_K_B:
    ds_read2_b32 v[20:21], v14 offset0:0 offset1:16
    ds_read2_b32 v[22:23], v14 offset0:32 offset1:48
    ds_read_b128 v[36:39], v1
    v_mfma_f32_16x16x32_bf16 v[80:83], v[172:175], v[48:51], v[80:83]
    ds_read_b128 v[40:43], v1 offset:512
    ds_read2_b32 v[24:25], v10 offset0:128 offset1:144
    v_lshrrev_b32 v5, 6, v0
    v_lshlrev_b32 v5, 7, v5
    v_mfma_f32_16x16x32_bf16 v[84:87], v[252:255], v[48:51], v[84:87]
    ds_read2_b32 v[26:27], v10 offset0:160 offset1:176
    ds_read_b128 v[44:47], v2
    v_bfe_u32 v6, v0, 4, 2
    v_lshl_add_u32 v5, v6, 3, v5
    v_mfma_f32_16x16x32_bf16 v[88:91], v[172:175], v[52:55], v[88:91]
    ds_read_b128 v[28:31], v2 offset:512
    v_bfe_u32 v6, v0, 7, 2
    v_lshl_add_u32 v5, v6, 5, v5
    v_mfma_f32_16x16x32_bf16 v[92:95], v[252:255], v[52:55], v[92:95]
    v_xor_b32 v5, s14, v5
    v_xor_b32 v6, 32, v5
    s_setprio 2
    s_waitcnt lgkmcnt(0)
    v_add_f32 v24, v24, v25
    v_add_f32 v26, v26, v27
    v_add_u32 v3, s19, v0
    v_add_f32 v24, v24, v26
    v_pk_mul_f32 v[32:33], v[28:29], v[20:21] op_sel:[0,0] op_sel_hi:[1,0] neg_lo:[0,1] neg_hi:[0,1]
    v_pk_mul_f32 v[34:35], v[30:31], v[20:21] op_sel:[0,0] op_sel_hi:[1,0] neg_lo:[0,1] neg_hi:[0,1]
    v_pk_fma_f32 v[60:61], v[60:61], v[44:45], v[32:33]
    v_pk_fma_f32 v[62:63], v[62:63], v[46:47], v[34:35]
    v_cvt_pk_bf16_f32 v60, v60, v61
    v_cvt_pk_bf16_f32 v61, v62, v63
    v_pk_mul_f32 v[32:33], v[40:41], v[20:21] op_sel:[0,0] op_sel_hi:[1,0] neg_lo:[0,1] neg_hi:[0,1]
    v_pk_mul_f32 v[34:35], v[42:43], v[20:21] op_sel:[0,0] op_sel_hi:[1,0] neg_lo:[0,1] neg_hi:[0,1]
    v_pk_fma_f32 v[56:57], v[56:57], v[36:37], v[32:33]
    v_pk_fma_f32 v[58:59], v[58:59], v[38:39], v[34:35]
    v_cvt_pk_bf16_f32 v62, v56, v57
    v_cvt_pk_bf16_f32 v63, v58, v59
    s_add_u32 s60, s50, 0
    s_and_b32 s60, s60, 3
    s_lshl_b32 s60, s60, 10
    v_add_u32 v4, s60, v3
    ds_write_b128 v4, v[60:63]
    v_pk_mul_f32 v[32:33], v[28:29], v[24:25] op_sel:[0,0] op_sel_hi:[1,0] neg_lo:[0,1] neg_hi:[0,1]
    v_pk_mul_f32 v[34:35], v[30:31], v[24:25] op_sel:[0,0] op_sel_hi:[1,0] neg_lo:[0,1] neg_hi:[0,1]
    v_pk_fma_f32 v[68:69], v[68:69], v[44:45], v[32:33]
    v_pk_fma_f32 v[70:71], v[70:71], v[46:47], v[34:35]
    v_cvt_pk_bf16_f32 v68, v68, v69
    v_cvt_pk_bf16_f32 v69, v70, v71
    v_pk_mul_f32 v[32:33], v[40:41], v[24:25] op_sel:[0,0] op_sel_hi:[1,0] neg_lo:[0,1] neg_hi:[0,1]
    v_pk_mul_f32 v[34:35], v[42:43], v[24:25] op_sel:[0,0] op_sel_hi:[1,0] neg_lo:[0,1] neg_hi:[0,1]
    v_pk_fma_f32 v[64:65], v[64:65], v[36:37], v[32:33]
    v_pk_fma_f32 v[66:67], v[66:67], v[38:39], v[34:35]
    v_cvt_pk_bf16_f32 v70, v64, v65
    v_cvt_pk_bf16_f32 v71, v66, v67
    ds_write_b128 v3, v[68:71] offset:4096
    v_mov_b32 v26, v21
    v_pk_mul_f32 v[32:33], v[28:29], v[26:27] op_sel:[0,0] op_sel_hi:[1,0] neg_lo:[0,1] neg_hi:[0,1]
    v_pk_mul_f32 v[34:35], v[30:31], v[26:27] op_sel:[0,0] op_sel_hi:[1,0] neg_lo:[0,1] neg_hi:[0,1]
    v_pk_fma_f32 v[76:77], v[76:77], v[44:45], v[32:33]
    v_pk_fma_f32 v[78:79], v[78:79], v[46:47], v[34:35]
    v_cvt_pk_bf16_f32 v76, v76, v77
    v_cvt_pk_bf16_f32 v77, v78, v79
    v_pk_mul_f32 v[32:33], v[40:41], v[26:27] op_sel:[0,0] op_sel_hi:[1,0] neg_lo:[0,1] neg_hi:[0,1]
    v_pk_mul_f32 v[34:35], v[42:43], v[26:27] op_sel:[0,0] op_sel_hi:[1,0] neg_lo:[0,1] neg_hi:[0,1]
    v_pk_fma_f32 v[72:73], v[72:73], v[36:37], v[32:33]
    v_pk_fma_f32 v[74:75], v[74:75], v[38:39], v[34:35]
    v_cvt_pk_bf16_f32 v78, v72, v73
    v_cvt_pk_bf16_f32 v79, v74, v75
    s_add_u32 s60, s50, 1
    s_and_b32 s60, s60, 3
    s_lshl_b32 s60, s60, 10
    v_add_u32 v4, s60, v3
    ds_write_b128 v4, v[76:79]
    v_pk_mul_f32 v[32:33], v[28:29], v[22:23] op_sel:[0,0] op_sel_hi:[1,0] neg_lo:[0,1] neg_hi:[0,1]
    v_pk_mul_f32 v[34:35], v[30:31], v[22:23] op_sel:[0,0] op_sel_hi:[1,0] neg_lo:[0,1] neg_hi:[0,1]
    v_pk_fma_f32 v[84:85], v[84:85], v[44:45], v[32:33]
    v_pk_fma_f32 v[86:87], v[86:87], v[46:47], v[34:35]
    v_cvt_pk_bf16_f32 v84, v84, v85
    v_cvt_pk_bf16_f32 v85, v86, v87
    v_pk_mul_f32 v[32:33], v[40:41], v[22:23] op_sel:[0,0] op_sel_hi:[1,0] neg_lo:[0,1] neg_hi:[0,1]
    v_pk_mul_f32 v[34:35], v[42:43], v[22:23] op_sel:[0,0] op_sel_hi:[1,0] neg_lo:[0,1] neg_hi:[0,1]
    v_pk_fma_f32 v[80:81], v[80:81], v[36:37], v[32:33]
    v_pk_fma_f32 v[82:83], v[82:83], v[38:39], v[34:35]
    v_cvt_pk_bf16_f32 v86, v80, v81
    v_cvt_pk_bf16_f32 v87, v82, v83
    s_add_u32 s60, s50, 2
    s_and_b32 s60, s60, 3
    s_lshl_b32 s60, s60, 10
    v_add_u32 v4, s60, v3
    ds_write_b128 v4, v[84:87]
    v_mov_b32 v26, v23
    v_pk_mul_f32 v[32:33], v[28:29], v[26:27] op_sel:[0,0] op_sel_hi:[1,0] neg_lo:[0,1] neg_hi:[0,1]
    v_pk_mul_f32 v[34:35], v[30:31], v[26:27] op_sel:[0,0] op_sel_hi:[1,0] neg_lo:[0,1] neg_hi:[0,1]
    v_pk_fma_f32 v[92:93], v[92:93], v[44:45], v[32:33]
    v_pk_fma_f32 v[94:95], v[94:95], v[46:47], v[34:35]
    v_cvt_pk_bf16_f32 v92, v92, v93
    v_cvt_pk_bf16_f32 v93, v94, v95
    v_pk_mul_f32 v[32:33], v[40:41], v[26:27] op_sel:[0,0] op_sel_hi:[1,0] neg_lo:[0,1] neg_hi:[0,1]
    v_pk_mul_f32 v[34:35], v[42:43], v[26:27] op_sel:[0,0] op_sel_hi:[1,0] neg_lo:[0,1] neg_hi:[0,1]
    v_pk_fma_f32 v[88:89], v[88:89], v[36:37], v[32:33]
    v_pk_fma_f32 v[90:91], v[90:91], v[38:39], v[34:35]
    v_cvt_pk_bf16_f32 v94, v88, v89
    v_cvt_pk_bf16_f32 v95, v90, v91
    s_add_u32 s60, s50, 3
    s_and_b32 s60, s60, 3
    s_lshl_b32 s60, s60, 10
    v_add_u32 v4, s60, v3
    ds_write_b128 v4, v[92:95]
    s_mov_b64 exec, 1
    ds_write_b128 v3, v[16:19] offset:5120
    s_mov_b64 exec, -1
    v_add_u32 v7, 81920, v5
    v_add_u32 v8, 81920, v6
    s_and_b32 s60, s50, 1
    s_lshl_b32 s60, s60, 6
    s_xor_b32 s15, s14, s60
    v_xor_b32 v9, s60, v5
    v_xor_b32 v10, 64, v9
    v_add_u32 v11, 81920, v9
    v_add_u32 v12, 81920, v10
    s_setprio 0
    ds_read_b64_tr_b16 v[20:21], v5 offset:32768
    ds_read_b64_tr_b16 v[22:23], v5 offset:34816
    ds_read_b64_tr_b16 v[24:25], v6 offset:32768
    ds_read_b64_tr_b16 v[26:27], v6 offset:34816
    ds_read_b64_tr_b16 v[64:65], v5 offset:36864
    ds_read_b64_tr_b16 v[66:67], v5 offset:38912
    ds_read_b64_tr_b16 v[68:69], v6 offset:36864
    ds_read_b64_tr_b16 v[70:71], v6 offset:38912
    ds_read_b64_tr_b16 v[72:73], v9 offset:32768
    s_waitcnt lgkmcnt(7)
    v_mfma_f32_16x16x32_bf16 v[40:43], v[20:23], v[96:99], 0
    ds_read_b64_tr_b16 v[74:75], v9 offset:34816
    ds_read_b64_tr_b16 v[76:77], v5 offset:40960
    v_lshl_add_u32 v28, s62, 10, v0
    v_add_u32 v28, 65536, v28
    v_mfma_f32_16x16x32_bf16 v[44:47], v[20:23], v[176:179], 0
    ds_read_b64_tr_b16 v[78:79], v5 offset:43008
    ds_read_b64_tr_b16 v[80:81], v6 offset:40960
    v_lshl_add_u32 v29, s63, 10, v0
    v_add_u32 v29, 70656, v29
    s_waitcnt lgkmcnt(9)
    v_mfma_f32_16x16x32_bf16 v[48:51], v[24:27], v[96:99], 0
    ds_read_b64_tr_b16 v[82:83], v6 offset:43008
    ds_read_b64_tr_b16 v[84:85], v10 offset:36864
    v_lshl_add_u32 v30, s3, 10, v0
    v_add_u32 v30, 70656, v30
    v_mfma_f32_16x16x32_bf16 v[52:55], v[24:27], v[176:179], 0
    ds_read_b64_tr_b16 v[86:87], v10 offset:38912
    ds_read_b64_tr_b16 v[88:89], v5 offset:45056
    v_bfe_u32 v32, v0, 4, 4
    v_cmp_eq_u32 vcc, s18, v32
    s_waitcnt lgkmcnt(11)
    v_mfma_f32_16x16x32_bf16 v[40:43], v[64:67], v[100:103], v[40:43]
    ds_read_b64_tr_b16 v[90:91], v5 offset:47104
    ds_read_b64_tr_b16 v[92:93], v6 offset:45056
    v_mov_b32 v31, 75776
    s_nop 0
    v_mfma_f32_16x16x32_bf16 v[44:47], v[64:67], v[180:183], v[44:47]
    ds_read_b64_tr_b16 v[94:95], v6 offset:47104
    ds_read_b64_tr_b16 v[20:21], v9 offset:40960
    v_cndmask_b32 v29, v29, v31, vcc
    s_cmp_eq_u32 s64, 0
    s_cbranch_scc1 K1_ZP1
K1_ZPR1:
    s_waitcnt lgkmcnt(13)
    v_mfma_f32_16x16x32_bf16 v[48:51], v[68:71], v[100:103], v[48:51]
    ds_read_b64_tr_b16 v[22:23], v9 offset:43008
    v_lshl_add_u32 v33, s62, 4, v32
    v_mul_u32_u24 v37, 205, v33
    v_mfma_f32_16x16x32_bf16 v[52:55], v[68:71], v[180:183], v[52:55]
    ds_read_b64_tr_b16 v[24:25], v10 offset:45056
    v_lshrrev_b32 v37, 12, v37
    v_lshlrev_b32 v33, 2, v33
    s_waitcnt lgkmcnt(13)
    v_mfma_f32_16x16x32_bf16 v[96:99], v[16:19], v[72:75], 0
    ds_read_b64_tr_b16 v[26:27], v10 offset:47104
    v_lshrrev_b32 v36, 8, v0
    v_mad_i32_i24 v35, v37, -5, v36
    s_waitcnt lgkmcnt(12)
    v_mfma_f32_16x16x32_bf16 v[40:43], v[76:79], v[104:107], v[40:43]
    v_lshl_add_u32 v34, s63, 2, v35
    v_lshl_add_u32 v35, s3, 2, v35
    v_mfma_f32_16x16x32_bf16 v[44:47], v[76:79], v[184:187], v[44:47]
    v_cmp_gt_u32 vcc, 5, v34
    v_cmp_gt_u32 s[100:101], 5, v35
    s_waitcnt lgkmcnt(10)
    v_mfma_f32_16x16x32_bf16 v[48:51], v[80:83], v[104:107], v[48:51]
    v_lshl_add_u32 v34, s63, 2, v36
    v_lshl_add_u32 v35, s3, 2, v36
    v_mfma_f32_16x16x32_bf16 v[52:55], v[80:83], v[184:187], v[52:55]
    s_movk_i32 s60, 320
    v_mad_u32_u24 v34, v34, s60, v33
    v_mad_u32_u24 v35, v35, s60, v33
    s_movk_i32 s60, 1600
    v_mad_u32_u24 v37, v37, s60, v33
    v_mov_b32 v33, 0x7ffffff0
    v_cndmask_b32 v34, v33, v34, vcc
    v_cndmask_b32 v35, v33, v35, s[100:101]
    v_mul_u32_u24 v36, 5, v36
    v_add_u32 v33, 1600, v37
    v_cmp_eq_u32 vcc, s18, v36
    v_add_u32 v37, 1360, v37
    s_cmp_eq_u32 s18, 0
    s_cselect_b64 s[60:61], vcc, 0
    s_cselect_b64 s[100:101], 0, vcc
    v_cndmask_b32 v33, v34, v33, s[60:61]
    v_cndmask_b32 v36, v34, v37, s[100:101]
    s_waitcnt vmcnt(0)
    s_waitcnt lgkmcnt(0)
    s_barrier
    v_mfma_f32_16x16x32_bf16 v[176:179], v[16:19], v[84:87], 0
    ds_read_b128 v[64:67], v28 offset:0
    ds_read_b128 v[68:71], v29 offset:0
    v_mfma_f32_16x16x32_bf16 v[40:43], v[88:91], v[108:111], v[40:43]
    ds_read_b128 v[180:183], v30 offset:0
    ds_read_b128 v[72:75], v28 offset:10256
    v_mfma_f32_16x16x32_bf16 v[44:47], v[88:91], v[188:191], v[44:47]
    ds_read_b128 v[76:79], v29 offset:10256
    ds_read_b128 v[80:83], v30 offset:10256
    v_mfma_f32_16x16x32_bf16 v[48:51], v[92:95], v[108:111], v[48:51]
    ds_read_b128 v[104:107], v28 offset:20512
    ds_read_b128 v[184:187], v29 offset:20512
    v_mfma_f32_16x16x32_bf16 v[52:55], v[92:95], v[188:191], v[52:55]
    ds_read_b128 v[84:87], v30 offset:20512
    ds_read_b128 v[88:91], v28 offset:30768
    v_mfma_f32_16x16x32_bf16 v[96:99], v[16:19], v[20:23], v[96:99]
    ds_read_b128 v[92:95], v29 offset:30768
    ds_read_b128 v[108:111], v30 offset:30768
    v_mfma_f32_16x16x32_bf16 v[176:179], v[16:19], v[24:27], v[176:179]
    ds_read_b64_tr_b16 v[188:189], v11 offset:28672
    ds_read_b64_tr_b16 v[190:191], v11 offset:30720
    s_waitcnt lgkmcnt(11)
    v_mfma_f32_16x16x32_bf16 v[56:59], v[68:71], v[64:67], 0
    ds_read_b64_tr_b16 v[20:21], v7 offset:28672
    ds_read_b64_tr_b16 v[22:23], v7 offset:30720
    v_mfma_f32_16x16x32_bf16 v[60:63], v[180:183], v[64:67], 0
    ds_read_b64_tr_b16 v[24:25], v8 offset:28672
    ds_read_b64_tr_b16 v[26:27], v8 offset:30720
    s_waitcnt lgkmcnt(12)
    v_mfma_f32_16x16x32_bf16 v[56:59], v[76:79], v[72:75], v[56:59]
    ds_read_b64_tr_b16 v[64:65], v12 offset:32768
    ds_read_b64_tr_b16 v[66:67], v12 offset:34816
    v_mfma_f32_16x16x32_bf16 v[60:63], v[80:83], v[72:75], v[60:63]
    ds_read_b64_tr_b16 v[68:69], v7 offset:32768
    ds_read_b64_tr_b16 v[70:71], v7 offset:34816
    s_waitcnt lgkmcnt(13)
    v_mfma_f32_16x16x32_bf16 v[56:59], v[184:187], v[104:107], v[56:59]
    ds_read_b64_tr_b16 v[180:181], v8 offset:32768
    v_mfma_f32_16x16x32_bf16 v[60:63], v[84:87], v[104:107], v[60:63]
    ds_read_b64_tr_b16 v[182:183], v8 offset:34816
    ds_read_b64_tr_b16 v[72:73], v11 offset:36864
    s_waitcnt lgkmcnt(13)
    v_mfma_f32_16x16x32_bf16 v[56:59], v[92:95], v[88:91], v[56:59]
    ds_read_b64_tr_b16 v[74:75], v11 offset:38912
    v_mfma_f32_16x16x32_bf16 v[60:63], v[108:111], v[88:91], v[60:63]
    ds_read_b64_tr_b16 v[76:77], v7 offset:36864
    s_waitcnt lgkmcnt(13)
    v_mfma_f32_16x16x32_bf16 v[96:99], v[16:19], v[188:191], v[96:99]
    ds_read_b64_tr_b16 v[78:79], v7 offset:38912
    ds_read_b64_tr_b16 v[80:81], v8 offset:36864
    s_waitcnt lgkmcnt(13)
    v_mfma_f32_16x16x32_bf16 v[40:43], v[20:23], v[112:115], v[40:43]
    ds_read_b64_tr_b16 v[82:83], v8 offset:38912
    buffer_atomic_add_f32 v56, v33, s[92:95], s42 offen offset:0
    buffer_atomic_add_f32 v57, v34, s[92:95], s42 offen offset:80
    v_mfma_f32_16x16x32_bf16 v[44:47], v[20:23], v[192:195], v[44:47]
    ds_read_b64_tr_b16 v[104:105], v12 offset:40960
    buffer_atomic_add_f32 v58, v34, s[92:95], s42 offen offset:160
    buffer_atomic_add_f32 v59, v36, s[92:95], s42 offen offset:240
    s_waitcnt lgkmcnt(13)
    v_mfma_f32_16x16x32_bf16 v[48:51], v[24:27], v[112:115], v[48:51]
    ds_read_b64_tr_b16 v[106:107], v12 offset:43008
    buffer_atomic_add_f32 v60, v35, s[92:95], s42 offen offset:0
    buffer_atomic_add_f32 v61, v35, s[92:95], s42 offen offset:80
    v_mfma_f32_16x16x32_bf16 v[52:55], v[24:27], v[192:195], v[52:55]
    ds_read_b64_tr_b16 v[184:185], v7 offset:40960
    buffer_atomic_add_f32 v62, v35, s[92:95], s42 offen offset:160
    buffer_atomic_add_f32 v63, v35, s[92:95], s42 offen offset:240
    s_waitcnt lgkmcnt(13)
    v_mfma_f32_16x16x32_bf16 v[176:179], v[16:19], v[64:67], v[176:179]
    ds_read_b64_tr_b16 v[186:187], v7 offset:43008
    ds_read_b64_tr_b16 v[84:85], v8 offset:40960
    v_bfe_u32 v13, v0, 4, 4
    s_waitcnt lgkmcnt(13)
    v_mfma_f32_16x16x32_bf16 v[40:43], v[68:71], v[116:119], v[40:43]
    ds_read_b64_tr_b16 v[86:87], v8 offset:43008
    s_lshl_b32 s60, s15, 2
    s_add_u32 s60, s60, s59
    v_mfma_f32_16x16x32_bf16 v[44:47], v[68:71], v[196:199], v[44:47]
    ds_read_b64_tr_b16 v[88:89], v9 offset:49152
    v_lshl_add_u32 v13, v13, 2, s60
    v_xor_b32 v14, 0x100, v13
    s_waitcnt lgkmcnt(13)
    v_mfma_f32_16x16x32_bf16 v[48:51], v[180:183], v[116:119], v[48:51]
    ds_read_b64_tr_b16 v[90:91], v9 offset:51200
    v_mfma_f32_16x16x32_bf16 v[52:55], v[180:183], v[196:199], v[52:55]
    ds_read_b64_tr_b16 v[92:93], v5 offset:49152
    s_waitcnt lgkmcnt(13)
    v_mfma_f32_16x16x32_bf16 v[96:99], v[16:19], v[72:75], v[96:99]
    ds_read_b64_tr_b16 v[94:95], v5 offset:51200
    ds_read_b64_tr_b16 v[108:109], v6 offset:49152
    s_waitcnt lgkmcnt(13)
    v_mfma_f32_16x16x32_bf16 v[40:43], v[76:79], v[120:123], v[40:43]
    ds_read_b64_tr_b16 v[110:111], v6 offset:51200
    v_mfma_f32_16x16x32_bf16 v[44:47], v[76:79], v[200:203], v[44:47]
    ds_read_b64_tr_b16 v[188:189], v10 offset:53248
    s_waitcnt lgkmcnt(13)
    v_mfma_f32_16x16x32_bf16 v[48:51], v[80:83], v[120:123], v[48:51]
    ds_read_b64_tr_b16 v[190:191], v10 offset:55296
    v_mfma_f32_16x16x32_bf16 v[52:55], v[80:83], v[200:203], v[52:55]
    ds_read_b64_tr_b16 v[20:21], v5 offset:53248
    s_waitcnt lgkmcnt(13)
    v_mfma_f32_16x16x32_bf16 v[176:179], v[16:19], v[104:107], v[176:179]
    ds_read_b64_tr_b16 v[22:23], v5 offset:55296
    ds_read_b64_tr_b16 v[24:25], v6 offset:53248
    s_waitcnt lgkmcnt(13)
    v_mfma_f32_16x16x32_bf16 v[40:43], v[184:187], v[124:127], v[40:43]
    ds_read_b64_tr_b16 v[26:27], v6 offset:55296
    v_mfma_f32_16x16x32_bf16 v[44:47], v[184:187], v[204:207], v[44:47]
    ds_read_b64_tr_b16 v[112:113], v9 offset:57344
    s_waitcnt lgkmcnt(13)
    v_mfma_f32_16x16x32_bf16 v[48:51], v[84:87], v[124:127], v[48:51]
    ds_read_b64_tr_b16 v[114:115], v9 offset:59392
    v_mfma_f32_16x16x32_bf16 v[52:55], v[84:87], v[204:207], v[52:55]
    ds_read_b64_tr_b16 v[192:193], v5 offset:57344
    s_waitcnt lgkmcnt(13)
    v_mfma_f32_16x16x32_bf16 v[96:99], v[16:19], v[88:91], v[96:99]
    ds_read_b64_tr_b16 v[194:195], v5 offset:59392
    ds_read_b64_tr_b16 v[64:65], v6 offset:57344
    s_waitcnt lgkmcnt(13)
    v_mfma_f32_16x16x32_bf16 v[40:43], v[92:95], v[128:131], v[40:43]
    ds_read_b64_tr_b16 v[66:67], v6 offset:59392
    v_mfma_f32_16x16x32_bf16 v[44:47], v[92:95], v[208:211], v[44:47]
    ds_read_b64_tr_b16 v[68:69], v10 offset:61440
    s_waitcnt lgkmcnt(13)
    v_mfma_f32_16x16x32_bf16 v[48:51], v[108:111], v[128:131], v[48:51]
    ds_read_b64_tr_b16 v[70:71], v10 offset:63488
    v_mfma_f32_16x16x32_bf16 v[52:55], v[108:111], v[208:211], v[52:55]
    ds_read_b64_tr_b16 v[180:181], v5 offset:61440
    s_waitcnt lgkmcnt(13)
    v_mfma_f32_16x16x32_bf16 v[176:179], v[16:19], v[188:191], v[176:179]
    ds_read_b64_tr_b16 v[182:183], v5 offset:63488
    ds_read_b64_tr_b16 v[116:117], v6 offset:61440
    s_waitcnt lgkmcnt(13)
    v_mfma_f32_16x16x32_bf16 v[40:43], v[20:23], v[132:135], v[40:43]
    ds_read_b64_tr_b16 v[118:119], v6 offset:63488
    v_mfma_f32_16x16x32_bf16 v[44:47], v[20:23], v[212:215], v[44:47]
    ds_read_b64_tr_b16 v[196:197], v11 offset:45056
    s_waitcnt lgkmcnt(13)
    v_mfma_f32_16x16x32_bf16 v[48:51], v[24:27], v[132:135], v[48:51]
    ds_read_b64_tr_b16 v[198:199], v11 offset:47104
    v_mfma_f32_16x16x32_bf16 v[52:55], v[24:27], v[212:215], v[52:55]
    ds_read_b64_tr_b16 v[72:73], v7 offset:45056
    s_waitcnt lgkmcnt(13)
    v_mfma_f32_16x16x32_bf16 v[96:99], v[16:19], v[112:115], v[96:99]
    ds_read_b64_tr_b16 v[74:75], v7 offset:47104
    ds_read_b64_tr_b16 v[76:77], v8 offset:45056
    s_waitcnt lgkmcnt(13)
    v_mfma_f32_16x16x32_bf16 v[40:43], v[192:195], v[136:139], v[40:43]
    ds_read_b64_tr_b16 v[78:79], v8 offset:47104
    v_mfma_f32_16x16x32_bf16 v[44:47], v[192:195], v[216:219], v[44:47]
    ds_read_b64_tr_b16 v[80:81], v12 offset:49152
    s_waitcnt lgkmcnt(13)
    v_mfma_f32_16x16x32_bf16 v[48:51], v[64:67], v[136:139], v[48:51]
    ds_read_b64_tr_b16 v[82:83], v12 offset:51200
    v_mfma_f32_16x16x32_bf16 v[52:55], v[64:67], v[216:219], v[52:55]
    ds_read_b64_tr_b16 v[200:201], v7 offset:49152
    s_waitcnt lgkmcnt(13)
    v_mfma_f32_16x16x32_bf16 v[176:179], v[16:19], v[68:71], v[176:179]
    ds_read_b64_tr_b16 v[202:203], v7 offset:51200
    ds_read_b64_tr_b16 v[104:105], v8 offset:49152
    s_waitcnt lgkmcnt(13)
    v_mfma_f32_16x16x32_bf16 v[40:43], v[180:183], v[140:143], v[40:43]
    ds_read_b64_tr_b16 v[106:107], v8 offset:51200
    v_mfma_f32_16x16x32_bf16 v[44:47], v[180:183], v[220:223], v[44:47]
    ds_read_b64_tr_b16 v[184:185], v11 offset:53248
    s_waitcnt lgkmcnt(13)
    v_mfma_f32_16x16x32_bf16 v[48:51], v[116:119], v[140:143], v[48:51]
    ds_read_b64_tr_b16 v[186:187], v11 offset:55296
    v_mfma_f32_16x16x32_bf16 v[52:55], v[116:119], v[220:223], v[52:55]
    ds_read_b64_tr_b16 v[84:85], v7 offset:53248
    s_waitcnt lgkmcnt(13)
    v_mfma_f32_16x16x32_bf16 v[96:99], v[16:19], v[196:199], v[96:99]
    ds_read_b64_tr_b16 v[86:87], v7 offset:55296
    ds_read_b64_tr_b16 v[204:205], v8 offset:53248
    s_waitcnt lgkmcnt(13)
    v_mfma_f32_16x16x32_bf16 v[40:43], v[72:75], v[144:147], v[40:43]
    ds_read_b64_tr_b16 v[206:207], v8 offset:55296
    v_mfma_f32_16x16x32_bf16 v[44:47], v[72:75], v[224:227], v[44:47]
    ds_read_b64_tr_b16 v[88:89], v12 offset:57344
    s_waitcnt lgkmcnt(13)
    v_mfma_f32_16x16x32_bf16 v[48:51], v[76:79], v[144:147], v[48:51]
    ds_read_b64_tr_b16 v[90:91], v12 offset:59392
    v_mfma_f32_16x16x32_bf16 v[52:55], v[76:79], v[224:227], v[52:55]
    ds_read_b64_tr_b16 v[92:93], v7 offset:57344
    s_waitcnt lgkmcnt(13)
    v_mfma_f32_16x16x32_bf16 v[176:179], v[16:19], v[80:83], v[176:179]
    ds_read_b64_tr_b16 v[94:95], v7 offset:59392
    ds_read_b64_tr_b16 v[108:109], v8 offset:57344
    s_waitcnt lgkmcnt(13)
    v_mfma_f32_16x16x32_bf16 v[40:43], v[200:203], v[148:151], v[40:43]
    ds_read_b64_tr_b16 v[110:111], v8 offset:59392
    v_mfma_f32_16x16x32_bf16 v[44:47], v[200:203], v[228:231], v[44:47]
    ds_read_b64_tr_b16 v[208:209], v9 offset:0
    s_waitcnt lgkmcnt(13)
    v_mfma_f32_16x16x32_bf16 v[48:51], v[104:107], v[148:151], v[48:51]
    ds_read_b64_tr_b16 v[210:211], v9 offset:2048
    v_mfma_f32_16x16x32_bf16 v[52:55], v[104:107], v[228:231], v[52:55]
    ds_read_b64_tr_b16 v[188:189], v5 offset:0
    s_waitcnt lgkmcnt(13)
    v_mfma_f32_16x16x32_bf16 v[96:99], v[16:19], v[184:187], v[96:99]
    ds_read_b64_tr_b16 v[190:191], v5 offset:2048
    ds_read_b64_tr_b16 v[20:21], v6 offset:0
    s_waitcnt lgkmcnt(13)
    v_mfma_f32_16x16x32_bf16 v[40:43], v[84:87], v[152:155], v[40:43]
    ds_read_b64_tr_b16 v[22:23], v6 offset:2048
    v_mfma_f32_16x16x32_bf16 v[44:47], v[84:87], v[232:235], v[44:47]
    ds_read_b64_tr_b16 v[24:25], v10 offset:4096
    s_waitcnt lgkmcnt(13)
    v_mfma_f32_16x16x32_bf16 v[48:51], v[204:207], v[152:155], v[48:51]
    ds_read_b64_tr_b16 v[26:27], v10 offset:6144
    v_mfma_f32_16x16x32_bf16 v[52:55], v[204:207], v[232:235], v[52:55]
    ds_read_b64_tr_b16 v[212:213], v5 offset:4096
    s_waitcnt lgkmcnt(13)
    v_mfma_f32_16x16x32_bf16 v[176:179], v[16:19], v[88:91], v[176:179]
    ds_read_b64_tr_b16 v[214:215], v5 offset:6144
    ds_read_b64_tr_b16 v[112:113], v6 offset:4096
    s_waitcnt lgkmcnt(13)
    v_mfma_f32_16x16x32_bf16 v[40:43], v[92:95], v[156:159], v[40:43]
    ds_read_b64_tr_b16 v[114:115], v6 offset:6144
    v_mfma_f32_16x16x32_bf16 v[44:47], v[92:95], v[236:239], v[44:47]
    ds_read_b64_tr_b16 v[192:193], v9 offset:8192
    s_waitcnt lgkmcnt(13)
    v_mfma_f32_16x16x32_bf16 v[48:51], v[108:111], v[156:159], v[48:51]
    ds_read_b64_tr_b16 v[194:195], v9 offset:10240
    v_mfma_f32_16x16x32_bf16 v[52:55], v[108:111], v[236:239], v[52:55]
    ds_read_b64_tr_b16 v[64:65], v5 offset:8192
    s_waitcnt lgkmcnt(13)
    v_mfma_f32_16x16x32_bf16 v[96:99], v[16:19], v[208:211], v[96:99]
    ds_read_b64_tr_b16 v[66:67], v5 offset:10240
    ds_read_b64_tr_b16 v[216:217], v6 offset:8192
    s_waitcnt lgkmcnt(13)
    v_mfma_f32_16x16x32_bf16 v[40:43], v[188:191], v[160:163], v[40:43]
    ds_read_b64_tr_b16 v[218:219], v6 offset:10240
    v_mfma_f32_16x16x32_bf16 v[44:47], v[188:191], v[240:243], v[44:47]
    ds_read_b64_tr_b16 v[68:69], v10 offset:12288
    s_waitcnt lgkmcnt(13)
    v_mfma_f32_16x16x32_bf16 v[48:51], v[20:23], v[160:163], v[48:51]
    ds_read_b64_tr_b16 v[70:71], v10 offset:14336
    v_mfma_f32_16x16x32_bf16 v[52:55], v[20:23], v[240:243], v[52:55]
    ds_read_b64_tr_b16 v[180:181], v5 offset:12288
    s_waitcnt lgkmcnt(13)
    v_mfma_f32_16x16x32_bf16 v[176:179], v[16:19], v[24:27], v[176:179]
    ds_read_b64_tr_b16 v[182:183], v5 offset:14336
    ds_read_b64_tr_b16 v[116:117], v6 offset:12288
    s_waitcnt lgkmcnt(13)
    v_mfma_f32_16x16x32_bf16 v[40:43], v[212:215], v[164:167], v[40:43]
    ds_read_b64_tr_b16 v[118:119], v6 offset:14336
    v_mfma_f32_16x16x32_bf16 v[44:47], v[212:215], v[244:247], v[44:47]
    s_waitcnt lgkmcnt(12)
    v_mfma_f32_16x16x32_bf16 v[48:51], v[112:115], v[164:167], v[48:51]
    v_mfma_f32_16x16x32_bf16 v[52:55], v[112:115], v[244:247], v[52:55]
    s_waitcnt lgkmcnt(10)
    v_mfma_f32_16x16x32_bf16 v[96:99], v[16:19], v[192:195], v[96:99]
    s_waitcnt lgkmcnt(8)
    v_mfma_f32_16x16x32_bf16 v[40:43], v[64:67], v[168:171], v[40:43]
    v_mfma_f32_16x16x32_bf16 v[44:47], v[64:67], v[248:251], v[44:47]
    s_waitcnt lgkmcnt(6)
    v_mfma_f32_16x16x32_bf16 v[48:51], v[216:219], v[168:171], v[48:51]
    v_mfma_f32_16x16x32_bf16 v[52:55], v[216:219], v[248:251], v[52:55]
    s_waitcnt lgkmcnt(4)
    v_mfma_f32_16x16x32_bf16 v[176:179], v[16:19], v[68:71], v[176:179]
    s_waitcnt lgkmcnt(2)
    v_mfma_f32_16x16x32_bf16 v[40:43], v[180:183], v[172:175], v[40:43]
    v_mfma_f32_16x16x32_bf16 v[44:47], v[180:183], v[252:255], v[44:47]
    s_waitcnt lgkmcnt(0)
    v_mfma_f32_16x16x32_bf16 v[48:51], v[116:119], v[172:175], v[48:51]
    ds_write_b32 v13, v96 offset:4096
    s_nop 1
    ds_write_b32 v14, v176 offset:4160
    s_waitcnt lgkmcnt(0)
    s_barrier
    v_mfma_f32_16x16x32_bf16 v[52:55], v[116:119], v[252:255], v[52:55]
    v_bfe_u32 v4, v0, 4, 4
    v_lshl_add_u32 v1, v4, 2, s56
    v_xor_b32 v2, 64, v1
    v_lshrrev_b32 v3, 8, v0
    s_lshl_b32 s60, s14, 2
    s_add_u32 s60, s60, s59
    v_lshl_add_u32 v3, v3, 4, s60
    v_xor_b32 v4, 128, v3
    s_lshr_b32 s60, s14, 4
    s_add_u32 s60, s60, s91
    s_xor_b32 s61, s60, 2
    v_lshrrev_b32 v10, 9, v0
    v_add_u32 v10, s60, v10
    v_mul_u32_u24 v12, 205, v10
    v_lshrrev_b32 v12, 10, v12
    v_mul_u32_u24 v13, 5, v12
    v_sub_u32 v10, v10, v13
    v_cmp_eq_u32 vcc, 4, v10
    v_and_b32 v13, 3, v12
    s_nop 0
    v_cndmask_b32 v10, v10, v13, vcc
    v_lshrrev_b32 v13, 2, v12
    v_add_u32 v13, 16, v13
    v_cndmask_b32 v12, v12, v13, vcc
    v_and_b32 v13, 0x1f0, v0
    v_lshl_add_u32 v12, v12, 10, v13
    v_and_b32 v13, 1, v10
    v_lshl_add_u32 v12, v13, 9, v12
    v_lshrrev_b32 v10, 1, v10
    v_lshl_add_u32 v10, v10, 3, v12
    v_lshrrev_b32 v11, 9, v0
    v_add_u32 v11, s61, v11
    v_mul_u32_u24 v12, 205, v11
    v_lshrrev_b32 v12, 10, v12
    v_mul_u32_u24 v13, 5, v12
    v_sub_u32 v11, v11, v13
    v_cmp_eq_u32 vcc, 4, v11
    v_and_b32 v13, 3, v12
    s_nop 0
    v_cndmask_b32 v11, v11, v13, vcc
    v_lshrrev_b32 v13, 2, v12
    v_add_u32 v13, 16, v13
    v_cndmask_b32 v12, v12, v13, vcc
    v_and_b32 v13, 0x1f0, v0
    v_lshl_add_u32 v12, v12, 10, v13
    v_and_b32 v13, 1, v11
    v_lshl_add_u32 v12, v13, 9, v12
    v_lshrrev_b32 v11, 1, v11
    v_lshl_add_u32 v11, v11, 3, v12
    ds_read2st64_b32 v[120:121], v1 offset0:0 offset1:2
    ds_read2st64_b32 v[122:123], v2 offset0:0 offset1:2
    ds_read_b128 v[124:127], v3 offset:4096
    ds_read_b128 v[128:131], v3 offset:4160
    ds_read_b128 v[132:135], v4 offset:4096
    ds_read_b128 v[136:139], v4 offset:4160
    s_waitcnt lgkmcnt(2)
    v_add_f32_e64 v124, v124, v128
    v_add_f32_e64 v125, v125, v129
    v_add_f32_e64 v126, v126, v130
    v_add_f32_e64 v127, v127, v131
    v_fma_f32 v140, v124, -v121, s82
    v_fma_f32 v141, v125, -v121, s83
    v_fma_f32 v142, v126, -v121, s82
    v_fma_f32 v143, v127, -v121, s83
    v_fma_f32 v40, v40, v120, v140
    v_fma_f32 v41, v41, v120, v141
    v_fma_f32 v42, v42, v120, v142
    v_fma_f32 v43, v43, v120, v143
    v_exp_f32_e64 v144, v40 clamp
    v_exp_f32_e64 v145, v41 clamp
    v_max_f32 v40, s82, v40
    v_max_f32 v41, s82, v41
    v_fma_f32 v40, v40, s84, v144
    v_fma_f32 v41, v41, s85, v145
    v_exp_f32_e64 v146, v42 clamp
    v_exp_f32_e64 v147, v43 clamp
    v_max_f32 v42, s82, v42
    v_max_f32 v43, s82, v43
    v_fma_f32 v42, v42, s84, v146
    v_fma_f32 v43, v43, s85, v147
    v_cvt_pk_bf16_f32 v40, v40, v41
    v_cvt_pk_bf16_f32 v41, v42, v43
    buffer_store_dwordx2 v[40:41], v10, s[32:35], s96 offen sc1
    v_fma_f32 v140, v124, -v123, s82
    v_fma_f32 v141, v125, -v123, s83
    v_fma_f32 v142, v126, -v123, s82
    v_fma_f32 v143, v127, -v123, s83
    v_fma_f32 v44, v44, v122, v140
    v_fma_f32 v45, v45, v122, v141
    v_fma_f32 v46, v46, v122, v142
    v_fma_f32 v47, v47, v122, v143
    v_exp_f32_e64 v144, v44 clamp
    v_exp_f32_e64 v145, v45 clamp
    v_max_f32 v44, s82, v44
    v_max_f32 v45, s82, v45
    v_fma_f32 v44, v44, s84, v144
    v_fma_f32 v45, v45, s85, v145
    v_exp_f32_e64 v146, v46 clamp
    v_exp_f32_e64 v147, v47 clamp
    v_max_f32 v46, s82, v46
    v_max_f32 v47, s82, v47
    v_fma_f32 v46, v46, s84, v146
    v_fma_f32 v47, v47, s85, v147
    v_cvt_pk_bf16_f32 v44, v44, v45
    v_cvt_pk_bf16_f32 v45, v46, v47
    buffer_store_dwordx2 v[44:45], v10, s[32:35], s97 offen sc1
    s_waitcnt lgkmcnt(0)
    v_add_f32_e64 v132, v132, v136
    v_add_f32_e64 v133, v133, v137
    v_add_f32_e64 v134, v134, v138
    v_add_f32_e64 v135, v135, v139
    v_fma_f32 v140, v132, -v121, s82
    v_fma_f32 v141, v133, -v121, s83
    v_fma_f32 v142, v134, -v121, s82
    v_fma_f32 v143, v135, -v121, s83
    v_fma_f32 v48, v48, v120, v140
    v_fma_f32 v49, v49, v120, v141
    v_fma_f32 v50, v50, v120, v142
    v_fma_f32 v51, v51, v120, v143
    v_exp_f32_e64 v144, v48 clamp
    v_exp_f32_e64 v145, v49 clamp
    v_max_f32 v48, s82, v48
    v_max_f32 v49, s82, v49
    v_fma_f32 v48, v48, s84, v144
    v_fma_f32 v49, v49, s85, v145
    v_exp_f32_e64 v146, v50 clamp
    v_exp_f32_e64 v147, v51 clamp
    v_max_f32 v50, s82, v50
    v_max_f32 v51, s82, v51
    v_fma_f32 v50, v50, s84, v146
    v_fma_f32 v51, v51, s85, v147
    v_cvt_pk_bf16_f32 v48, v48, v49
    v_cvt_pk_bf16_f32 v49, v50, v51
    buffer_store_dwordx2 v[48:49], v11, s[32:35], s96 offen sc1
    v_fma_f32 v140, v132, -v123, s82
    v_fma_f32 v141, v133, -v123, s83
    v_fma_f32 v142, v134, -v123, s82
    v_fma_f32 v143, v135, -v123, s83
    v_fma_f32 v52, v52, v122, v140
    v_fma_f32 v53, v53, v122, v141
    v_fma_f32 v54, v54, v122, v142
    v_fma_f32 v55, v55, v122, v143
    v_exp_f32_e64 v144, v52 clamp
    v_exp_f32_e64 v145, v53 clamp
    v_max_f32 v52, s82, v52
    v_max_f32 v53, s82, v53
    v_fma_f32 v52, v52, s84, v144
    v_fma_f32 v53, v53, s85, v145
    v_exp_f32_e64 v146, v54 clamp
    v_exp_f32_e64 v147, v55 clamp
    v_max_f32 v54, s82, v54
    v_max_f32 v55, s82, v55
    v_fma_f32 v54, v54, s84, v146
    v_fma_f32 v55, v55, s85, v147
    v_cvt_pk_bf16_f32 v52, v52, v53
    v_cvt_pk_bf16_f32 v53, v54, v55
    buffer_store_dwordx2 v[52:53], v11, s[32:35], s97 offen sc1
    s_endpgm
K1_ZF:
    s_mov_b32 s45, s42
    buffer_store_dwordx4 v[248:251], v0, s[92:95], s45 offen offset:0 sc1
    buffer_store_dwordx4 v[248:251], v0, s[92:95], s45 offen offset:1024 sc1
    buffer_store_dwordx4 v[248:251], v0, s[92:95], s45 offen offset:2048 sc1
    buffer_store_dwordx4 v[248:251], v0, s[92:95], s45 offen offset:3072 sc1
    s_add_u32 s45, s45, 4096
    buffer_store_dwordx4 v[248:251], v0, s[92:95], s45 offen offset:0 sc1
    buffer_store_dwordx4 v[248:251], v0, s[92:95], s45 offen offset:1024 sc1
    buffer_store_dwordx4 v[248:251], v0, s[92:95], s45 offen offset:2048 sc1
    s_branch K1_ZFR
K1_ZG:
    v_mov_b32 v252, 1
    s_mov_b64 exec, 1
    buffer_store_dword v252, off, s[36:39], s77 offset:4 sc1
    s_mov_b64 exec, -1
    s_branch K1_ZGR
K1_ZP0:
    s_mov_b32 s61, 0x10000
    s_lshl_b32 s45, s48, 4
K1_ZQ0:
    s_sleep 8
    buffer_load_dword v12, off, s[36:39], s45 offset:4 sc1
    s_waitcnt vmcnt(0)
    v_readfirstlane_b32 s60, v12
    s_sub_u32 s61, s61, 1
    s_cselect_b32 s60, 1, s60
    s_cmp_eq_u32 s60, 0
    s_cbranch_scc1 K1_ZQ0
    s_branch K1_ZPR0
K1_ZP1:
    s_mov_b32 s61, 0x10000
    s_lshl_b32 s45, s48, 4
K1_ZQ1:
    s_sleep 8
    buffer_load_dword v35, off, s[36:39], s45 offset:4 sc1
    s_waitcnt vmcnt(0)
    v_readfirstlane_b32 s60, v35
    s_sub_u32 s61, s61, 1
    s_cselect_b32 s60, 1, s60
    s_cmp_eq_u32 s60, 0
    s_cbranch_scc1 K1_ZQ1
    s_branch K1_ZPR1
K1_G:
    s_mov_b32 s41, s96
    s_mov_b32 s42, s97
    s_add_u32 m0, s47, 16384
    s_mov_b32 s45, 128
    buffer_load_dwordx4 v10, s[20:23], s45 offen lds
    s_add_u32 m0, s47, 17408
    s_mov_b32 s45, 10368
    buffer_load_dwordx4 v10, s[20:23], s45 offen lds
    s_add_u32 m0, s44, 86016
    s_mov_b32 s45, 196608
    buffer_load_dwordx4 v13, s[28:31], s45 offen lds
    s_add_u32 m0, s44, 94208
    s_mov_b32 s45, 196736
    buffer_load_dwordx4 v13, s[28:31], s45 offen lds
    s_add_u32 m0, s46, 20480
    s_mov_b32 s45, 245760
    s_mov_b64 exec, 0xffff
    buffer_load_dwordx4 v12, s[24:27], s45 offen lds
    s_mov_b64 exec, -1
    v_lshrrev_b32 v240, 4, v0
    s_and_b32 s60, s49, 15
    s_lshl_b32 s60, s60, 2
    s_add_u32 s60, s60, s50
    s_cmp_eq_u32 s51, 1
    s_cbranch_scc1 K1_G_PS1
    s_lshl_b32 s61, s48, 4
    s_lshl_b32 s45, s49, 7
    s_add_u32 s61, s61, s45
    s_lshl_b32 s45, s50, 1
    s_add_u32 s61, s61, s45
    s_add_u32 s61, s61, 8
    v_bfe_u32 v241, v240, 2, 1
    v_add_u32 v241, s61, v241
    v_mul_u32_u24 v241, 1280, v241
    v_and_b32 v242, 3, v240
    v_lshl_add_u32 v241, v242, 7, v241
    s_lshl_b32 s61, s60, 2
    s_lshl_b32 s45, s48, 5
    s_add_u32 s45, s45, 1024
    v_and_b32 v244, 3, v240
    v_add_u32 v244, s61, v244
    v_mul_u32_u24 v244, 3840, v244
    v_add_u32 v244, s45, v244
    s_branch K1_G_PSE
K1_G_PS1:
    s_lshl_b32 s61, s60, 2
    v_bfe_u32 v241, v240, 2, 2
    v_add_u32 v241, s61, v241
    v_mul_u32_u24 v241, 3072, v241
    s_mul_i32 s45, s48, 384
    v_and_b32 v242, 3, v240
    v_min_u32 v242, 2, v242
    v_lshl_add_u32 v241, v242, 7, v241
    v_add_u32 v241, s45, v241
    s_mul_i32 s61, s60, 2
    v_min_u32 v244, 1, v240
    v_add_u32 v244, s61, v244
    v_mul_u32_u24 v244, 3072, v244
    v_add_u32 v244, s45, v244
K1_G_PSE:
    s_waitcnt vmcnt(5)
    v_lshlrev_b32 v60, 16, v60
    v_mul_f32 v60, 0x3eeff558, v60
    v_lshl_add_u32 v61, v61, 1, s59
    ds_write_b32 v61, v60 offset:4608
    s_cmp_eq_u32 s51, 1
    s_cselect_b64 vcc, -1, 0
    s_waitcnt lgkmcnt(0)
    s_barrier
    s_cbranch_vccz K1_G_P0
    s_setprio 1
K1_G_P0:
    ds_read_b128 v[96:99], v1 offset:0
    ds_read_b128 v[176:179], v3 offset:0
    ds_read_b64_tr_b16 v[36:37], v5 offset:0
    ds_read_b64_tr_b16 v[38:39], v5 offset:2048
    ds_read_b64_tr_b16 v[40:41], v6 offset:0
    ds_read_b64_tr_b16 v[42:43], v6 offset:512
    ds_read_b64_tr_b16 v[44:45], v7 offset:0
    ds_read_b64_tr_b16 v[46:47], v7 offset:2048
    ds_read_b64_tr_b16 v[48:49], v8 offset:0
    ds_read_b64_tr_b16 v[50:51], v8 offset:2048
    ds_read_b64_tr_b16 v[52:53], v9 offset:0
    ds_read_b64_tr_b16 v[54:55], v9 offset:2048
    s_waitcnt lgkmcnt(11)
    s_waitcnt lgkmcnt(10)
    s_waitcnt lgkmcnt(8)
    v_mfma_f32_16x16x32_bf16 v[56:59], v[36:39], v[96:99], 0
    ds_read_b128 v[100:103], v2 offset:0
    v_mfma_f32_16x16x32_bf16 v[60:63], v[36:39], v[176:179], 0
    ds_read_b128 v[180:183], v4 offset:0
    s_mov_b64 exec, 0xffff
    s_cbranch_vccnz K1_G_PB0
    buffer_load_dword v243, v241, s[20:23], 0 offen offset:384
    s_mov_b32 s45, 737280
    buffer_load_dword v245, v244, s[24:27], s45 offen
    s_branch K1_G_PC0
K1_G_PB0:
    s_mov_b32 s45, 589824
    buffer_load_dword v243, v241, s[28:31], s45 offen
    s_mov_b32 s45, 0
    buffer_load_dword v245, v244, s[28:31], s45 offen offset:256
K1_G_PC0:
    s_mov_b64 exec, -1
    v_mfma_f32_16x16x32_bf16 v[20:23], v[16:19], v[36:39], 0
    s_waitcnt lgkmcnt(8)
    v_mfma_f32_16x16x32_bf16 v[64:67], v[40:43], v[96:99], 0
    ds_read_b64_tr_b16 v[36:37], v5 offset:4096
    s_add_u32 m0, s47, 32768
    s_mov_b32 s45, 256
    buffer_load_dwordx4 v10, s[20:23], s45 offen lds
    s_cmp_lg_u32 s15, 0
    s_cbranch_scc1 K1_G_C0
    v_mfma_f32_16x16x32_bf16 v[24:27], v[16:19], v[40:43], 0
K1_G_C0:
    s_waitcnt lgkmcnt(7)
    v_mfma_f32_16x16x32_bf16 v[72:75], v[44:47], v[96:99], 0
    ds_read_b64_tr_b16 v[38:39], v5 offset:6144
    v_mfma_f32_16x16x32_bf16 v[76:79], v[44:47], v[176:179], 0
    ds_read_b64_tr_b16 v[40:41], v6 offset:1024
    s_add_u32 m0, s47, 33792
    s_mov_b32 s45, 10496
    buffer_load_dwordx4 v10, s[20:23], s45 offen lds
    s_waitcnt lgkmcnt(7)
    v_mfma_f32_16x16x32_bf16 v[80:83], v[48:51], v[96:99], 0
    ds_read_b64_tr_b16 v[42:43], v6 offset:1536
    v_mfma_f32_16x16x32_bf16 v[84:87], v[48:51], v[176:179], 0
    ds_read_b64_tr_b16 v[44:45], v7 offset:4096
    s_add_u32 m0, s44, 106496
    s_mov_b32 s45, 393216
    buffer_load_dwordx4 v13, s[28:31], s45 offen lds
    s_waitcnt lgkmcnt(7)
    v_mfma_f32_16x16x32_bf16 v[88:91], v[52:55], v[96:99], 0
    ds_read_b64_tr_b16 v[46:47], v7 offset:6144
    v_mfma_f32_16x16x32_bf16 v[92:95], v[52:55], v[176:179], 0
    ds_read_b64_tr_b16 v[48:49], v8 offset:4096
    s_add_u32 m0, s44, 114688
    s_mov_b32 s45, 393344
    buffer_load_dwordx4 v13, s[28:31], s45 offen lds
    v_mfma_f32_16x16x32_bf16 v[28:31], v[96:99], v[96:99], 0
    ds_read_b64_tr_b16 v[50:51], v8 offset:6144
    v_mfma_f32_16x16x32_bf16 v[32:35], v[96:99], v[16:19], 0
    ds_read_b64_tr_b16 v[52:53], v9 offset:4096
    s_add_u32 m0, s46, 40960
    s_mov_b32 s45, 491520
    s_mov_b64 exec, 0xffff
    buffer_load_dwordx4 v12, s[24:27], s45 offen lds
    s_mov_b64 exec, -1
    s_waitcnt lgkmcnt(10)
    s_waitcnt lgkmcnt(9)
    s_waitcnt lgkmcnt(7)
    v_mfma_f32_16x16x32_bf16 v[56:59], v[36:39], v[100:103], v[56:59]
    ds_read_b64_tr_b16 v[54:55], v9 offset:6144
    s_lshl_b32 s60, s40, 7
    s_and_b32 s61, s2, 127
    s_setprio 0
    v_mfma_f32_16x16x32_bf16 v[60:63], v[36:39], v[180:183], v[60:63]
    s_add_u32 m0, s47, 49152
    s_mov_b32 s45, 384
    buffer_load_dwordx4 v10, s[20:23], s45 offen lds
    s_add_u32 s60, s60, s61
    s_mul_i32 s61, s60, 6554
    v_mfma_f32_16x16x32_bf16 v[20:23], v[16:19], v[36:39], v[20:23]
    s_lshr_b32 s61, s61, 16
    s_mul_i32 s62, s61, 10
    s_waitcnt lgkmcnt(6)
    v_mfma_f32_16x16x32_bf16 v[64:67], v[40:43], v[100:103], v[64:67]
    s_add_u32 m0, s47, 50176
    s_mov_b32 s45, 10624
    buffer_load_dwordx4 v10, s[20:23], s45 offen lds
    s_sub_u32 s62, s60, s62
    s_lshl_b32 s3, s61, 5
    s_cmp_lg_u32 s15, 1
    s_cbranch_scc1 K1_G_C1
    v_mfma_f32_16x16x32_bf16 v[24:27], v[16:19], v[40:43], 0
K1_G_C1:
    s_add_u32 m0, s44, 126976
    s_mov_b32 s45, 589824
    buffer_load_dwordx4 v13, s[28:31], s45 offen lds
    s_add_u32 m0, s44, 135168
    s_mov_b32 s45, 589952
    buffer_load_dwordx4 v13, s[28:31], s45 offen lds
    s_add_u32 m0, s46, 61440
    s_mov_b32 s45, 737280
    s_mov_b64 exec, 0xffff
    buffer_load_dwordx4 v12, s[24:27], s45 offen lds
    s_mov_b64 exec, -1
    s_waitcnt vmcnt(12)
    s_waitcnt lgkmcnt(0)
    s_barrier
    s_cbranch_vccz K1_G_P1
    s_setprio 1
K1_G_P1:
    v_mfma_f32_16x16x32_bf16 v[72:75], v[44:47], v[100:103], v[72:75]
    ds_read_b64_tr_b16 v[36:37], v5 offset:20480
    ds_read_b64_tr_b16 v[38:39], v5 offset:22528
    s_sub_u32 s63, s61, 48
    s_mul_i32 s18, s63, 40
    v_mfma_f32_16x16x32_bf16 v[76:79], v[44:47], v[180:183], v[76:79]
    ds_read_b128 v[104:107], v1 offset:16384
    s_cmp_lt_u32 s61, 48
    s_cselect_b32 s64, s64, s88
    s_cselect_b32 s65, s65, s89
    s_cselect_b32 s66, s66, s90
    s_cselect_b32 s3, s3, s18
    s_mul_i32 s18, s63, 160
    v_mfma_f32_16x16x32_bf16 v[80:83], v[48:51], v[100:103], v[80:83]
    ds_read_b128 v[184:187], v3 offset:16384
    ds_read_b64_tr_b16 v[40:41], v6 offset:20480
    s_sub_u32 s18, s18, 2528
    s_cmp_lt_u32 s61, 64
    s_cselect_b32 s3, s3, s18
    s_mov_b32 s88, 10240
    s_cselect_b32 s88, s88, 51200
    v_mfma_f32_16x16x32_bf16 v[84:87], v[48:51], v[180:183], v[84:87]
    ds_read_b64_tr_b16 v[42:43], v6 offset:20992
    s_mul_i32 s3, s3, 1280
    s_lshl_b32 s18, s62, 7
    v_mfma_f32_16x16x32_bf16 v[88:91], v[52:55], v[100:103], v[88:91]
    ds_read_b64_tr_b16 v[44:45], v7 offset:20480
    s_mov_b64 exec, 0xffff
    s_cbranch_vccnz K1_G_PB1
    buffer_load_dword v243, v241, s[20:23], 0 offen offset:768
    s_mov_b32 s45, 1474560
    buffer_load_dword v245, v244, s[24:27], s45 offen
    s_branch K1_G_PC1
K1_G_PB1:
    s_mov_b32 s45, 1179648
    buffer_load_dword v243, v241, s[28:31], s45 offen
    s_mov_b32 s45, 294912
    buffer_load_dword v245, v244, s[28:31], s45 offen offset:256
K1_G_PC1:
    s_mov_b64 exec, -1
    s_add_u32 s3, s3, s18
    s_cmp_lt_u32 s61, 68
    s_cselect_b32 s3, s3, 0x70000000
    s_cselect_b32 s89, 0, 0x1c0000
    v_mfma_f32_16x16x32_bf16 v[92:95], v[52:55], v[180:183], v[92:95]
    ds_read_b64_tr_b16 v[46:47], v7 offset:22528
    s_lshr_b32 s18, s63, 2
    s_add_u32 s18, s18, s63
    v_mfma_f32_16x16x32_bf16 v[28:31], v[100:103], v[100:103], v[28:31]
    ds_read_b64_tr_b16 v[48:49], v8 offset:20480
    s_mul_i32 s60, s63, 5
    s_sub_u32 s60, s60, 76
    v_mfma_f32_16x16x32_bf16 v[32:35], v[100:103], v[16:19], v[32:35]
    ds_read_b64_tr_b16 v[50:51], v8 offset:22528
    s_cmp_lt_u32 s61, 64
    s_cselect_b32 s18, s18, s60
    s_add_u32 s60, s61, 20
    s_waitcnt lgkmcnt(7)
    s_waitcnt lgkmcnt(6)
    v_mfma_f32_16x16x32_bf16 v[56:59], v[36:39], v[104:107], v[56:59]
    ds_read_b64_tr_b16 v[52:53], v9 offset:20480
    s_cmp_lt_u32 s61, 48
    s_cselect_b32 s61, s60, s18
    s_mul_i32 s61, s61, 5
    v_mfma_f32_16x16x32_bf16 v[60:63], v[36:39], v[184:187], v[60:63]
    ds_read_b64_tr_b16 v[54:55], v9 offset:22528
    s_add_u32 m0, s47, 0
    s_mov_b32 s45, 512
    buffer_load_dwordx4 v10, s[20:23], s45 offen lds
    s_add_u32 s89, s89, s61
    s_lshl_b32 s90, s62, 2
    v_mfma_f32_16x16x32_bf16 v[20:23], v[16:19], v[36:39], v[20:23]
    ds_read_b128 v[108:111], v2 offset:16384
    s_add_u32 s60, s90, 0
    s_mul_i32 s61, s60, 205
    s_waitcnt lgkmcnt(7)
    v_mfma_f32_16x16x32_bf16 v[64:67], v[40:43], v[104:107], v[64:67]
    ds_read_b128 v[188:191], v4 offset:16384
    s_lshr_b32 s61, s61, 10
    s_mul_i32 s62, s61, 5
    s_cmp_lg_u32 s15, 2
    s_cbranch_scc1 K1_G_C2
    v_mfma_f32_16x16x32_bf16 v[24:27], v[16:19], v[40:43], 0
K1_G_C2:
    s_waitcnt lgkmcnt(6)
    v_mfma_f32_16x16x32_bf16 v[72:75], v[44:47], v[104:107], v[72:75]
    ds_read_b64_tr_b16 v[36:37], v5 offset:24576
    s_sub_u32 s60, s60, s62
    s_and_b32 s62, s61, 1
    s_setprio 0
    v_mfma_f32_16x16x32_bf16 v[76:79], v[44:47], v[184:187], v[76:79]
    ds_read_b64_tr_b16 v[38:39], v5 offset:26624
    s_sub_u32 s60, s60, s62
    s_cselect_b32 s60, 4, s60
    s_mul_i32 s61, s61, 340
    s_waitcnt lgkmcnt(6)
    v_mfma_f32_16x16x32_bf16 v[80:83], v[48:51], v[104:107], v[80:83]
    ds_read_b64_tr_b16 v[40:41], v6 offset:21504
    s_add_u32 m0, s47, 1024
    s_mov_b32 s45, 10752
    buffer_load_dwordx4 v10, s[20:23], s45 offen lds
    s_add_u32 s60, s60, s61
    s_add_u32 s60, s60, s89
    v_mfma_f32_16x16x32_bf16 v[84:87], v[48:51], v[184:187], v[84:87]
    ds_read_b64_tr_b16 v[42:43], v6 offset:22016
    s_lshl_b32 s36, s60, 10
    s_add_u32 s60, s90, 1
    s_waitcnt lgkmcnt(6)
    v_mfma_f32_16x16x32_bf16 v[88:91], v[52:55], v[104:107], v[88:91]
    ds_read_b64_tr_b16 v[44:45], v7 offset:24576
    s_mul_i32 s61, s60, 205
    s_lshr_b32 s61, s61, 10
    v_mfma_f32_16x16x32_bf16 v[92:95], v[52:55], v[184:187], v[92:95]
    ds_read_b64_tr_b16 v[46:47], v7 offset:26624
    s_mul_i32 s62, s61, 5
    s_sub_u32 s60, s60, s62
    v_mfma_f32_16x16x32_bf16 v[28:31], v[104:107], v[104:107], v[28:31]
    ds_read_b64_tr_b16 v[48:49], v8 offset:24576
    s_and_b32 s62, s61, 1
    s_sub_u32 s60, s60, s62
    s_cselect_b32 s60, 4, s60
    v_mfma_f32_16x16x32_bf16 v[32:35], v[104:107], v[16:19], v[32:35]
    ds_read_b64_tr_b16 v[50:51], v8 offset:26624
    s_add_u32 m0, s44, 65536
    s_mov_b32 s45, 786432
    buffer_load_dwordx4 v13, s[28:31], s45 offen lds
    s_mul_i32 s61, s61, 340
    s_add_u32 s60, s60, s61
    s_waitcnt lgkmcnt(9)
    s_waitcnt lgkmcnt(8)
    s_waitcnt lgkmcnt(6)
    v_mfma_f32_16x16x32_bf16 v[56:59], v[36:39], v[108:111], v[56:59]
    ds_read_b64_tr_b16 v[52:53], v9 offset:24576
    s_add_u32 s60, s60, s89
    s_lshl_b32 s37, s60, 10
    v_mfma_f32_16x16x32_bf16 v[60:63], v[36:39], v[188:191], v[60:63]
    ds_read_b64_tr_b16 v[54:55], v9 offset:26624
    s_add_u32 s60, s90, 2
    s_mul_i32 s61, s60, 205
    v_mfma_f32_16x16x32_bf16 v[20:23], v[16:19], v[36:39], v[20:23]
    s_lshr_b32 s61, s61, 10
    s_mul_i32 s62, s61, 5
    s_waitcnt lgkmcnt(6)
    v_mfma_f32_16x16x32_bf16 v[64:67], v[40:43], v[108:111], v[64:67]
    s_sub_u32 s60, s60, s62
    s_and_b32 s62, s61, 1
    s_cmp_lg_u32 s15, 3
    s_cbranch_scc1 K1_G_C3
    v_mfma_f32_16x16x32_bf16 v[24:27], v[16:19], v[40:43], 0
K1_G_C3:
    s_add_u32 m0, s44, 73728
    s_mov_b32 s45, 786560
    buffer_load_dwordx4 v13, s[28:31], s45 offen lds
    s_add_u32 m0, s46, 0
    s_mov_b32 s45, 983040
    s_mov_b64 exec, 0xffff
    buffer_load_dwordx4 v12, s[24:27], s45 offen lds
    s_mov_b64 exec, -1
    s_waitcnt vmcnt(12)
    s_waitcnt lgkmcnt(0)
    s_barrier
    s_cbranch_vccz K1_G_P2
    s_setprio 1
K1_G_P2:
    v_add_u32 v5, 0xa000, v5
    v_add_u32 v6, 0xa000, v6
    v_add_u32 v7, 0xa000, v7
    v_add_u32 v8, 0xa000, v8
    v_add_u32 v9, 0xa000, v9
    v_mfma_f32_16x16x32_bf16 v[72:75], v[44:47], v[108:111], v[72:75]
    ds_read_b64_tr_b16 v[36:37], v5 offset:0
    ds_read_b64_tr_b16 v[38:39], v5 offset:2048
    s_sub_u32 s60, s60, s62
    s_cselect_b32 s60, 4, s60
    s_mul_i32 s61, s61, 340
    v_mfma_f32_16x16x32_bf16 v[76:79], v[44:47], v[188:191], v[76:79]
    ds_read_b128 v[112:115], v1 offset:32768
    s_add_u32 s60, s60, s61
    s_add_u32 s60, s60, s89
    v_mfma_f32_16x16x32_bf16 v[80:83], v[48:51], v[108:111], v[80:83]
    ds_read_b128 v[192:195], v3 offset:32768
    ds_read_b64_tr_b16 v[40:41], v6 offset:0
    s_lshl_b32 s38, s60, 10
    s_add_u32 s60, s90, 3
    v_mfma_f32_16x16x32_bf16 v[84:87], v[48:51], v[188:191], v[84:87]
    ds_read_b64_tr_b16 v[42:43], v6 offset:512
    s_mul_i32 s61, s60, 205
    s_lshr_b32 s61, s61, 10
    v_mfma_f32_16x16x32_bf16 v[88:91], v[52:55], v[108:111], v[88:91]
    ds_read_b64_tr_b16 v[44:45], v7 offset:0
    s_add_u32 m0, s47, 16384
    s_mov_b32 s45, 640
    buffer_load_dwordx4 v10, s[20:23], s45 offen lds
    s_mul_i32 s62, s61, 5
    s_sub_u32 s60, s60, s62
    v_mfma_f32_16x16x32_bf16 v[92:95], v[52:55], v[188:191], v[92:95]
    ds_read_b64_tr_b16 v[46:47], v7 offset:2048
    s_and_b32 s62, s61, 1
    s_sub_u32 s60, s60, s62
    s_cselect_b32 s60, 4, s60
    v_mfma_f32_16x16x32_bf16 v[28:31], v[108:111], v[108:111], v[28:31]
    ds_read_b64_tr_b16 v[48:49], v8 offset:0
    s_mul_i32 s61, s61, 340
    s_add_u32 s60, s60, s61
    v_mfma_f32_16x16x32_bf16 v[32:35], v[108:111], v[16:19], v[32:35]
    ds_read_b64_tr_b16 v[50:51], v8 offset:2048
    s_add_u32 s60, s60, s89
    s_lshl_b32 s39, s60, 10
    s_waitcnt lgkmcnt(7)
    s_waitcnt lgkmcnt(6)
    v_mfma_f32_16x16x32_bf16 v[56:59], v[36:39], v[112:115], v[56:59]
    ds_read_b64_tr_b16 v[52:53], v9 offset:0
    s_add_u32 s92, s16, 0x1400000
    s_addc_u32 s93, s17, 0
    s_mov_b32 s94, 0x2a0000
    v_mfma_f32_16x16x32_bf16 v[60:63], v[36:39], v[192:195], v[60:63]
    ds_read_b64_tr_b16 v[54:55], v9 offset:2048
    s_add_u32 m0, s47, 17408
    s_mov_b32 s45, 10880
    buffer_load_dwordx4 v10, s[20:23], s45 offen lds
    s_mov_b32 s95, 0x00020000
    s_lshl_b32 s10, s2, 3
    v_mfma_f32_16x16x32_bf16 v[20:23], v[16:19], v[36:39], v[20:23]
    ds_read_b128 v[116:119], v2 offset:32768
    s_add_u32 s10, s10, s40
    s_mul_i32 s10, s10, 1344
    s_waitcnt lgkmcnt(7)
    v_mfma_f32_16x16x32_bf16 v[64:67], v[40:43], v[112:115], v[64:67]
    ds_read_b128 v[196:199], v4 offset:32768
    s_cmp_lg_u32 s15, 0
    s_cbranch_scc1 K1_G_C4
    v_mfma_f32_16x16x32_bf16 v[24:27], v[16:19], v[40:43], v[24:27]
K1_G_C4:
    s_waitcnt lgkmcnt(6)
    v_mfma_f32_16x16x32_bf16 v[72:75], v[44:47], v[112:115], v[72:75]
    ds_read_b64_tr_b16 v[36:37], v5 offset:4096
    s_setprio 0
    v_mfma_f32_16x16x32_bf16 v[76:79], v[44:47], v[192:195], v[76:79]
    ds_read_b64_tr_b16 v[38:39], v5 offset:6144
    s_waitcnt lgkmcnt(6)
    v_mfma_f32_16x16x32_bf16 v[80:83], v[48:51], v[112:115], v[80:83]
    ds_read_b64_tr_b16 v[40:41], v6 offset:1024
    s_add_u32 m0, s44, 86016
    s_mov_b32 s45, 983040
    buffer_load_dwordx4 v13, s[28:31], s45 offen lds
    v_mfma_f32_16x16x32_bf16 v[84:87], v[48:51], v[192:195], v[84:87]
    ds_read_b64_tr_b16 v[42:43], v6 offset:1536
    s_waitcnt lgkmcnt(6)
    v_mfma_f32_16x16x32_bf16 v[88:91], v[52:55], v[112:115], v[88:91]
    ds_read_b64_tr_b16 v[44:45], v7 offset:4096
    v_mfma_f32_16x16x32_bf16 v[92:95], v[52:55], v[192:195], v[92:95]
    ds_read_b64_tr_b16 v[46:47], v7 offset:6144
    v_mfma_f32_16x16x32_bf16 v[28:31], v[112:115], v[112:115], v[28:31]
    ds_read_b64_tr_b16 v[48:49], v8 offset:4096
    v_mfma_f32_16x16x32_bf16 v[32:35], v[112:115], v[16:19], v[32:35]
    ds_read_b64_tr_b16 v[50:51], v8 offset:6144
    s_add_u32 m0, s44, 94208
    s_mov_b32 s45, 983168
    buffer_load_dwordx4 v13, s[28:31], s45 offen lds
    s_waitcnt lgkmcnt(9)
    s_waitcnt lgkmcnt(8)
    s_waitcnt lgkmcnt(6)
    v_mfma_f32_16x16x32_bf16 v[56:59], v[36:39], v[116:119], v[56:59]
    ds_read_b64_tr_b16 v[52:53], v9 offset:4096
    v_mfma_f32_16x16x32_bf16 v[60:63], v[36:39], v[196:199], v[60:63]
    ds_read_b64_tr_b16 v[54:55], v9 offset:6144
    v_mfma_f32_16x16x32_bf16 v[20:23], v[16:19], v[36:39], v[20:23]
    s_waitcnt lgkmcnt(6)
    v_mfma_f32_16x16x32_bf16 v[64:67], v[40:43], v[116:119], v[64:67]
    s_cmp_lg_u32 s15, 1
    s_cbranch_scc1 K1_G_C5
    v_mfma_f32_16x16x32_bf16 v[24:27], v[16:19], v[40:43], v[24:27]
K1_G_C5:
    s_add_u32 m0, s46, 20480
    s_mov_b32 s45, 1228800
    s_mov_b64 exec, 0xffff
    buffer_load_dwordx4 v12, s[24:27], s45 offen lds
    s_mov_b64 exec, -1
    s_waitcnt vmcnt(12)
    s_waitcnt lgkmcnt(0)
    s_barrier
    s_cbranch_vccz K1_G_P3
    s_setprio 1
K1_G_P3:
    v_mfma_f32_16x16x32_bf16 v[72:75], v[44:47], v[116:119], v[72:75]
    ds_read_b64_tr_b16 v[36:37], v5 offset:20480
    ds_read_b64_tr_b16 v[38:39], v5 offset:22528
    v_mfma_f32_16x16x32_bf16 v[76:79], v[44:47], v[196:199], v[76:79]
    ds_read_b128 v[120:123], v1 offset:49152
    v_mfma_f32_16x16x32_bf16 v[80:83], v[48:51], v[116:119], v[80:83]
    ds_read_b128 v[200:203], v3 offset:49152
    ds_read_b64_tr_b16 v[40:41], v6 offset:20480
    v_mfma_f32_16x16x32_bf16 v[84:87], v[48:51], v[196:199], v[84:87]
    ds_read_b64_tr_b16 v[42:43], v6 offset:20992
    v_mfma_f32_16x16x32_bf16 v[88:91], v[52:55], v[116:119], v[88:91]
    ds_read_b64_tr_b16 v[44:45], v7 offset:20480
    s_add_u32 m0, s47, 32768
    s_mov_b32 s45, 768
    buffer_load_dwordx4 v10, s[20:23], s45 offen lds
    v_mfma_f32_16x16x32_bf16 v[92:95], v[52:55], v[196:199], v[92:95]
    ds_read_b64_tr_b16 v[46:47], v7 offset:22528
    v_mfma_f32_16x16x32_bf16 v[28:31], v[116:119], v[116:119], v[28:31]
    ds_read_b64_tr_b16 v[48:49], v8 offset:20480
    v_mfma_f32_16x16x32_bf16 v[32:35], v[116:119], v[16:19], v[32:35]
    ds_read_b64_tr_b16 v[50:51], v8 offset:22528
    s_waitcnt lgkmcnt(7)
    s_waitcnt lgkmcnt(6)
    v_mfma_f32_16x16x32_bf16 v[56:59], v[36:39], v[120:123], v[56:59]
    ds_read_b64_tr_b16 v[52:53], v9 offset:20480
    v_mfma_f32_16x16x32_bf16 v[60:63], v[36:39], v[200:203], v[60:63]
    ds_read_b64_tr_b16 v[54:55], v9 offset:22528
    s_add_u32 m0, s47, 33792
    s_mov_b32 s45, 11008
    buffer_load_dwordx4 v10, s[20:23], s45 offen lds
    v_mfma_f32_16x16x32_bf16 v[20:23], v[16:19], v[36:39], v[20:23]
    ds_read_b128 v[124:127], v2 offset:49152
    s_waitcnt lgkmcnt(7)
    v_mfma_f32_16x16x32_bf16 v[64:67], v[40:43], v[120:123], v[64:67]
    ds_read_b128 v[204:207], v4 offset:49152
    s_cmp_lg_u32 s15, 2
    s_cbranch_scc1 K1_G_C6
    v_mfma_f32_16x16x32_bf16 v[24:27], v[16:19], v[40:43], v[24:27]
K1_G_C6:
    s_waitcnt lgkmcnt(6)
    v_mfma_f32_16x16x32_bf16 v[72:75], v[44:47], v[120:123], v[72:75]
    ds_read_b64_tr_b16 v[36:37], v5 offset:24576
    s_setprio 0
    v_mfma_f32_16x16x32_bf16 v[76:79], v[44:47], v[200:203], v[76:79]
    ds_read_b64_tr_b16 v[38:39], v5 offset:26624
    s_waitcnt lgkmcnt(6)
    v_mfma_f32_16x16x32_bf16 v[80:83], v[48:51], v[120:123], v[80:83]
    ds_read_b64_tr_b16 v[40:41], v6 offset:21504
    s_add_u32 m0, s44, 106496
    s_mov_b32 s45, 1179648
    buffer_load_dwordx4 v13, s[28:31], s45 offen lds
    v_mfma_f32_16x16x32_bf16 v[84:87], v[48:51], v[200:203], v[84:87]
    ds_read_b64_tr_b16 v[42:43], v6 offset:22016
    s_waitcnt lgkmcnt(6)
    v_mfma_f32_16x16x32_bf16 v[88:91], v[52:55], v[120:123], v[88:91]
    ds_read_b64_tr_b16 v[44:45], v7 offset:24576
    v_mfma_f32_16x16x32_bf16 v[92:95], v[52:55], v[200:203], v[92:95]
    ds_read_b64_tr_b16 v[46:47], v7 offset:26624
    v_mfma_f32_16x16x32_bf16 v[28:31], v[120:123], v[120:123], v[28:31]
    ds_read_b64_tr_b16 v[48:49], v8 offset:24576
    v_mfma_f32_16x16x32_bf16 v[32:35], v[120:123], v[16:19], v[32:35]
    ds_read_b64_tr_b16 v[50:51], v8 offset:26624
    s_add_u32 m0, s44, 114688
    s_mov_b32 s45, 1179776
    buffer_load_dwordx4 v13, s[28:31], s45 offen lds
    s_waitcnt lgkmcnt(9)
    s_waitcnt lgkmcnt(8)
    s_waitcnt lgkmcnt(6)
    v_mfma_f32_16x16x32_bf16 v[56:59], v[36:39], v[124:127], v[56:59]
    ds_read_b64_tr_b16 v[52:53], v9 offset:24576
    v_mfma_f32_16x16x32_bf16 v[60:63], v[36:39], v[204:207], v[60:63]
    ds_read_b64_tr_b16 v[54:55], v9 offset:26624
    v_mfma_f32_16x16x32_bf16 v[20:23], v[16:19], v[36:39], v[20:23]
    s_waitcnt lgkmcnt(6)
    v_mfma_f32_16x16x32_bf16 v[64:67], v[40:43], v[124:127], v[64:67]
    s_cmp_lg_u32 s15, 3
    s_cbranch_scc1 K1_G_C7
    v_mfma_f32_16x16x32_bf16 v[24:27], v[16:19], v[40:43], v[24:27]
K1_G_C7:
    s_add_u32 m0, s46, 40960
    s_mov_b32 s45, 1474560
    s_mov_b64 exec, 0xffff
    buffer_load_dwordx4 v12, s[24:27], s45 offen lds
    s_mov_b64 exec, -1
    s_waitcnt vmcnt(10)
    s_waitcnt lgkmcnt(0)
    s_barrier
    s_cbranch_vccz K1_G_P4
    s_setprio 1
K1_G_P4:
    v_add_u32 v5, 0xffff6000, v5
    v_add_u32 v6, 0xffff6000, v6
    v_add_u32 v7, 0xffff6000, v7
    v_add_u32 v8, 0xffff6000, v8
    v_add_u32 v9, 0xffff6000, v9
    v_mfma_f32_16x16x32_bf16 v[72:75], v[44:47], v[124:127], v[72:75]
    ds_read_b64_tr_b16 v[36:37], v5 offset:0
    ds_read_b64_tr_b16 v[38:39], v5 offset:2048
    v_mfma_f32_16x16x32_bf16 v[76:79], v[44:47], v[204:207], v[76:79]
    ds_read_b128 v[128:131], v1 offset:0
    v_mfma_f32_16x16x32_bf16 v[80:83], v[48:51], v[124:127], v[80:83]
    ds_read_b128 v[208:211], v3 offset:0
    ds_read_b64_tr_b16 v[40:41], v6 offset:0
    v_mfma_f32_16x16x32_bf16 v[84:87], v[48:51], v[204:207], v[84:87]
    ds_read_b64_tr_b16 v[42:43], v6 offset:512
    v_mfma_f32_16x16x32_bf16 v[88:91], v[52:55], v[124:127], v[88:91]
    ds_read_b64_tr_b16 v[44:45], v7 offset:0
    s_add_u32 m0, s47, 49152
    s_mov_b32 s45, 896
    buffer_load_dwordx4 v10, s[20:23], s45 offen lds
    v_mfma_f32_16x16x32_bf16 v[92:95], v[52:55], v[204:207], v[92:95]
    ds_read_b64_tr_b16 v[46:47], v7 offset:2048
    v_mfma_f32_16x16x32_bf16 v[28:31], v[124:127], v[124:127], v[28:31]
    ds_read_b64_tr_b16 v[48:49], v8 offset:0
    v_mfma_f32_16x16x32_bf16 v[32:35], v[124:127], v[16:19], v[32:35]
    ds_read_b64_tr_b16 v[50:51], v8 offset:2048
    s_waitcnt lgkmcnt(7)
    s_waitcnt lgkmcnt(6)
    v_mfma_f32_16x16x32_bf16 v[56:59], v[36:39], v[128:131], v[56:59]
    ds_read_b64_tr_b16 v[52:53], v9 offset:0
    v_mfma_f32_16x16x32_bf16 v[60:63], v[36:39], v[208:211], v[60:63]
    ds_read_b64_tr_b16 v[54:55], v9 offset:2048
    s_add_u32 m0, s47, 50176
    s_mov_b32 s45, 11136
    buffer_load_dwordx4 v10, s[20:23], s45 offen lds
    v_mfma_f32_16x16x32_bf16 v[20:23], v[16:19], v[36:39], v[20:23]
    ds_read_b128 v[132:135], v2 offset:0
    s_waitcnt lgkmcnt(7)
    v_mfma_f32_16x16x32_bf16 v[64:67], v[40:43], v[128:131], v[64:67]
    ds_read_b128 v[212:215], v4 offset:0
    s_cmp_lg_u32 s15, 0
    s_cbranch_scc1 K1_G_C8
    v_mfma_f32_16x16x32_bf16 v[24:27], v[16:19], v[40:43], v[24:27]
K1_G_C8:
    s_waitcnt lgkmcnt(6)
    v_mfma_f32_16x16x32_bf16 v[72:75], v[44:47], v[128:131], v[72:75]
    ds_read_b64_tr_b16 v[36:37], v5 offset:4096
    s_setprio 0
    v_mfma_f32_16x16x32_bf16 v[76:79], v[44:47], v[208:211], v[76:79]
    ds_read_b64_tr_b16 v[38:39], v5 offset:6144
    s_waitcnt lgkmcnt(6)
    v_mfma_f32_16x16x32_bf16 v[80:83], v[48:51], v[128:131], v[80:83]
    ds_read_b64_tr_b16 v[40:41], v6 offset:1024
    s_add_u32 m0, s44, 126976
    s_mov_b32 s45, 1376256
    buffer_load_dwordx4 v13, s[28:31], s45 offen lds
    v_mfma_f32_16x16x32_bf16 v[84:87], v[48:51], v[208:211], v[84:87]
    ds_read_b64_tr_b16 v[42:43], v6 offset:1536
    s_waitcnt lgkmcnt(6)
    v_mfma_f32_16x16x32_bf16 v[88:91], v[52:55], v[128:131], v[88:91]
    ds_read_b64_tr_b16 v[44:45], v7 offset:4096
    v_mfma_f32_16x16x32_bf16 v[92:95], v[52:55], v[208:211], v[92:95]
    ds_read_b64_tr_b16 v[46:47], v7 offset:6144
    v_mfma_f32_16x16x32_bf16 v[28:31], v[128:131], v[128:131], v[28:31]
    ds_read_b64_tr_b16 v[48:49], v8 offset:4096
    v_mfma_f32_16x16x32_bf16 v[32:35], v[128:131], v[16:19], v[32:35]
    ds_read_b64_tr_b16 v[50:51], v8 offset:6144
    s_add_u32 m0, s44, 135168
    s_mov_b32 s45, 1376384
    buffer_load_dwordx4 v13, s[28:31], s45 offen lds
    s_waitcnt lgkmcnt(9)
    s_waitcnt lgkmcnt(8)
    s_waitcnt lgkmcnt(6)
    v_mfma_f32_16x16x32_bf16 v[56:59], v[36:39], v[132:135], v[56:59]
    ds_read_b64_tr_b16 v[52:53], v9 offset:4096
    v_mfma_f32_16x16x32_bf16 v[60:63], v[36:39], v[212:215], v[60:63]
    ds_read_b64_tr_b16 v[54:55], v9 offset:6144
    v_mfma_f32_16x16x32_bf16 v[20:23], v[16:19], v[36:39], v[20:23]
    s_waitcnt lgkmcnt(6)
    v_mfma_f32_16x16x32_bf16 v[64:67], v[40:43], v[132:135], v[64:67]
    s_cmp_lg_u32 s15, 1
    s_cbranch_scc1 K1_G_C9
    v_mfma_f32_16x16x32_bf16 v[24:27], v[16:19], v[40:43], v[24:27]
K1_G_C9:
    s_add_u32 m0, s46, 61440
    s_mov_b32 s45, 1720320
    s_mov_b64 exec, 0xffff
    buffer_load_dwordx4 v12, s[24:27], s45 offen lds
    s_mov_b64 exec, -1
    s_waitcnt vmcnt(10)
    s_waitcnt lgkmcnt(0)
    s_barrier
    s_cbranch_vccz K1_G_P5
    s_setprio 1
K1_G_P5:
    v_mfma_f32_16x16x32_bf16 v[72:75], v[44:47], v[132:135], v[72:75]
    ds_read_b64_tr_b16 v[36:37], v5 offset:20480
    ds_read_b64_tr_b16 v[38:39], v5 offset:22528
    v_mfma_f32_16x16x32_bf16 v[76:79], v[44:47], v[212:215], v[76:79]
    ds_read_b128 v[136:139], v1 offset:16384
    v_mfma_f32_16x16x32_bf16 v[80:83], v[48:51], v[132:135], v[80:83]
    ds_read_b128 v[216:219], v3 offset:16384
    ds_read_b64_tr_b16 v[40:41], v6 offset:20480
    v_mfma_f32_16x16x32_bf16 v[84:87], v[48:51], v[212:215], v[84:87]
    ds_read_b64_tr_b16 v[42:43], v6 offset:20992
    v_mfma_f32_16x16x32_bf16 v[88:91], v[52:55], v[132:135], v[88:91]
    ds_read_b64_tr_b16 v[44:45], v7 offset:20480
    s_add_u32 m0, s47, 0
    s_mov_b32 s45, 1024
    buffer_load_dwordx4 v10, s[20:23], s45 offen lds
    v_mfma_f32_16x16x32_bf16 v[92:95], v[52:55], v[212:215], v[92:95]
    ds_read_b64_tr_b16 v[46:47], v7 offset:22528
    v_mfma_f32_16x16x32_bf16 v[28:31], v[132:135], v[132:135], v[28:31]
    ds_read_b64_tr_b16 v[48:49], v8 offset:20480
    v_mfma_f32_16x16x32_bf16 v[32:35], v[132:135], v[16:19], v[32:35]
    ds_read_b64_tr_b16 v[50:51], v8 offset:22528
    s_waitcnt lgkmcnt(7)
    s_waitcnt lgkmcnt(6)
    v_mfma_f32_16x16x32_bf16 v[56:59], v[36:39], v[136:139], v[56:59]
    ds_read_b64_tr_b16 v[52:53], v9 offset:20480
    v_mfma_f32_16x16x32_bf16 v[60:63], v[36:39], v[216:219], v[60:63]
    ds_read_b64_tr_b16 v[54:55], v9 offset:22528
    s_add_u32 m0, s47, 1024
    s_mov_b32 s45, 11264
    buffer_load_dwordx4 v10, s[20:23], s45 offen lds
    v_mfma_f32_16x16x32_bf16 v[20:23], v[16:19], v[36:39], v[20:23]
    ds_read_b128 v[140:143], v2 offset:16384
    s_waitcnt lgkmcnt(7)
    v_mfma_f32_16x16x32_bf16 v[64:67], v[40:43], v[136:139], v[64:67]
    ds_read_b128 v[220:223], v4 offset:16384
    s_cmp_lg_u32 s15, 2
    s_cbranch_scc1 K1_G_C10
    v_mfma_f32_16x16x32_bf16 v[24:27], v[16:19], v[40:43], v[24:27]
K1_G_C10:
    s_waitcnt lgkmcnt(6)
    v_mfma_f32_16x16x32_bf16 v[72:75], v[44:47], v[136:139], v[72:75]
    ds_read_b64_tr_b16 v[36:37], v5 offset:24576
    s_setprio 0
    v_mfma_f32_16x16x32_bf16 v[76:79], v[44:47], v[216:219], v[76:79]
    ds_read_b64_tr_b16 v[38:39], v5 offset:26624
    s_waitcnt lgkmcnt(6)
    v_mfma_f32_16x16x32_bf16 v[80:83], v[48:51], v[136:139], v[80:83]
    ds_read_b64_tr_b16 v[40:41], v6 offset:21504
    s_add_u32 m0, s44, 65536
    s_mov_b32 s45, 1572864
    buffer_load_dwordx4 v13, s[28:31], s45 offen lds
    v_mfma_f32_16x16x32_bf16 v[84:87], v[48:51], v[216:219], v[84:87]
    ds_read_b64_tr_b16 v[42:43], v6 offset:22016
    s_waitcnt lgkmcnt(6)
    v_mfma_f32_16x16x32_bf16 v[88:91], v[52:55], v[136:139], v[88:91]
    ds_read_b64_tr_b16 v[44:45], v7 offset:24576
    v_mfma_f32_16x16x32_bf16 v[92:95], v[52:55], v[216:219], v[92:95]
    ds_read_b64_tr_b16 v[46:47], v7 offset:26624
    v_mfma_f32_16x16x32_bf16 v[28:31], v[136:139], v[136:139], v[28:31]
    ds_read_b64_tr_b16 v[48:49], v8 offset:24576
    v_mfma_f32_16x16x32_bf16 v[32:35], v[136:139], v[16:19], v[32:35]
    ds_read_b64_tr_b16 v[50:51], v8 offset:26624
    s_add_u32 m0, s44, 73728
    s_mov_b32 s45, 1572992
    buffer_load_dwordx4 v13, s[28:31], s45 offen lds
    s_waitcnt lgkmcnt(9)
    s_waitcnt lgkmcnt(8)
    s_waitcnt lgkmcnt(6)
    v_mfma_f32_16x16x32_bf16 v[56:59], v[36:39], v[140:143], v[56:59]
    ds_read_b64_tr_b16 v[52:53], v9 offset:24576
    v_mfma_f32_16x16x32_bf16 v[60:63], v[36:39], v[220:223], v[60:63]
    ds_read_b64_tr_b16 v[54:55], v9 offset:26624
    v_mfma_f32_16x16x32_bf16 v[20:23], v[16:19], v[36:39], v[20:23]
    s_waitcnt lgkmcnt(6)
    v_mfma_f32_16x16x32_bf16 v[64:67], v[40:43], v[140:143], v[64:67]
    s_cmp_lg_u32 s15, 3
    s_cbranch_scc1 K1_G_C11
    v_mfma_f32_16x16x32_bf16 v[24:27], v[16:19], v[40:43], v[24:27]
K1_G_C11:
    s_add_u32 m0, s46, 0
    s_mov_b32 s45, 1966080
    s_mov_b64 exec, 0xffff
    buffer_load_dwordx4 v12, s[24:27], s45 offen lds
    s_mov_b64 exec, -1
    s_waitcnt vmcnt(10)
    s_waitcnt lgkmcnt(0)
    s_barrier
    s_cbranch_vccz K1_G_P6
    s_setprio 1
K1_G_P6:
    v_add_u32 v5, 0xa000, v5
    v_add_u32 v6, 0xa000, v6
    v_add_u32 v7, 0xa000, v7
    v_add_u32 v8, 0xa000, v8
    v_add_u32 v9, 0xa000, v9
    v_mfma_f32_16x16x32_bf16 v[72:75], v[44:47], v[140:143], v[72:75]
    ds_read_b64_tr_b16 v[36:37], v5 offset:0
    ds_read_b64_tr_b16 v[38:39], v5 offset:2048
    v_mfma_f32_16x16x32_bf16 v[76:79], v[44:47], v[220:223], v[76:79]
    ds_read_b128 v[144:147], v1 offset:32768
    v_mfma_f32_16x16x32_bf16 v[80:83], v[48:51], v[140:143], v[80:83]
    ds_read_b128 v[224:227], v3 offset:32768
    ds_read_b64_tr_b16 v[40:41], v6 offset:0
    v_mfma_f32_16x16x32_bf16 v[84:87], v[48:51], v[220:223], v[84:87]
    ds_read_b64_tr_b16 v[42:43], v6 offset:512
    v_mfma_f32_16x16x32_bf16 v[88:91], v[52:55], v[140:143], v[88:91]
    ds_read_b64_tr_b16 v[44:45], v7 offset:0
    s_add_u32 m0, s47, 16384
    s_mov_b32 s45, 1152
    buffer_load_dwordx4 v10, s[20:23], s45 offen lds
    v_mfma_f32_16x16x32_bf16 v[92:95], v[52:55], v[220:223], v[92:95]
    ds_read_b64_tr_b16 v[46:47], v7 offset:2048
    v_mfma_f32_16x16x32_bf16 v[28:31], v[140:143], v[140:143], v[28:31]
    ds_read_b64_tr_b16 v[48:49], v8 offset:0
    v_mfma_f32_16x16x32_bf16 v[32:35], v[140:143], v[16:19], v[32:35]
    ds_read_b64_tr_b16 v[50:51], v8 offset:2048
    s_waitcnt lgkmcnt(7)
    s_waitcnt lgkmcnt(6)
    v_mfma_f32_16x16x32_bf16 v[56:59], v[36:39], v[144:147], v[56:59]
    ds_read_b64_tr_b16 v[52:53], v9 offset:0
    v_mfma_f32_16x16x32_bf16 v[60:63], v[36:39], v[224:227], v[60:63]
    ds_read_b64_tr_b16 v[54:55], v9 offset:2048
    s_add_u32 m0, s47, 17408
    s_mov_b32 s45, 11392
    buffer_load_dwordx4 v10, s[20:23], s45 offen lds
    v_mfma_f32_16x16x32_bf16 v[20:23], v[16:19], v[36:39], v[20:23]
    ds_read_b128 v[148:151], v2 offset:32768
    s_waitcnt lgkmcnt(7)
    v_mfma_f32_16x16x32_bf16 v[64:67], v[40:43], v[144:147], v[64:67]
    ds_read_b128 v[228:231], v4 offset:32768
    s_cmp_lg_u32 s15, 0
    s_cbranch_scc1 K1_G_C12
    v_mfma_f32_16x16x32_bf16 v[24:27], v[16:19], v[40:43], v[24:27]
K1_G_C12:
    s_waitcnt lgkmcnt(6)
    v_mfma_f32_16x16x32_bf16 v[72:75], v[44:47], v[144:147], v[72:75]
    ds_read_b64_tr_b16 v[36:37], v5 offset:4096
    s_setprio 0
    v_mfma_f32_16x16x32_bf16 v[76:79], v[44:47], v[224:227], v[76:79]
    ds_read_b64_tr_b16 v[38:39], v5 offset:6144
    s_waitcnt lgkmcnt(6)
    v_mfma_f32_16x16x32_bf16 v[80:83], v[48:51], v[144:147], v[80:83]
    ds_read_b64_tr_b16 v[40:41], v6 offset:1024
    s_add_u32 m0, s44, 86016
    s_mov_b32 s45, 1769472
    buffer_load_dwordx4 v13, s[28:31], s45 offen lds
    v_mfma_f32_16x16x32_bf16 v[84:87], v[48:51], v[224:227], v[84:87]
    ds_read_b64_tr_b16 v[42:43], v6 offset:1536
    s_waitcnt lgkmcnt(6)
    v_mfma_f32_16x16x32_bf16 v[88:91], v[52:55], v[144:147], v[88:91]
    ds_read_b64_tr_b16 v[44:45], v7 offset:4096
    v_mfma_f32_16x16x32_bf16 v[92:95], v[52:55], v[224:227], v[92:95]
    ds_read_b64_tr_b16 v[46:47], v7 offset:6144
    v_mfma_f32_16x16x32_bf16 v[28:31], v[144:147], v[144:147], v[28:31]
    ds_read_b64_tr_b16 v[48:49], v8 offset:4096
    v_mfma_f32_16x16x32_bf16 v[32:35], v[144:147], v[16:19], v[32:35]
    ds_read_b64_tr_b16 v[50:51], v8 offset:6144
    s_add_u32 m0, s44, 94208
    s_mov_b32 s45, 1769600
    buffer_load_dwordx4 v13, s[28:31], s45 offen lds
    s_waitcnt lgkmcnt(9)
    s_waitcnt lgkmcnt(8)
    s_waitcnt lgkmcnt(6)
    v_mfma_f32_16x16x32_bf16 v[56:59], v[36:39], v[148:151], v[56:59]
    ds_read_b64_tr_b16 v[52:53], v9 offset:4096
    v_mfma_f32_16x16x32_bf16 v[60:63], v[36:39], v[228:231], v[60:63]
    ds_read_b64_tr_b16 v[54:55], v9 offset:6144
    v_mfma_f32_16x16x32_bf16 v[20:23], v[16:19], v[36:39], v[20:23]
    s_waitcnt lgkmcnt(6)
    v_mfma_f32_16x16x32_bf16 v[64:67], v[40:43], v[148:151], v[64:67]
    s_cmp_lg_u32 s15, 1
    s_cbranch_scc1 K1_G_C13
    v_mfma_f32_16x16x32_bf16 v[24:27], v[16:19], v[40:43], v[24:27]
K1_G_C13:
    s_add_u32 m0, s46, 20480
    s_mov_b32 s45, 2211840
    s_mov_b64 exec, 0xffff
    buffer_load_dwordx4 v12, s[24:27], s45 offen lds
    s_mov_b64 exec, -1
    s_waitcnt vmcnt(10)
    s_waitcnt lgkmcnt(0)
    s_barrier
    s_cbranch_vccz K1_G_P7
    s_setprio 1
K1_G_P7:
    v_mov_b32 v248, -1
    v_mov_b32 v249, -1
    v_mov_b32 v250, -1
    v_mov_b32 v251, -1
    v_mfma_f32_16x16x32_bf16 v[72:75], v[44:47], v[148:151], v[72:75]
    ds_read_b64_tr_b16 v[36:37], v5 offset:20480
    ds_read_b64_tr_b16 v[38:39], v5 offset:22528
    v_mfma_f32_16x16x32_bf16 v[76:79], v[44:47], v[228:231], v[76:79]
    ds_read_b128 v[152:155], v1 offset:49152
    v_mfma_f32_16x16x32_bf16 v[80:83], v[48:51], v[148:151], v[80:83]
    ds_read_b128 v[232:235], v3 offset:49152
    ds_read_b64_tr_b16 v[40:41], v6 offset:20480
    v_mfma_f32_16x16x32_bf16 v[84:87], v[48:51], v[228:231], v[84:87]
    ds_read_b64_tr_b16 v[42:43], v6 offset:20992
    v_mfma_f32_16x16x32_bf16 v[88:91], v[52:55], v[148:151], v[88:91]
    ds_read_b64_tr_b16 v[44:45], v7 offset:20480
    s_add_u32 m0, s44, 32768
    s_mov_b32 s45, 256
    buffer_load_dwordx4 v13, s[28:31], s45 offen lds
    v_mfma_f32_16x16x32_bf16 v[92:95], v[52:55], v[228:231], v[92:95]
    ds_read_b64_tr_b16 v[46:47], v7 offset:22528
    v_mfma_f32_16x16x32_bf16 v[28:31], v[148:151], v[148:151], v[28:31]
    ds_read_b64_tr_b16 v[48:49], v8 offset:20480
    v_mfma_f32_16x16x32_bf16 v[32:35], v[148:151], v[16:19], v[32:35]
    ds_read_b64_tr_b16 v[50:51], v8 offset:22528
    s_waitcnt lgkmcnt(7)
    s_waitcnt lgkmcnt(6)
    v_mfma_f32_16x16x32_bf16 v[56:59], v[36:39], v[152:155], v[56:59]
    ds_read_b64_tr_b16 v[52:53], v9 offset:20480
    v_mfma_f32_16x16x32_bf16 v[60:63], v[36:39], v[232:235], v[60:63]
    ds_read_b64_tr_b16 v[54:55], v9 offset:22528
    s_add_u32 m0, s44, 40960
    s_mov_b32 s45, 196864
    buffer_load_dwordx4 v13, s[28:31], s45 offen lds
    v_mfma_f32_16x16x32_bf16 v[20:23], v[16:19], v[36:39], v[20:23]
    ds_read_b128 v[156:159], v2 offset:49152
    s_waitcnt lgkmcnt(7)
    v_mfma_f32_16x16x32_bf16 v[64:67], v[40:43], v[152:155], v[64:67]
    ds_read_b128 v[236:239], v4 offset:49152
    s_cmp_lg_u32 s15, 2
    s_cbranch_scc1 K1_G_C14
    v_mfma_f32_16x16x32_bf16 v[24:27], v[16:19], v[40:43], v[24:27]
K1_G_C14:
    s_waitcnt lgkmcnt(6)
    v_mfma_f32_16x16x32_bf16 v[72:75], v[44:47], v[152:155], v[72:75]
    ds_read_b64_tr_b16 v[36:37], v5 offset:24576
    s_setprio 0
    v_mfma_f32_16x16x32_bf16 v[76:79], v[44:47], v[232:235], v[76:79]
    ds_read_b64_tr_b16 v[38:39], v5 offset:26624
    s_waitcnt lgkmcnt(6)
    v_mfma_f32_16x16x32_bf16 v[80:83], v[48:51], v[152:155], v[80:83]
    ds_read_b64_tr_b16 v[40:41], v6 offset:21504
    s_add_u32 m0, s44, 110592
    s_mov_b32 s45, 393472
    buffer_load_dwordx4 v13, s[28:31], s45 offen lds
    v_mfma_f32_16x16x32_bf16 v[84:87], v[48:51], v[232:235], v[84:87]
    ds_read_b64_tr_b16 v[42:43], v6 offset:22016
    s_waitcnt lgkmcnt(6)
    v_mfma_f32_16x16x32_bf16 v[88:91], v[52:55], v[152:155], v[88:91]
    ds_read_b64_tr_b16 v[44:45], v7 offset:24576
    v_mfma_f32_16x16x32_bf16 v[92:95], v[52:55], v[232:235], v[92:95]
    ds_read_b64_tr_b16 v[46:47], v7 offset:26624
    v_mfma_f32_16x16x32_bf16 v[28:31], v[152:155], v[152:155], v[28:31]
    ds_read_b64_tr_b16 v[48:49], v8 offset:24576
    v_mfma_f32_16x16x32_bf16 v[32:35], v[152:155], v[16:19], v[32:35]
    ds_read_b64_tr_b16 v[50:51], v8 offset:26624
    s_add_u32 m0, s44, 118784
    s_mov_b32 s45, 590080
    buffer_load_dwordx4 v13, s[28:31], s45 offen lds
    s_waitcnt lgkmcnt(9)
    s_waitcnt lgkmcnt(8)
    s_waitcnt lgkmcnt(6)
    v_mfma_f32_16x16x32_bf16 v[56:59], v[36:39], v[156:159], v[56:59]
    ds_read_b64_tr_b16 v[52:53], v9 offset:24576
    v_mfma_f32_16x16x32_bf16 v[60:63], v[36:39], v[236:239], v[60:63]
    ds_read_b64_tr_b16 v[54:55], v9 offset:26624
    v_mfma_f32_16x16x32_bf16 v[20:23], v[16:19], v[36:39], v[20:23]
    s_waitcnt lgkmcnt(6)
    v_mfma_f32_16x16x32_bf16 v[64:67], v[40:43], v[156:159], v[64:67]
    s_cmp_lg_u32 s15, 3
    s_cbranch_scc1 K1_G_C15
    v_mfma_f32_16x16x32_bf16 v[24:27], v[16:19], v[40:43], v[24:27]
K1_G_C15:
    buffer_store_dwordx4 v[248:251], v0, s[92:95], s10 offen sc1
    s_mov_b64 exec, 0xfffff
    buffer_store_dwordx4 v[248:251], v0, s[92:95], s10 offen offset:1024 sc1
    s_mov_b64 exec, -1
    s_waitcnt vmcnt(11)
    s_waitcnt vmcnt(9)
    s_waitcnt lgkmcnt(0)
    s_barrier
    s_cbranch_vccz K1_G_P8
    s_setprio 1
K1_G_P8:
    v_add_u32 v5, 0xffff6000, v5
    v_add_u32 v6, 0xffff6000, v6
    v_add_u32 v7, 0xffff6000, v7
    v_add_u32 v8, 0xffff6000, v8
    v_add_u32 v9, 0xffff6000, v9
    v_mfma_f32_16x16x32_bf16 v[72:75], v[44:47], v[156:159], v[72:75]
    ds_read_b64_tr_b16 v[36:37], v5 offset:0
    ds_read_b64_tr_b16 v[38:39], v5 offset:2048
    v_mfma_f32_16x16x32_bf16 v[76:79], v[44:47], v[236:239], v[76:79]
    ds_read_b128 v[160:163], v1 offset:0
    ds_read_b128 v[240:243], v3 offset:0
    v_mfma_f32_16x16x32_bf16 v[80:83], v[48:51], v[156:159], v[80:83]
    ds_read_b64_tr_b16 v[40:41], v6 offset:0
    ds_read_b64_tr_b16 v[42:43], v6 offset:512
    v_mfma_f32_16x16x32_bf16 v[84:87], v[48:51], v[236:239], v[84:87]
    ds_read_b128 v[164:167], v2 offset:0
    v_mfma_f32_16x16x32_bf16 v[88:91], v[52:55], v[156:159], v[88:91]
    ds_read_b64_tr_b16 v[44:45], v7 offset:0
    ds_read_b64_tr_b16 v[46:47], v7 offset:2048
    s_add_u32 m0, s44, 49152
    s_mov_b32 s45, 786688
    buffer_load_dwordx4 v13, s[28:31], s45 offen lds
    v_mfma_f32_16x16x32_bf16 v[92:95], v[52:55], v[236:239], v[92:95]
    ds_read_b128 v[168:171], v1 offset:16384
    v_mfma_f32_16x16x32_bf16 v[28:31], v[156:159], v[156:159], v[28:31]
    ds_read_b64_tr_b16 v[48:49], v8 offset:0
    ds_read_b64_tr_b16 v[50:51], v8 offset:2048
    v_mfma_f32_16x16x32_bf16 v[32:35], v[156:159], v[16:19], v[32:35]
    ds_read_b128 v[172:175], v2 offset:16384
    s_waitcnt lgkmcnt(10)
    s_waitcnt lgkmcnt(9)
    v_mfma_f32_16x16x32_bf16 v[56:59], v[36:39], v[160:163], v[56:59]
    ds_read_b64_tr_b16 v[52:53], v9 offset:0
    v_mfma_f32_16x16x32_bf16 v[60:63], v[36:39], v[240:243], v[60:63]
    ds_read_b64_tr_b16 v[54:55], v9 offset:2048
    s_add_u32 m0, s44, 57344
    s_mov_b32 s45, 983296
    buffer_load_dwordx4 v13, s[28:31], s45 offen lds
    v_mfma_f32_16x16x32_bf16 v[20:23], v[16:19], v[36:39], v[20:23]
    ds_read_b128 v[244:247], v4 offset:0
    s_waitcnt lgkmcnt(10)
    v_mfma_f32_16x16x32_bf16 v[64:67], v[40:43], v[160:163], v[64:67]
    ds_read_b64_tr_b16 v[36:37], v5 offset:4096
    s_cmp_lg_u32 s15, 0
    s_cbranch_scc1 K1_G_C16
    v_mfma_f32_16x16x32_bf16 v[24:27], v[16:19], v[40:43], v[24:27]
K1_G_C16:
    s_waitcnt lgkmcnt(8)
    v_mfma_f32_16x16x32_bf16 v[72:75], v[44:47], v[160:163], v[72:75]
    ds_read_b64_tr_b16 v[38:39], v5 offset:6144
    s_setprio 0
    v_mfma_f32_16x16x32_bf16 v[76:79], v[44:47], v[240:243], v[76:79]
    ds_read_b64_tr_b16 v[40:41], v6 offset:1024
    s_waitcnt lgkmcnt(7)
    v_mfma_f32_16x16x32_bf16 v[80:83], v[48:51], v[160:163], v[80:83]
    ds_read_b64_tr_b16 v[42:43], v6 offset:1536
    ds_read_b128 v[248:251], v3 offset:16384
    s_add_u32 m0, s44, 126976
    s_mov_b32 s45, 1179904
    buffer_load_dwordx4 v13, s[28:31], s45 offen lds
    v_mfma_f32_16x16x32_bf16 v[84:87], v[48:51], v[240:243], v[84:87]
    ds_read_b64_tr_b16 v[44:45], v7 offset:4096
    s_waitcnt lgkmcnt(7)
    v_mfma_f32_16x16x32_bf16 v[88:91], v[52:55], v[160:163], v[88:91]
    ds_read_b64_tr_b16 v[46:47], v7 offset:6144
    v_mfma_f32_16x16x32_bf16 v[92:95], v[52:55], v[240:243], v[92:95]
    ds_read_b128 v[252:255], v4 offset:16384
    v_mfma_f32_16x16x32_bf16 v[28:31], v[160:163], v[160:163], v[28:31]
    ds_read_b64_tr_b16 v[48:49], v8 offset:4096
    v_mfma_f32_16x16x32_bf16 v[32:35], v[160:163], v[16:19], v[32:35]
    ds_read_b64_tr_b16 v[50:51], v8 offset:6144
    s_add_u32 m0, s44, 135168
    s_mov_b32 s45, 1376512
    buffer_load_dwordx4 v13, s[28:31], s45 offen lds
    v_mfma_f32_16x16x32_bf16 v[28:31], v[164:167], v[164:167], v[28:31]
    ds_read_b64_tr_b16 v[52:53], v9 offset:4096
    v_mfma_f32_16x16x32_bf16 v[32:35], v[164:167], v[16:19], v[32:35]
    ds_read_b64_tr_b16 v[54:55], v9 offset:6144
    s_waitcnt lgkmcnt(12)
    s_waitcnt lgkmcnt(10)
    v_mfma_f32_16x16x32_bf16 v[56:59], v[36:39], v[164:167], v[56:59]
    v_mfma_f32_16x16x32_bf16 v[60:63], v[36:39], v[244:247], v[60:63]
    v_mfma_f32_16x16x32_bf16 v[20:23], v[16:19], v[36:39], v[20:23]
    s_waitcnt lgkmcnt(8)
    v_mfma_f32_16x16x32_bf16 v[64:67], v[40:43], v[164:167], v[64:67]
    s_cmp_lg_u32 s15, 1
    s_cbranch_scc1 K1_G_C17
    v_mfma_f32_16x16x32_bf16 v[24:27], v[16:19], v[40:43], v[24:27]
K1_G_C17:
    s_waitcnt vmcnt(10)
    s_waitcnt lgkmcnt(0)
    s_barrier
    s_cbranch_vccz K1_G_P9
    s_setprio 1
K1_G_P9:
    v_mfma_f32_16x16x32_bf16 v[72:75], v[44:47], v[164:167], v[72:75]
    ds_read_b64_tr_b16 v[36:37], v5 offset:20480
    ds_read_b64_tr_b16 v[38:39], v5 offset:22528
    v_mfma_f32_16x16x32_bf16 v[76:79], v[44:47], v[244:247], v[76:79]
    ds_read_b128 v[168:171], v1 offset:16384
    v_mfma_f32_16x16x32_bf16 v[80:83], v[48:51], v[164:167], v[80:83]
    ds_read_b128 v[248:251], v3 offset:16384
    ds_read_b64_tr_b16 v[40:41], v6 offset:20480
    v_mfma_f32_16x16x32_bf16 v[84:87], v[48:51], v[244:247], v[84:87]
    ds_read_b64_tr_b16 v[42:43], v6 offset:20992
    v_mfma_f32_16x16x32_bf16 v[88:91], v[52:55], v[164:167], v[88:91]
    ds_read_b64_tr_b16 v[44:45], v7 offset:20480
    s_add_u32 m0, s44, 0
    s_mov_b32 s45, 1573120
    buffer_load_dwordx4 v13, s[28:31], s45 offen lds
    v_mfma_f32_16x16x32_bf16 v[92:95], v[52:55], v[244:247], v[92:95]
    ds_read_b64_tr_b16 v[46:47], v7 offset:22528
    s_waitcnt lgkmcnt(5)
    v_mfma_f32_16x16x32_bf16 v[28:31], v[168:171], v[168:171], v[28:31]
    ds_read_b64_tr_b16 v[48:49], v8 offset:20480
    v_mfma_f32_16x16x32_bf16 v[32:35], v[168:171], v[16:19], v[32:35]
    ds_read_b64_tr_b16 v[50:51], v8 offset:22528
    v_mfma_f32_16x16x32_bf16 v[28:31], v[172:175], v[172:175], v[28:31]
    ds_read_b64_tr_b16 v[52:53], v9 offset:20480
    v_mfma_f32_16x16x32_bf16 v[32:35], v[172:175], v[16:19], v[32:35]
    ds_read_b64_tr_b16 v[54:55], v9 offset:22528
    s_add_u32 m0, s44, 8192
    s_mov_b32 s45, 1769728
    buffer_load_dwordx4 v13, s[28:31], s45 offen lds
    s_waitcnt lgkmcnt(8)
    v_mfma_f32_16x16x32_bf16 v[56:59], v[36:39], v[168:171], v[56:59]
    v_bfe_u32 v15, v0, 4, 4
    v_lshl_add_u32 v14, v15, 2, s43
    v_mfma_f32_16x16x32_bf16 v[60:63], v[36:39], v[248:251], v[60:63]
    v_add_u32 v10, s58, v14
    v_lshl_add_u32 v1, v15, 2, s56
    v_mfma_f32_16x16x32_bf16 v[20:23], v[16:19], v[36:39], v[20:23]
    v_xor_b32 v2, 64, v1
    v_lshrrev_b32 v3, 8, v0
    s_setprio 0
    s_waitcnt lgkmcnt(6)
    v_mfma_f32_16x16x32_bf16 v[64:67], v[40:43], v[168:171], v[64:67]
    ds_read_b64_tr_b16 v[36:37], v5 offset:24576
    v_lshl_add_u32 v3, v3, 4, s43
    v_lshl_add_u32 v15, v15, 2, s56
    s_cmp_lg_u32 s15, 2
    s_cbranch_scc1 K1_G_C18
    v_mfma_f32_16x16x32_bf16 v[24:27], v[16:19], v[40:43], v[24:27]
K1_G_C18:
    s_waitcnt lgkmcnt(5)
    v_mfma_f32_16x16x32_bf16 v[72:75], v[44:47], v[168:171], v[72:75]
    ds_read_b64_tr_b16 v[38:39], v5 offset:26624
    v_cndmask_b32 v28, v28, v29, s[4:5]
    v_cndmask_b32 v28, v28, v30, s[6:7]
    v_mfma_f32_16x16x32_bf16 v[76:79], v[44:47], v[248:251], v[76:79]
    ds_read_b64_tr_b16 v[40:41], v6 offset:21504
    v_cndmask_b32 v28, v28, v31, s[8:9]
    v_cndmask_b32 v32, v32, v33, s[4:5]
    s_waitcnt lgkmcnt(5)
    v_mfma_f32_16x16x32_bf16 v[80:83], v[48:51], v[168:171], v[80:83]
    ds_read_b64_tr_b16 v[42:43], v6 offset:22016
    v_cndmask_b32 v32, v32, v34, s[6:7]
    v_cndmask_b32 v32, v32, v35, s[8:9]
    v_mfma_f32_16x16x32_bf16 v[84:87], v[48:51], v[248:251], v[84:87]
    ds_read_b64_tr_b16 v[44:45], v7 offset:24576
    v_mul_f32 v32, 0x3acccccd, v32
    v_mul_f32 v28, 0x3acccccd, v28
    s_waitcnt lgkmcnt(5)
    v_mfma_f32_16x16x32_bf16 v[88:91], v[52:55], v[168:171], v[88:91]
    ds_read_b64_tr_b16 v[46:47], v7 offset:26624
    v_fma_f32 v28, -v32, v32, v28
    v_max_f32 v28, 0, v28
    v_mfma_f32_16x16x32_bf16 v[92:95], v[52:55], v[248:251], v[92:95]
    ds_read_b64_tr_b16 v[48:49], v8 offset:24576
    v_cvt_pk_bf16_f32 v35, v32, v28
    v_lshlrev_b32 v31, 16, v35
    s_waitcnt lgkmcnt(5)
    v_mfma_f32_16x16x32_bf16 v[56:59], v[36:39], v[172:175], v[56:59]
    ds_read_b64_tr_b16 v[50:51], v8 offset:26624
    v_and_b32 v33, 0xffff0000, v35
    v_add_f32 v33, 0x3727c5ac, v33
    v_mfma_f32_16x16x32_bf16 v[60:63], v[36:39], v[252:255], v[60:63]
    ds_read_b64_tr_b16 v[52:53], v9 offset:24576
    v_cvt_pk_bf16_f32 v35, v33, v33
    v_lshlrev_b32 v33, 16, v35
    v_mfma_f32_16x16x32_bf16 v[20:23], v[16:19], v[36:39], v[20:23]
    ds_read_b64_tr_b16 v[54:55], v9 offset:26624
    v_sqrt_f32 v33, v33
    s_nop 0
    v_cvt_pk_bf16_f32 v35, v33, v33
    s_waitcnt lgkmcnt(6)
    v_mfma_f32_16x16x32_bf16 v[64:67], v[40:43], v[172:175], v[64:67]
    v_lshlrev_b32 v33, 16, v35
    v_rcp_f32 v34, v33
    s_nop 0
    s_cmp_lg_u32 s15, 3
    s_cbranch_scc1 K1_G_C19
    v_mfma_f32_16x16x32_bf16 v[24:27], v[16:19], v[40:43], v[24:27]
K1_G_C19:
    s_waitcnt lgkmcnt(4)
    v_mfma_f32_16x16x32_bf16 v[72:75], v[44:47], v[172:175], v[72:75]
    v_sub_f32 v29, v32, v31
    v_mul_f32 v29, v29, v34
    v_mfma_f32_16x16x32_bf16 v[76:79], v[44:47], v[252:255], v[76:79]
    v_mul_f32 v30, v28, v34
    v_mul_f32 v30, v30, v34
    v_cvt_pk_bf16_f32 v35, v29, v30
    v_lshlrev_b32 v29, 16, v35
    v_and_b32 v30, 0xffff0000, v35
    v_add_f32 v30, 0x3727c5ac, v30
    v_cvt_pk_bf16_f32 v35, v30, v30
    v_lshlrev_b32 v30, 16, v35
    v_sqrt_f32 v30, v30
    s_nop 0
    v_cvt_pk_bf16_f32 v35, v30, v30
    v_lshlrev_b32 v30, 16, v35
    v_rcp_f32 v33, v30
    s_nop 0
    v_mul_f32 v33, 0x3eeff558, v33
    v_mul_f32 v31, v31, v34
    v_add_f32 v30, v31, v29
    v_mul_f32 v30, v30, v33
    v_mul_f32 v29, v34, v33
    v_mul_f32 v32, 0x3fb8aa3b, v34
    v_mul_f32 v28, 0x3fb8aa3b, v31
    s_mov_b64 exec, s[12:13]
    ds_write2st64_b32 v15, v32, v28 offset0:0 offset1:2
    s_mov_b64 exec, -1
    s_mov_b64 exec, s[12:13]
    ds_write2st64_b32 v15, v29, v30 offset0:4 offset1:6
    s_mov_b64 exec, -1
    s_nop 3
    ds_write_b32 v14, v20
    ds_write_b32 v10, v24
    s_waitcnt vmcnt(2)
    s_waitcnt lgkmcnt(0)
    s_barrier
    s_setprio 0
    s_cmp_eq_u32 s51, 1
    s_cbranch_scc1 K1_G_B
    ds_read2st64_b32 v[20:21], v1 offset0:4 offset1:6
    ds_read2st64_b32 v[22:23], v2 offset0:4 offset1:6
    ds_read_b128 v[36:39], v3
    v_mfma_f32_16x16x32_bf16 v[80:83], v[48:51], v[172:175], v[80:83]
    ds_read_b128 v[40:43], v3 offset:2560
    ds_read2st64_b32 v[24:25], v1 offset0:0 offset1:2
    v_mfma_f32_16x16x32_bf16 v[84:87], v[48:51], v[252:255], v[84:87]
    v_mfma_f32_16x16x32_bf16 v[88:91], v[52:55], v[172:175], v[88:91]
    v_mfma_f32_16x16x32_bf16 v[92:95], v[52:55], v[252:255], v[92:95]
    v_xor_b32 v4, 64, v3
    ds_read_b128 v[44:47], v4
    ds_read_b128 v[48:51], v4 offset:2560
    s_waitcnt lgkmcnt(3)
    v_fma_f32 v28, v36, -v21, v40
    v_fma_f32 v29, v37, -v21, v41
    v_fma_f32 v30, v38, -v21, v42
    v_lshrrev_b32 v13, 7, v0
    v_fma_f32 v31, v39, -v21, v43
    v_fma_f32 v56, v56, v20, v28
    v_fma_f32 v57, v57, v20, v29
    v_mul_u32_u24 v13, 1280, v13
    v_fma_f32 v58, v58, v20, v30
    v_fma_f32 v59, v59, v20, v31
    v_fma_f32 v32, v56, v56, s86
    v_and_b32 v14, 0x70, v0
    v_fma_f32 v33, v57, v57, s87
    v_fma_f32 v34, v58, v58, s86
    v_fma_f32 v35, v59, v59, s87
    v_add_u32 v13, v13, v14
    v_mul_f32_e64 v32, v32, -v56
    v_mul_f32_e64 v33, v33, -v57
    v_mul_f32_e64 v34, v34, -v58
    s_add_u32 m0, s19, 0
    s_nop 0
    buffer_load_dwordx4 v13, s[64:67], s3 offen lds
    v_mul_f32_e64 v35, v35, -v59
    v_exp_f32 v32, v32
    v_exp_f32 v33, v33
    s_add_u32 m0, s19, 1024
    s_add_u32 s3, s3, s88
    buffer_load_dwordx4 v13, s[64:67], s3 offen lds
    v_exp_f32 v34, v34
    v_exp_f32 v35, v35
    v_fma_f32 v32, v32, s98, s98
    s_add_u32 m0, s19, 2048
    s_add_u32 s3, s3, s88
    buffer_load_dwordx4 v13, s[64:67], s3 offen lds
    v_fma_f32 v33, v33, s99, s99
    v_fma_f32 v34, v34, s98, s98
    v_fma_f32 v35, v35, s99, s99
    s_add_u32 m0, s19, 3072
    s_add_u32 s3, s3, s88
    buffer_load_dwordx4 v13, s[64:67], s3 offen lds
    v_rcp_f32 v32, v32
    v_rcp_f32 v33, v33
    v_rcp_f32 v34, v34
    v_rcp_f32 v35, v35
    v_mul_f32_e64 v56, v56, v32
    v_mul_f32_e64 v57, v57, v33
    v_mul_f32_e64 v58, v58, v34
    v_mul_f32_e64 v59, v59, v35
    v_cvt_pk_bf16_f32 v56, v56, v57
    v_cvt_pk_bf16_f32 v57, v58, v59
    v_fma_f32 v28, v36, -v23, v40
    v_fma_f32 v29, v37, -v23, v41
    v_fma_f32 v30, v38, -v23, v42
    v_fma_f32 v31, v39, -v23, v43
    v_fma_f32 v60, v60, v22, v28
    v_fma_f32 v61, v61, v22, v29
    v_fma_f32 v62, v62, v22, v30
    v_fma_f32 v63, v63, v22, v31
    v_fma_f32 v32, v60, v60, s86
    v_fma_f32 v33, v61, v61, s87
    v_fma_f32 v34, v62, v62, s86
    v_fma_f32 v35, v63, v63, s87
    v_mul_f32_e64 v32, v32, -v60
    v_mul_f32_e64 v33, v33, -v61
    v_mul_f32_e64 v34, v34, -v62
    v_mul_f32_e64 v35, v35, -v63
    v_exp_f32 v32, v32
    v_exp_f32 v33, v33
    v_exp_f32 v34, v34
    v_exp_f32 v35, v35
    v_fma_f32 v32, v32, s98, s98
    v_fma_f32 v33, v33, s99, s99
    v_fma_f32 v34, v34, s98, s98
    v_fma_f32 v35, v35, s99, s99
    v_rcp_f32 v32, v32
    v_rcp_f32 v33, v33
    v_rcp_f32 v34, v34
    v_rcp_f32 v35, v35
    v_mul_f32_e64 v60, v60, v32
    v_mul_f32_e64 v61, v61, v33
    v_mul_f32_e64 v62, v62, v34
    v_mul_f32_e64 v63, v63, v35
    v_cvt_pk_bf16_f32 v60, v60, v61
    v_cvt_pk_bf16_f32 v61, v62, v63
    v_xor_b32 v4, 128, v3
    ds_read_b128 v[36:39], v4
    ds_read_b128 v[40:43], v4 offset:2560
    s_waitcnt lgkmcnt(2)
    v_fma_f32 v28, v44, -v21, v48
    v_fma_f32 v29, v45, -v21, v49
    v_fma_f32 v30, v46, -v21, v50
    v_fma_f32 v31, v47, -v21, v51
    v_fma_f32 v72, v72, v20, v28
    v_fma_f32 v73, v73, v20, v29
    v_fma_f32 v74, v74, v20, v30
    v_fma_f32 v75, v75, v20, v31
    v_fma_f32 v32, v72, v72, s86
    v_fma_f32 v33, v73, v73, s87
    v_fma_f32 v34, v74, v74, s86
    v_fma_f32 v35, v75, v75, s87
    v_mul_f32_e64 v32, v32, -v72
    v_mul_f32_e64 v33, v33, -v73
    v_mul_f32_e64 v34, v34, -v74
    v_mul_f32_e64 v35, v35, -v75
    v_exp_f32 v32, v32
    v_exp_f32 v33, v33
    v_exp_f32 v34, v34
    v_exp_f32 v35, v35
    v_fma_f32 v32, v32, s98, s98
    v_fma_f32 v33, v33, s99, s99
    v_fma_f32 v34, v34, s98, s98
    v_fma_f32 v35, v35, s99, s99
    v_rcp_f32 v32, v32
    v_rcp_f32 v33, v33
    v_rcp_f32 v34, v34
    v_rcp_f32 v35, v35
    v_mul_f32_e64 v72, v72, v32
    v_mul_f32_e64 v73, v73, v33
    v_mul_f32_e64 v74, v74, v34
    v_mul_f32_e64 v75, v75, v35
    v_cvt_pk_bf16_f32 v58, v72, v73
    v_cvt_pk_bf16_f32 v59, v74, v75
    s_mov_b64 exec, s[100:101]
    v_swap_b32 v56, v58
    v_swap_b32 v57, v59
    s_mov_b64 exec, -1
    s_add_u32 s60, s41, s57
    buffer_store_dwordx4 v[56:59], v0, s[32:35], s60 offen sc1
    v_fma_f32 v28, v44, -v23, v48
    v_fma_f32 v29, v45, -v23, v49
    v_fma_f32 v30, v46, -v23, v50
    v_fma_f32 v31, v47, -v23, v51
    v_fma_f32 v76, v76, v22, v28
    v_fma_f32 v77, v77, v22, v29
    v_fma_f32 v78, v78, v22, v30
    v_fma_f32 v79, v79, v22, v31
    v_fma_f32 v32, v76, v76, s86
    v_fma_f32 v33, v77, v77, s87
    v_fma_f32 v34, v78, v78, s86
    v_fma_f32 v35, v79, v79, s87
    v_mul_f32_e64 v32, v32, -v76
    v_mul_f32_e64 v33, v33, -v77
    v_mul_f32_e64 v34, v34, -v78
    v_mul_f32_e64 v35, v35, -v79
    v_exp_f32 v32, v32
    v_exp_f32 v33, v33
    v_exp_f32 v34, v34
    v_exp_f32 v35, v35
    v_fma_f32 v32, v32, s98, s98
    v_fma_f32 v33, v33, s99, s99
    v_fma_f32 v34, v34, s98, s98
    v_fma_f32 v35, v35, s99, s99
    v_rcp_f32 v32, v32
    v_rcp_f32 v33, v33
    v_rcp_f32 v34, v34
    v_rcp_f32 v35, v35
    v_mul_f32_e64 v76, v76, v32
    v_mul_f32_e64 v77, v77, v33
    v_mul_f32_e64 v78, v78, v34
    v_mul_f32_e64 v79, v79, v35
    v_cvt_pk_bf16_f32 v62, v76, v77
    v_cvt_pk_bf16_f32 v63, v78, v79
    s_mov_b64 exec, s[100:101]
    v_swap_b32 v60, v62
    v_swap_b32 v61, v63
    s_mov_b64 exec, -1
    s_add_u32 s60, s42, s57
    buffer_store_dwordx4 v[60:63], v0, s[32:35], s60 offen sc1
    s_waitcnt vmcnt(6)
    s_waitcnt lgkmcnt(0)
    s_barrier
    v_xor_b32 v4, 192, v3
    ds_read_b128 v[44:47], v4
    ds_read_b128 v[48:51], v4 offset:2560
    v_fma_f32 v28, v36, -v21, v40
    v_lshrrev_b32 v13, 6, v0
    v_fma_f32 v29, v37, -v21, v41
    v_fma_f32 v30, v38, -v21, v42
    v_fma_f32 v31, v39, -v21, v43
    v_lshlrev_b32 v13, 7, v13
    v_fma_f32 v80, v80, v20, v28
    v_fma_f32 v81, v81, v20, v29
    v_fma_f32 v82, v82, v20, v30
    v_bfe_u32 v14, v0, 4, 2
    v_fma_f32 v83, v83, v20, v31
    v_fma_f32 v32, v80, v80, s86
    v_fma_f32 v33, v81, v81, s87
    v_lshl_add_u32 v13, v14, 4, v13
    v_fma_f32 v34, v82, v82, s86
    v_fma_f32 v35, v83, v83, s87
    v_mul_f32_e64 v32, v32, -v80
    v_add_u32 v13, s19, v13
    v_mul_f32_e64 v33, v33, -v81
    v_mul_f32_e64 v34, v34, -v82
    v_mul_f32_e64 v35, v35, -v83
    s_waitcnt vmcnt(2)
    v_exp_f32 v32, v32
    v_exp_f32 v33, v33
    v_exp_f32 v34, v34
    ds_read_b64_tr_b16 v[56:57], v13 offset:0
    v_exp_f32 v35, v35
    v_fma_f32 v32, v32, s98, s98
    v_fma_f32 v33, v33, s99, s99
    ds_read_b64_tr_b16 v[58:59], v13 offset:2048
    v_fma_f32 v34, v34, s98, s98
    v_fma_f32 v35, v35, s99, s99
    v_rcp_f32 v32, v32
    ds_read_b64_tr_b16 v[60:61], v13 offset:8
    v_rcp_f32 v33, v33
    v_rcp_f32 v34, v34
    v_rcp_f32 v35, v35
    ds_read_b64_tr_b16 v[62:63], v13 offset:2056
    v_mul_f32_e64 v80, v80, v32
    v_mul_f32_e64 v81, v81, v33
    v_mul_f32_e64 v82, v82, v34
    ds_read_b64_tr_b16 v[72:73], v13 offset:64
    v_mul_f32_e64 v83, v83, v35
    v_cvt_pk_bf16_f32 v80, v80, v81
    v_cvt_pk_bf16_f32 v81, v82, v83
    v_mov_b32 v32, v23
    v_pk_fma_f32 v[28:29], v[36:37], v[32:33], v[40:41] op_sel:[0,0,0] op_sel_hi:[1,0,1] neg_lo:[0,1,0] neg_hi:[0,1,0]
    ds_read_b64_tr_b16 v[74:75], v13 offset:2112
    v_pk_fma_f32 v[30:31], v[38:39], v[32:33], v[42:43] op_sel:[0,0,0] op_sel_hi:[1,0,1] neg_lo:[0,1,0] neg_hi:[0,1,0]
    v_pk_fma_f32 v[84:85], v[84:85], v[22:23], v[28:29] op_sel:[0,0,0] op_sel_hi:[1,0,1]
    v_pk_fma_f32 v[86:87], v[86:87], v[22:23], v[30:31] op_sel:[0,0,0] op_sel_hi:[1,0,1]
    ds_read_b64_tr_b16 v[76:77], v13 offset:72
    v_pk_fma_f32 v[32:33], v[84:85], v[84:85], s[86:87]
    v_pk_fma_f32 v[34:35], v[86:87], v[86:87], s[86:87]
    v_pk_mul_f32 v[32:33], v[32:33], v[84:85] neg_lo:[0,1] neg_hi:[0,1]
    ds_read_b64_tr_b16 v[78:79], v13 offset:2120
    v_pk_mul_f32 v[34:35], v[34:35], v[86:87] neg_lo:[0,1] neg_hi:[0,1]
    v_exp_f32 v32, v32
    v_exp_f32 v33, v33
    s_waitcnt lgkmcnt(6)
    v_exp_f32 v34, v34
    v_exp_f32 v35, v35
    v_pk_fma_f32 v[32:33], v[32:33], s[98:99], s[98:99]
    buffer_store_dwordx4 v[56:59], v0, s[68:71], s36 offen sc1
    v_pk_fma_f32 v[34:35], v[34:35], s[98:99], s[98:99]
    v_rcp_f32 v32, v32
    v_rcp_f32 v33, v33
    s_waitcnt lgkmcnt(4)
    v_rcp_f32 v34, v34
    v_rcp_f32 v35, v35
    v_pk_mul_f32 v[84:85], v[84:85], v[32:33]
    buffer_store_dwordx4 v[60:63], v0, s[68:71], s37 offen sc1
    v_pk_mul_f32 v[86:87], v[86:87], v[34:35]
    v_cvt_pk_bf16_f32 v84, v84, v85
    v_cvt_pk_bf16_f32 v85, v86, v87
    v_lshrrev_b32 v4, 8, v0
    v_lshl_add_u32 v4, v4, 4, s59
    ds_read_b128 v[36:39], v4 offset:2560
    ds_read_b128 v[40:43], v4 offset:2624
    ds_read_b128 v[68:71], v4 offset:2688
    ds_read_b128 v[52:55], v4 offset:2752
    v_mov_b32 v32, v21
    v_pk_fma_f32 v[28:29], v[44:45], v[32:33], v[48:49] op_sel:[0,0,0] op_sel_hi:[1,0,1] neg_lo:[0,1,0] neg_hi:[0,1,0]
    s_waitcnt lgkmcnt(6)
    v_pk_fma_f32 v[30:31], v[46:47], v[32:33], v[50:51] op_sel:[0,0,0] op_sel_hi:[1,0,1] neg_lo:[0,1,0] neg_hi:[0,1,0]
    v_pk_fma_f32 v[88:89], v[88:89], v[20:21], v[28:29] op_sel:[0,0,0] op_sel_hi:[1,0,1]
    v_pk_fma_f32 v[90:91], v[90:91], v[20:21], v[30:31] op_sel:[0,0,0] op_sel_hi:[1,0,1]
    buffer_store_dwordx4 v[72:75], v0, s[68:71], s38 offen sc1
    v_pk_fma_f32 v[32:33], v[88:89], v[88:89], s[86:87]
    v_pk_fma_f32 v[34:35], v[90:91], v[90:91], s[86:87]
    v_pk_mul_f32 v[32:33], v[32:33], v[88:89] neg_lo:[0,1] neg_hi:[0,1]
    s_waitcnt lgkmcnt(4)
    v_pk_mul_f32 v[34:35], v[34:35], v[90:91] neg_lo:[0,1] neg_hi:[0,1]
    v_exp_f32 v32, v32
    v_exp_f32 v33, v33
    buffer_store_dwordx4 v[76:79], v0, s[68:71], s39 offen sc1
    v_exp_f32 v34, v34
    v_exp_f32 v35, v35
    v_pk_fma_f32 v[32:33], v[32:33], s[98:99], s[98:99]
    v_pk_fma_f32 v[34:35], v[34:35], s[98:99], s[98:99]
    v_rcp_f32 v32, v32
    v_rcp_f32 v33, v33
    v_rcp_f32 v34, v34
    v_rcp_f32 v35, v35
    v_pk_mul_f32 v[88:89], v[88:89], v[32:33]
    v_pk_mul_f32 v[90:91], v[90:91], v[34:35]
    v_cvt_pk_bf16_f32 v82, v88, v89
    v_cvt_pk_bf16_f32 v83, v90, v91
    s_mov_b64 exec, s[100:101]
    v_swap_b32 v80, v82
    v_swap_b32 v81, v83
    s_mov_b64 exec, -1
    s_xor_b32 s60, s57, 1024
    s_add_u32 s60, s41, s60
    buffer_store_dwordx4 v[80:83], v0, s[32:35], s60 offen sc1
    v_mov_b32 v32, v23
    v_pk_fma_f32 v[28:29], v[44:45], v[32:33], v[48:49] op_sel:[0,0,0] op_sel_hi:[1,0,1] neg_lo:[0,1,0] neg_hi:[0,1,0]
    v_pk_fma_f32 v[30:31], v[46:47], v[32:33], v[50:51] op_sel:[0,0,0] op_sel_hi:[1,0,1] neg_lo:[0,1,0] neg_hi:[0,1,0]
    v_pk_fma_f32 v[92:93], v[92:93], v[22:23], v[28:29] op_sel:[0,0,0] op_sel_hi:[1,0,1]
    v_pk_fma_f32 v[94:95], v[94:95], v[22:23], v[30:31] op_sel:[0,0,0] op_sel_hi:[1,0,1]
    v_pk_fma_f32 v[32:33], v[92:93], v[92:93], s[86:87]
    v_pk_fma_f32 v[34:35], v[94:95], v[94:95], s[86:87]
    v_pk_mul_f32 v[32:33], v[32:33], v[92:93] neg_lo:[0,1] neg_hi:[0,1]
    v_pk_mul_f32 v[34:35], v[34:35], v[94:95] neg_lo:[0,1] neg_hi:[0,1]
    v_exp_f32 v32, v32
    v_exp_f32 v33, v33
    v_exp_f32 v34, v34
    v_exp_f32 v35, v35
    v_pk_fma_f32 v[32:33], v[32:33], s[98:99], s[98:99]
    v_pk_fma_f32 v[34:35], v[34:35], s[98:99], s[98:99]
    v_rcp_f32 v32, v32
    v_rcp_f32 v33, v33
    v_rcp_f32 v34, v34
    v_rcp_f32 v35, v35
    v_pk_mul_f32 v[92:93], v[92:93], v[32:33]
    v_pk_mul_f32 v[94:95], v[94:95], v[34:35]
    v_cvt_pk_bf16_f32 v86, v92, v93
    v_cvt_pk_bf16_f32 v87, v94, v95
    s_mov_b64 exec, s[100:101]
    v_swap_b32 v84, v86
    v_swap_b32 v85, v87
    s_mov_b64 exec, -1
    s_xor_b32 s60, s57, 1024
    s_add_u32 s60, s42, s60
    buffer_store_dwordx4 v[84:87], v0, s[32:35], s60 offen sc1
    v_lshrrev_b32 v9, 9, v0
    v_add_u32 v9, s91, v9
    v_mul_u32_u24 v10, 205, v9
    v_lshrrev_b32 v10, 10, v10
    v_mul_u32_u24 v11, 5, v10
    v_sub_u32 v9, v9, v11
    v_cmp_eq_u32 vcc, 4, v9
    v_and_b32 v11, 3, v10
    s_nop 0
    v_cndmask_b32 v9, v9, v11, vcc
    v_lshrrev_b32 v11, 2, v10
    v_add_u32 v11, 16, v11
    v_cndmask_b32 v10, v10, v11, vcc
    v_and_b32 v11, 0x1f0, v0
    v_lshl_add_u32 v10, v10, 10, v11
    v_and_b32 v11, 1, v9
    v_lshl_add_u32 v10, v11, 9, v10
    v_lshrrev_b32 v9, 1, v9
    v_lshl_add_u32 v9, v9, 3, v10
    s_waitcnt lgkmcnt(0)
    v_pk_add_f32 v[36:37], v[36:37], v[40:41]
    v_pk_add_f32 v[52:53], v[52:53], v[68:69]
    v_pk_add_f32 v[38:39], v[38:39], v[42:43]
    v_pk_add_f32 v[54:55], v[54:55], v[70:71]
    v_pk_add_f32 v[36:37], v[36:37], v[52:53]
    v_pk_add_f32 v[38:39], v[38:39], v[54:55]
    v_mov_b32 v32, v25
    v_pk_fma_f32 v[28:29], v[36:37], v[32:33], s[82:83] op_sel:[0,0,0] op_sel_hi:[1,0,1] neg_lo:[0,1,0] neg_hi:[0,1,0]
    v_pk_fma_f32 v[30:31], v[38:39], v[32:33], s[82:83] op_sel:[0,0,0] op_sel_hi:[1,0,1] neg_lo:[0,1,0] neg_hi:[0,1,0]
    v_pk_fma_f32 v[64:65], v[64:65], v[24:25], v[28:29] op_sel:[0,0,0] op_sel_hi:[1,0,1]
    v_pk_fma_f32 v[66:67], v[66:67], v[24:25], v[30:31] op_sel:[0,0,0] op_sel_hi:[1,0,1]
    v_exp_f32_e64 v32, v64 clamp
    v_exp_f32_e64 v33, v65 clamp
    v_max_f32 v64, s82, v64
    v_max_f32 v65, s82, v65
    v_pk_fma_f32 v[64:65], v[64:65], s[84:85], v[32:33]
    v_exp_f32_e64 v34, v66 clamp
    v_exp_f32_e64 v35, v67 clamp
    v_max_f32 v66, s82, v66
    v_max_f32 v67, s82, v67
    v_pk_fma_f32 v[66:67], v[66:67], s[84:85], v[34:35]
    v_cvt_pk_bf16_f32 v24, v64, v65
    v_cvt_pk_bf16_f32 v25, v66, v67
    s_add_u32 s60, s41, 49152
    buffer_store_dwordx2 v[24:25], v9, s[32:35], s60 offen sc1
    v_lshrrev_b32 v5, 6, v0
    v_lshlrev_b32 v5, 7, v5
    v_bfe_u32 v6, v0, 4, 2
    v_lshl_add_u32 v5, v6, 3, v5
    v_bfe_u32 v6, v0, 7, 2
    v_lshl_add_u32 v5, v6, 5, v5
    v_xor_b32 v5, s14, v5
    v_xor_b32 v6, 32, v5
    v_add_u32 v7, 81920, v5
    v_add_u32 v8, 81920, v6
    ds_read_b64_tr_b16 v[64:65], v5 offset:32768
    ds_read_b64_tr_b16 v[66:67], v5 offset:34816
    ds_read_b64_tr_b16 v[68:69], v5 offset:36864
    ds_read_b64_tr_b16 v[70:71], v5 offset:38912
    ds_read_b64_tr_b16 v[28:29], v5 offset:40960
    ds_read_b64_tr_b16 v[30:31], v5 offset:43008
    ds_read_b64_tr_b16 v[32:33], v5 offset:45056
    ds_read_b64_tr_b16 v[34:35], v5 offset:47104
    ds_read_b64_tr_b16 v[56:57], v7 offset:28672
    s_waitcnt lgkmcnt(7)
    v_mfma_f32_16x16x32_bf16 v[40:43], v[64:67], v[96:99], 0
    ds_read_b64_tr_b16 v[58:59], v7 offset:30720
    ds_read_b64_tr_b16 v[60:61], v7 offset:32768
    v_bfe_u32 v4, v0, 4, 4
    v_lshl_add_u32 v1, v4, 2, s56
    v_mfma_f32_16x16x32_bf16 v[44:47], v[64:67], v[176:179], 0
    ds_read_b64_tr_b16 v[62:63], v7 offset:34816
    ds_read_b64_tr_b16 v[72:73], v7 offset:36864
    v_xor_b32 v2, 64, v1
    v_lshrrev_b32 v3, 8, v0
    s_waitcnt lgkmcnt(9)
    v_mfma_f32_16x16x32_bf16 v[40:43], v[68:71], v[100:103], v[40:43]
    ds_read_b64_tr_b16 v[74:75], v7 offset:38912
    ds_read_b64_tr_b16 v[76:77], v7 offset:40960
    s_lshl_b32 s60, s14, 2
    s_add_u32 s60, s60, s59
    v_mfma_f32_16x16x32_bf16 v[44:47], v[68:71], v[180:183], v[44:47]
    ds_read_b64_tr_b16 v[78:79], v7 offset:43008
    ds_read_b64_tr_b16 v[80:81], v5 offset:49152
    v_lshl_add_u32 v3, v3, 4, s60
    v_xor_b32 v4, 128, v3
    s_waitcnt lgkmcnt(11)
    v_mfma_f32_16x16x32_bf16 v[40:43], v[28:31], v[104:107], v[40:43]
    ds_read_b64_tr_b16 v[82:83], v5 offset:51200
    v_lshrrev_b32 v10, 8, v0
    s_lshl_b32 s60, s14, 1
    v_mfma_f32_16x16x32_bf16 v[44:47], v[28:31], v[184:187], v[44:47]
    ds_read_b64_tr_b16 v[84:85], v5 offset:53248
    s_add_u32 s60, s60, s59
    v_lshl_add_u32 v10, v10, 4, s60
    s_waitcnt lgkmcnt(11)
    v_mfma_f32_16x16x32_bf16 v[40:43], v[32:35], v[108:111], v[40:43]
    ds_read_b64_tr_b16 v[86:87], v5 offset:55296
    v_xor_b32 v11, 64, v10
    ds_read2st64_b32 v[20:21], v1 offset0:4 offset1:6
    v_mfma_f32_16x16x32_bf16 v[44:47], v[32:35], v[188:191], v[44:47]
    ds_read_b64_tr_b16 v[88:89], v5 offset:57344
    ds_read2st64_b32 v[22:23], v2 offset0:4 offset1:6
    ds_read_b128 v[24:27], v10 offset:5120
    s_waitcnt lgkmcnt(14)
    v_mfma_f32_16x16x32_bf16 v[40:43], v[56:59], v[112:115], v[40:43]
    ds_read_b64_tr_b16 v[90:91], v5 offset:59392
    ds_read_b128 v[36:39], v11 offset:5120
    v_mfma_f32_16x16x32_bf16 v[44:47], v[56:59], v[192:195], v[44:47]
    ds_read_b64_tr_b16 v[92:93], v5 offset:61440
    s_waitcnt lgkmcnt(15)
    v_mfma_f32_16x16x32_bf16 v[40:43], v[60:63], v[116:119], v[40:43]
    ds_read_b64_tr_b16 v[94:95], v5 offset:63488
    v_mfma_f32_16x16x32_bf16 v[44:47], v[60:63], v[196:199], v[44:47]
    ds_read_b64_tr_b16 v[64:65], v7 offset:45056
    s_waitcnt lgkmcnt(15)
    v_mfma_f32_16x16x32_bf16 v[40:43], v[72:75], v[120:123], v[40:43]
    ds_read_b64_tr_b16 v[66:67], v7 offset:47104
    v_mfma_f32_16x16x32_bf16 v[44:47], v[72:75], v[200:203], v[44:47]
    ds_read_b64_tr_b16 v[68:69], v7 offset:49152
    s_waitcnt lgkmcnt(15)
    v_mfma_f32_16x16x32_bf16 v[40:43], v[76:79], v[124:127], v[40:43]
    ds_read_b64_tr_b16 v[70:71], v7 offset:51200
    v_mfma_f32_16x16x32_bf16 v[44:47], v[76:79], v[204:207], v[44:47]
    ds_read_b64_tr_b16 v[28:29], v7 offset:53248
    s_waitcnt lgkmcnt(15)
    v_mfma_f32_16x16x32_bf16 v[40:43], v[80:83], v[128:131], v[40:43]
    ds_read_b64_tr_b16 v[30:31], v7 offset:55296
    v_mfma_f32_16x16x32_bf16 v[44:47], v[80:83], v[208:211], v[44:47]
    ds_read_b64_tr_b16 v[32:33], v7 offset:57344
    s_waitcnt lgkmcnt(15)
    v_mfma_f32_16x16x32_bf16 v[40:43], v[84:87], v[132:135], v[40:43]
    ds_read_b64_tr_b16 v[34:35], v7 offset:59392
    v_mfma_f32_16x16x32_bf16 v[44:47], v[84:87], v[212:215], v[44:47]
    ds_read_b64_tr_b16 v[56:57], v5 offset:0
    s_waitcnt lgkmcnt(12)
    v_mfma_f32_16x16x32_bf16 v[40:43], v[88:91], v[136:139], v[40:43]
    ds_read_b64_tr_b16 v[58:59], v5 offset:2048
    v_mfma_f32_16x16x32_bf16 v[44:47], v[88:91], v[216:219], v[44:47]
    ds_read_b64_tr_b16 v[60:61], v5 offset:4096
    s_waitcnt lgkmcnt(11)
    v_mfma_f32_16x16x32_bf16 v[40:43], v[92:95], v[140:143], v[40:43]
    ds_read_b64_tr_b16 v[62:63], v5 offset:6144
    v_mfma_f32_16x16x32_bf16 v[44:47], v[92:95], v[220:223], v[44:47]
    ds_read_b64_tr_b16 v[72:73], v5 offset:8192
    s_waitcnt lgkmcnt(11)
    v_mfma_f32_16x16x32_bf16 v[40:43], v[64:67], v[144:147], v[40:43]
    ds_read_b64_tr_b16 v[74:75], v5 offset:10240
    v_mfma_f32_16x16x32_bf16 v[44:47], v[64:67], v[224:227], v[44:47]
    ds_read_b64_tr_b16 v[76:77], v5 offset:12288
    s_waitcnt lgkmcnt(11)
    v_mfma_f32_16x16x32_bf16 v[40:43], v[68:71], v[148:151], v[40:43]
    ds_read_b64_tr_b16 v[78:79], v5 offset:14336
    v_mfma_f32_16x16x32_bf16 v[44:47], v[68:71], v[228:231], v[44:47]
    ds_read_b64_tr_b16 v[80:81], v6 offset:32768
    s_waitcnt lgkmcnt(11)
    v_mfma_f32_16x16x32_bf16 v[40:43], v[28:31], v[152:155], v[40:43]
    ds_read_b64_tr_b16 v[82:83], v6 offset:34816
    v_mfma_f32_16x16x32_bf16 v[44:47], v[28:31], v[232:235], v[44:47]
    ds_read_b64_tr_b16 v[84:85], v6 offset:36864
    s_waitcnt lgkmcnt(11)
    v_mfma_f32_16x16x32_bf16 v[40:43], v[32:35], v[156:159], v[40:43]
    ds_read_b64_tr_b16 v[86:87], v6 offset:38912
    v_mfma_f32_16x16x32_bf16 v[44:47], v[32:35], v[236:239], v[44:47]
    ds_read_b64_tr_b16 v[88:89], v6 offset:40960
    s_waitcnt lgkmcnt(11)
    v_mfma_f32_16x16x32_bf16 v[40:43], v[56:59], v[160:163], v[40:43]
    ds_read_b64_tr_b16 v[90:91], v6 offset:43008
    v_mfma_f32_16x16x32_bf16 v[44:47], v[56:59], v[240:243], v[44:47]
    ds_read_b64_tr_b16 v[92:93], v6 offset:45056
    s_waitcnt lgkmcnt(11)
    v_mfma_f32_16x16x32_bf16 v[40:43], v[60:63], v[164:167], v[40:43]
    ds_read_b64_tr_b16 v[94:95], v6 offset:47104
    v_mfma_f32_16x16x32_bf16 v[44:47], v[60:63], v[244:247], v[44:47]
    ds_read_b64_tr_b16 v[64:65], v8 offset:28672
    s_waitcnt lgkmcnt(11)
    v_mfma_f32_16x16x32_bf16 v[40:43], v[72:75], v[168:171], v[40:43]
    ds_read_b64_tr_b16 v[66:67], v8 offset:30720
    v_mfma_f32_16x16x32_bf16 v[44:47], v[72:75], v[248:251], v[44:47]
    ds_read_b64_tr_b16 v[68:69], v8 offset:32768
    s_waitcnt lgkmcnt(11)
    v_mfma_f32_16x16x32_bf16 v[40:43], v[76:79], v[172:175], v[40:43]
    ds_read_b64_tr_b16 v[70:71], v8 offset:34816
    v_mfma_f32_16x16x32_bf16 v[44:47], v[76:79], v[252:255], v[44:47]
    ds_read_b64_tr_b16 v[28:29], v8 offset:36864
    s_waitcnt lgkmcnt(11)
    v_mfma_f32_16x16x32_bf16 v[48:51], v[80:83], v[96:99], 0
    ds_read_b64_tr_b16 v[30:31], v8 offset:38912
    v_mfma_f32_16x16x32_bf16 v[52:55], v[80:83], v[176:179], 0
    ds_read_b64_tr_b16 v[32:33], v8 offset:40960
    s_waitcnt lgkmcnt(11)
    v_mfma_f32_16x16x32_bf16 v[48:51], v[84:87], v[100:103], v[48:51]
    ds_read_b64_tr_b16 v[34:35], v8 offset:43008
    v_mfma_f32_16x16x32_bf16 v[52:55], v[84:87], v[180:183], v[52:55]
    ds_read_b64_tr_b16 v[56:57], v6 offset:49152
    s_waitcnt lgkmcnt(11)
    v_mfma_f32_16x16x32_bf16 v[48:51], v[88:91], v[104:107], v[48:51]
    ds_read_b64_tr_b16 v[58:59], v6 offset:51200
    v_mfma_f32_16x16x32_bf16 v[52:55], v[88:91], v[184:187], v[52:55]
    ds_read_b64_tr_b16 v[60:61], v6 offset:53248
    s_waitcnt lgkmcnt(11)
    v_mfma_f32_16x16x32_bf16 v[48:51], v[92:95], v[108:111], v[48:51]
    ds_read_b64_tr_b16 v[62:63], v6 offset:55296
    v_mfma_f32_16x16x32_bf16 v[52:55], v[92:95], v[188:191], v[52:55]
    ds_read_b64_tr_b16 v[72:73], v6 offset:57344
    s_waitcnt lgkmcnt(11)
    v_mfma_f32_16x16x32_bf16 v[48:51], v[64:67], v[112:115], v[48:51]
    ds_read_b64_tr_b16 v[74:75], v6 offset:59392
    v_mfma_f32_16x16x32_bf16 v[52:55], v[64:67], v[192:195], v[52:55]
    ds_read_b64_tr_b16 v[76:77], v6 offset:61440
    s_waitcnt lgkmcnt(11)
    v_mfma_f32_16x16x32_bf16 v[48:51], v[68:71], v[116:119], v[48:51]
    ds_read_b64_tr_b16 v[78:79], v6 offset:63488
    v_mfma_f32_16x16x32_bf16 v[52:55], v[68:71], v[196:199], v[52:55]
    ds_read_b64_tr_b16 v[80:81], v8 offset:45056
    s_waitcnt lgkmcnt(11)
    v_mfma_f32_16x16x32_bf16 v[48:51], v[28:31], v[120:123], v[48:51]
    ds_read_b64_tr_b16 v[82:83], v8 offset:47104
    v_mfma_f32_16x16x32_bf16 v[52:55], v[28:31], v[200:203], v[52:55]
    ds_read_b64_tr_b16 v[96:97], v8 offset:49152
    s_waitcnt lgkmcnt(11)
    v_mfma_f32_16x16x32_bf16 v[48:51], v[32:35], v[124:127], v[48:51]
    ds_read_b64_tr_b16 v[98:99], v8 offset:51200
    v_mfma_f32_16x16x32_bf16 v[52:55], v[32:35], v[204:207], v[52:55]
    ds_read_b64_tr_b16 v[64:65], v8 offset:53248
    s_waitcnt lgkmcnt(11)
    v_mfma_f32_16x16x32_bf16 v[48:51], v[56:59], v[128:131], v[48:51]
    ds_read_b64_tr_b16 v[66:67], v8 offset:55296
    v_mfma_f32_16x16x32_bf16 v[52:55], v[56:59], v[208:211], v[52:55]
    ds_read_b64_tr_b16 v[68:69], v8 offset:57344
    s_waitcnt lgkmcnt(11)
    v_mfma_f32_16x16x32_bf16 v[48:51], v[60:63], v[132:135], v[48:51]
    ds_read_b64_tr_b16 v[70:71], v8 offset:59392
    v_mfma_f32_16x16x32_bf16 v[52:55], v[60:63], v[212:215], v[52:55]
    ds_read_b64_tr_b16 v[124:125], v6 offset:0
    s_waitcnt lgkmcnt(11)
    v_mfma_f32_16x16x32_bf16 v[48:51], v[72:75], v[136:139], v[48:51]
    ds_read_b64_tr_b16 v[126:127], v6 offset:2048
    v_mfma_f32_16x16x32_bf16 v[52:55], v[72:75], v[216:219], v[52:55]
    ds_read_b64_tr_b16 v[204:205], v6 offset:4096
    s_waitcnt lgkmcnt(11)
    v_mfma_f32_16x16x32_bf16 v[48:51], v[76:79], v[140:143], v[48:51]
    ds_read_b64_tr_b16 v[206:207], v6 offset:6144
    v_mfma_f32_16x16x32_bf16 v[52:55], v[76:79], v[220:223], v[52:55]
    ds_read_b64_tr_b16 v[56:57], v6 offset:8192
    s_waitcnt lgkmcnt(11)
    v_mfma_f32_16x16x32_bf16 v[48:51], v[80:83], v[144:147], v[48:51]
    ds_read_b64_tr_b16 v[58:59], v6 offset:10240
    v_mfma_f32_16x16x32_bf16 v[52:55], v[80:83], v[224:227], v[52:55]
    ds_read_b64_tr_b16 v[128:129], v6 offset:12288
    s_waitcnt lgkmcnt(11)
    v_mfma_f32_16x16x32_bf16 v[48:51], v[96:99], v[148:151], v[48:51]
    ds_read_b64_tr_b16 v[130:131], v6 offset:14336
    v_mfma_f32_16x16x32_bf16 v[52:55], v[96:99], v[228:231], v[52:55]
    s_waitcnt lgkmcnt(10)
    v_mfma_f32_16x16x32_bf16 v[48:51], v[64:67], v[152:155], v[48:51]
    v_mfma_f32_16x16x32_bf16 v[52:55], v[64:67], v[232:235], v[52:55]
    s_waitcnt lgkmcnt(0)
    s_barrier
    v_mfma_f32_16x16x32_bf16 v[48:51], v[68:71], v[156:159], v[48:51]
    ds_read_b128 v[80:83], v3 offset:4096
    ds_read_b128 v[84:87], v3 offset:4160
    v_mfma_f32_16x16x32_bf16 v[52:55], v[68:71], v[236:239], v[52:55]
    ds_read_b128 v[88:91], v4 offset:4096
    ds_read_b128 v[92:95], v4 offset:4160
    v_mfma_f32_16x16x32_bf16 v[48:51], v[124:127], v[160:163], v[48:51]
    v_mfma_f32_16x16x32_bf16 v[52:55], v[124:127], v[240:243], v[52:55]
    v_mfma_f32_16x16x32_bf16 v[48:51], v[204:207], v[164:167], v[48:51]
    v_mfma_f32_16x16x32_bf16 v[52:55], v[204:207], v[244:247], v[52:55]
    v_mfma_f32_16x16x32_bf16 v[48:51], v[56:59], v[168:171], v[48:51]
    v_mfma_f32_16x16x32_bf16 v[52:55], v[56:59], v[248:251], v[52:55]
    v_mfma_f32_16x16x32_bf16 v[48:51], v[128:131], v[172:175], v[48:51]
    v_mfma_f32_16x16x32_bf16 v[52:55], v[128:131], v[252:255], v[52:55]
    s_waitcnt lgkmcnt(2)
    v_pk_add_f32 v[80:81], v[80:81], v[84:85]
    v_pk_add_f32 v[82:83], v[82:83], v[86:87]
    v_mov_b32 v32, v21
    v_pk_fma_f32 v[28:29], v[80:81], v[32:33], v[24:25] op_sel:[0,0,0] op_sel_hi:[1,0,1] neg_lo:[0,1,0] neg_hi:[0,1,0]
    v_pk_fma_f32 v[30:31], v[82:83], v[32:33], v[26:27] op_sel:[0,0,0] op_sel_hi:[1,0,1] neg_lo:[0,1,0] neg_hi:[0,1,0]
    v_pk_fma_f32 v[40:41], v[40:41], v[20:21], v[28:29] op_sel:[0,0,0] op_sel_hi:[1,0,1]
    v_pk_fma_f32 v[42:43], v[42:43], v[20:21], v[30:31] op_sel:[0,0,0] op_sel_hi:[1,0,1]
    v_pk_fma_f32 v[32:33], v[40:41], v[40:41], s[86:87]
    v_pk_fma_f32 v[34:35], v[42:43], v[42:43], s[86:87]
    v_pk_mul_f32 v[32:33], v[32:33], v[40:41] neg_lo:[0,1] neg_hi:[0,1]
    v_pk_mul_f32 v[34:35], v[34:35], v[42:43] neg_lo:[0,1] neg_hi:[0,1]
    v_exp_f32 v32, v32
    v_exp_f32 v33, v33
    v_exp_f32 v34, v34
    v_exp_f32 v35, v35
    v_pk_fma_f32 v[32:33], v[32:33], s[98:99], s[98:99]
    v_pk_fma_f32 v[34:35], v[34:35], s[98:99], s[98:99]
    v_rcp_f32 v32, v32
    v_rcp_f32 v33, v33
    v_rcp_f32 v34, v34
    v_rcp_f32 v35, v35
    v_pk_mul_f32 v[40:41], v[40:41], v[32:33]
    v_pk_mul_f32 v[42:43], v[42:43], v[34:35]
    v_cvt_pk_bf16_f32 v40, v40, v41
    v_cvt_pk_bf16_f32 v41, v42, v43
    v_mov_b32 v32, v23
    v_pk_fma_f32 v[28:29], v[80:81], v[32:33], v[24:25] op_sel:[0,0,0] op_sel_hi:[1,0,1] neg_lo:[0,1,0] neg_hi:[0,1,0]
    v_pk_fma_f32 v[30:31], v[82:83], v[32:33], v[26:27] op_sel:[0,0,0] op_sel_hi:[1,0,1] neg_lo:[0,1,0] neg_hi:[0,1,0]
    v_pk_fma_f32 v[44:45], v[44:45], v[22:23], v[28:29] op_sel:[0,0,0] op_sel_hi:[1,0,1]
    v_pk_fma_f32 v[46:47], v[46:47], v[22:23], v[30:31] op_sel:[0,0,0] op_sel_hi:[1,0,1]
    v_pk_fma_f32 v[32:33], v[44:45], v[44:45], s[86:87]
    v_pk_fma_f32 v[34:35], v[46:47], v[46:47], s[86:87]
    v_pk_mul_f32 v[32:33], v[32:33], v[44:45] neg_lo:[0,1] neg_hi:[0,1]
    v_pk_mul_f32 v[34:35], v[34:35], v[46:47] neg_lo:[0,1] neg_hi:[0,1]
    v_exp_f32 v32, v32
    v_exp_f32 v33, v33
    v_exp_f32 v34, v34
    v_exp_f32 v35, v35
    v_pk_fma_f32 v[32:33], v[32:33], s[98:99], s[98:99]
    v_pk_fma_f32 v[34:35], v[34:35], s[98:99], s[98:99]
    v_rcp_f32 v32, v32
    v_rcp_f32 v33, v33
    v_rcp_f32 v34, v34
    v_rcp_f32 v35, v35
    v_pk_mul_f32 v[44:45], v[44:45], v[32:33]
    v_pk_mul_f32 v[46:47], v[46:47], v[34:35]
    v_cvt_pk_bf16_f32 v44, v44, v45
    v_cvt_pk_bf16_f32 v45, v46, v47
    s_waitcnt lgkmcnt(0)
    v_pk_add_f32 v[88:89], v[88:89], v[92:93]
    v_pk_add_f32 v[90:91], v[90:91], v[94:95]
    v_mov_b32 v32, v21
    v_pk_fma_f32 v[28:29], v[88:89], v[32:33], v[36:37] op_sel:[0,0,0] op_sel_hi:[1,0,1] neg_lo:[0,1,0] neg_hi:[0,1,0]
    v_pk_fma_f32 v[30:31], v[90:91], v[32:33], v[38:39] op_sel:[0,0,0] op_sel_hi:[1,0,1] neg_lo:[0,1,0] neg_hi:[0,1,0]
    v_pk_fma_f32 v[48:49], v[48:49], v[20:21], v[28:29] op_sel:[0,0,0] op_sel_hi:[1,0,1]
    v_pk_fma_f32 v[50:51], v[50:51], v[20:21], v[30:31] op_sel:[0,0,0] op_sel_hi:[1,0,1]
    v_pk_fma_f32 v[32:33], v[48:49], v[48:49], s[86:87]
    v_pk_fma_f32 v[34:35], v[50:51], v[50:51], s[86:87]
    v_pk_mul_f32 v[32:33], v[32:33], v[48:49] neg_lo:[0,1] neg_hi:[0,1]
    v_pk_mul_f32 v[34:35], v[34:35], v[50:51] neg_lo:[0,1] neg_hi:[0,1]
    v_exp_f32 v32, v32
    v_exp_f32 v33, v33
    v_exp_f32 v34, v34
    v_exp_f32 v35, v35
    v_pk_fma_f32 v[32:33], v[32:33], s[98:99], s[98:99]
    v_pk_fma_f32 v[34:35], v[34:35], s[98:99], s[98:99]
    v_rcp_f32 v32, v32
    v_rcp_f32 v33, v33
    v_rcp_f32 v34, v34
    v_rcp_f32 v35, v35
    v_pk_mul_f32 v[48:49], v[48:49], v[32:33]
    v_pk_mul_f32 v[50:51], v[50:51], v[34:35]
    v_cvt_pk_bf16_f32 v42, v48, v49
    v_cvt_pk_bf16_f32 v43, v50, v51
    s_mov_b64 exec, s[52:53]
    v_swap_b32 v40, v42
    v_swap_b32 v41, v43
    s_mov_b64 exec, -1
    s_add_u32 s60, s41, s54
    buffer_store_dwordx4 v[40:43], v0, s[32:35], s60 offen sc1
    v_mov_b32 v32, v23
    v_pk_fma_f32 v[28:29], v[88:89], v[32:33], v[36:37] op_sel:[0,0,0] op_sel_hi:[1,0,1] neg_lo:[0,1,0] neg_hi:[0,1,0]
    v_pk_fma_f32 v[30:31], v[90:91], v[32:33], v[38:39] op_sel:[0,0,0] op_sel_hi:[1,0,1] neg_lo:[0,1,0] neg_hi:[0,1,0]
    v_pk_fma_f32 v[52:53], v[52:53], v[22:23], v[28:29] op_sel:[0,0,0] op_sel_hi:[1,0,1]
    v_pk_fma_f32 v[54:55], v[54:55], v[22:23], v[30:31] op_sel:[0,0,0] op_sel_hi:[1,0,1]
    v_pk_fma_f32 v[32:33], v[52:53], v[52:53], s[86:87]
    v_pk_fma_f32 v[34:35], v[54:55], v[54:55], s[86:87]
    v_pk_mul_f32 v[32:33], v[32:33], v[52:53] neg_lo:[0,1] neg_hi:[0,1]
    v_pk_mul_f32 v[34:35], v[34:35], v[54:55] neg_lo:[0,1] neg_hi:[0,1]
    v_exp_f32 v32, v32
    v_exp_f32 v33, v33
    v_exp_f32 v34, v34
    v_exp_f32 v35, v35
    v_pk_fma_f32 v[32:33], v[32:33], s[98:99], s[98:99]
    v_pk_fma_f32 v[34:35], v[34:35], s[98:99], s[98:99]
    v_rcp_f32 v32, v32
    v_rcp_f32 v33, v33
    v_rcp_f32 v34, v34
    v_rcp_f32 v35, v35
    v_pk_mul_f32 v[52:53], v[52:53], v[32:33]
    v_pk_mul_f32 v[54:55], v[54:55], v[34:35]
    v_cvt_pk_bf16_f32 v46, v52, v53
    v_cvt_pk_bf16_f32 v47, v54, v55
    s_mov_b64 exec, s[52:53]
    v_swap_b32 v44, v46
    v_swap_b32 v45, v47
    s_mov_b64 exec, -1
    s_add_u32 s60, s42, s54
    buffer_store_dwordx4 v[44:47], v0, s[32:35], s60 offen sc1
    s_endpgm
K1_G_B:
    v_lshrrev_b32 v5, 6, v0
    v_lshlrev_b32 v5, 7, v5
    v_bfe_u32 v6, v0, 4, 2
    v_lshl_add_u32 v5, v6, 3, v5
    v_bfe_u32 v6, v0, 7, 2
    v_lshl_add_u32 v5, v6, 5, v5
    v_xor_b32 v5, s14, v5
    v_xor_b32 v6, 32, v5
    ds_read_b64_tr_b16 v[20:21], v5 offset:32768
    ds_read_b64_tr_b16 v[22:23], v5 offset:34816
    ds_read_b64_tr_b16 v[24:25], v6 offset:32768
    ds_read_b64_tr_b16 v[26:27], v6 offset:34816
    ds_read_b64_tr_b16 v[28:29], v5 offset:36864
    ds_read_b64_tr_b16 v[30:31], v5 offset:38912
    ds_read_b64_tr_b16 v[32:33], v6 offset:36864
    ds_read_b64_tr_b16 v[34:35], v6 offset:38912
    v_mfma_f32_16x16x32_bf16 v[80:83], v[48:51], v[172:175], v[80:83]
    v_add_u32 v7, 81920, v5
    v_add_u32 v8, 81920, v6
    s_and_b32 s60, s50, 1
    v_mfma_f32_16x16x32_bf16 v[84:87], v[48:51], v[252:255], v[84:87]
    s_lshl_b32 s60, s60, 6
    s_xor_b32 s15, s14, s60
    v_xor_b32 v9, s60, v5
    v_mfma_f32_16x16x32_bf16 v[88:91], v[52:55], v[172:175], v[88:91]
    v_xor_b32 v10, 64, v9
    v_add_u32 v11, 81920, v9
    v_add_u32 v12, 81920, v10
    v_mfma_f32_16x16x32_bf16 v[92:95], v[52:55], v[252:255], v[92:95]
    s_waitcnt lgkmcnt(6)
    v_mfma_f32_16x16x32_bf16 v[40:43], v[20:23], v[96:99], 0
    ds_read_b64_tr_b16 v[36:37], v9 offset:32768
    ds_read_b64_tr_b16 v[38:39], v9 offset:34816
    v_mfma_f32_16x16x32_bf16 v[44:47], v[20:23], v[176:179], 0
    ds_read_b64_tr_b16 v[68:69], v5 offset:40960
    ds_read_b64_tr_b16 v[70:71], v5 offset:43008
    s_waitcnt lgkmcnt(8)
    v_mfma_f32_16x16x32_bf16 v[48:51], v[24:27], v[96:99], 0
    ds_read_b64_tr_b16 v[20:21], v6 offset:40960
    v_mfma_f32_16x16x32_bf16 v[52:55], v[24:27], v[176:179], 0
    ds_read_b64_tr_b16 v[22:23], v6 offset:43008
    ds_read_b64_tr_b16 v[24:25], v10 offset:36864
    s_waitcnt lgkmcnt(9)
    v_mfma_f32_16x16x32_bf16 v[40:43], v[28:31], v[100:103], v[40:43]
    ds_read_b64_tr_b16 v[26:27], v10 offset:38912
    v_mfma_f32_16x16x32_bf16 v[44:47], v[28:31], v[180:183], v[44:47]
    ds_read_b64_tr_b16 v[28:29], v5 offset:45056
    s_waitcnt lgkmcnt(9)
    v_mfma_f32_16x16x32_bf16 v[48:51], v[32:35], v[100:103], v[48:51]
    ds_read_b64_tr_b16 v[30:31], v5 offset:47104
    v_mfma_f32_16x16x32_bf16 v[52:55], v[32:35], v[180:183], v[52:55]
    ds_read_b64_tr_b16 v[32:33], v6 offset:45056
    ds_read_b64_tr_b16 v[34:35], v6 offset:47104
    s_waitcnt lgkmcnt(10)
    v_mfma_f32_16x16x32_bf16 v[96:99], v[16:19], v[36:39], 0
    ds_read_b64_tr_b16 v[180:181], v9 offset:40960
    ds_read_b64_tr_b16 v[182:183], v9 offset:43008
    s_waitcnt lgkmcnt(10)
    v_mfma_f32_16x16x32_bf16 v[40:43], v[68:71], v[104:107], v[40:43]
    ds_read_b64_tr_b16 v[36:37], v10 offset:45056
    v_mfma_f32_16x16x32_bf16 v[44:47], v[68:71], v[184:187], v[44:47]
    ds_read_b64_tr_b16 v[38:39], v10 offset:47104
    ds_read_b64_tr_b16 v[68:69], v11 offset:28672
    s_waitcnt lgkmcnt(11)
    v_mfma_f32_16x16x32_bf16 v[48:51], v[20:23], v[104:107], v[48:51]
    ds_read_b64_tr_b16 v[70:71], v11 offset:30720
    v_mfma_f32_16x16x32_bf16 v[52:55], v[20:23], v[184:187], v[52:55]
    ds_read_b64_tr_b16 v[20:21], v7 offset:28672
    ds_read_b64_tr_b16 v[22:23], v7 offset:30720
    s_waitcnt lgkmcnt(12)
    v_mfma_f32_16x16x32_bf16 v[176:179], v[16:19], v[24:27], 0
    ds_read_b64_tr_b16 v[104:105], v8 offset:28672
    ds_read_b64_tr_b16 v[106:107], v8 offset:30720
    s_waitcnt lgkmcnt(12)
    v_mfma_f32_16x16x32_bf16 v[40:43], v[28:31], v[108:111], v[40:43]
    ds_read_b64_tr_b16 v[24:25], v12 offset:32768
    v_mfma_f32_16x16x32_bf16 v[44:47], v[28:31], v[188:191], v[44:47]
    ds_read_b64_tr_b16 v[26:27], v12 offset:34816
    ds_read_b64_tr_b16 v[28:29], v7 offset:32768
    s_waitcnt lgkmcnt(13)
    v_mfma_f32_16x16x32_bf16 v[48:51], v[32:35], v[108:111], v[48:51]
    ds_read_b64_tr_b16 v[30:31], v7 offset:34816
    v_mfma_f32_16x16x32_bf16 v[52:55], v[32:35], v[188:191], v[52:55]
    ds_read_b64_tr_b16 v[32:33], v8 offset:32768
    s_waitcnt lgkmcnt(13)
    v_mfma_f32_16x16x32_bf16 v[96:99], v[16:19], v[180:183], v[96:99]
    ds_read_b64_tr_b16 v[34:35], v8 offset:34816
    ds_read_b64_tr_b16 v[108:109], v11 offset:36864
    s_waitcnt lgkmcnt(13)
    v_mfma_f32_16x16x32_bf16 v[176:179], v[16:19], v[36:39], v[176:179]
    ds_read_b64_tr_b16 v[110:111], v11 offset:38912
    ds_read_b64_tr_b16 v[180:181], v7 offset:36864
    s_waitcnt lgkmcnt(13)
    v_mfma_f32_16x16x32_bf16 v[96:99], v[16:19], v[68:71], v[96:99]
    ds_read_b64_tr_b16 v[182:183], v7 offset:38912
    ds_read_b64_tr_b16 v[36:37], v8 offset:36864
    s_waitcnt lgkmcnt(13)
    v_mfma_f32_16x16x32_bf16 v[40:43], v[20:23], v[112:115], v[40:43]
    ds_read_b64_tr_b16 v[38:39], v8 offset:38912
    v_mfma_f32_16x16x32_bf16 v[44:47], v[20:23], v[192:195], v[44:47]
    ds_read_b64_tr_b16 v[68:69], v12 offset:40960
    s_waitcnt lgkmcnt(13)
    v_mfma_f32_16x16x32_bf16 v[48:51], v[104:107], v[112:115], v[48:51]
    ds_read_b64_tr_b16 v[70:71], v12 offset:43008
    v_mfma_f32_16x16x32_bf16 v[52:55], v[104:107], v[192:195], v[52:55]
    ds_read_b64_tr_b16 v[20:21], v7 offset:40960
    s_waitcnt lgkmcnt(13)
    v_mfma_f32_16x16x32_bf16 v[176:179], v[16:19], v[24:27], v[176:179]
    ds_read_b64_tr_b16 v[22:23], v7 offset:43008
    ds_read_b64_tr_b16 v[104:105], v8 offset:40960
    s_waitcnt lgkmcnt(13)
    v_mfma_f32_16x16x32_bf16 v[40:43], v[28:31], v[116:119], v[40:43]
    ds_read_b64_tr_b16 v[106:107], v8 offset:43008
    v_mfma_f32_16x16x32_bf16 v[44:47], v[28:31], v[196:199], v[44:47]
    ds_read_b64_tr_b16 v[112:113], v9 offset:49152
    s_waitcnt lgkmcnt(13)
    v_mfma_f32_16x16x32_bf16 v[48:51], v[32:35], v[116:119], v[48:51]
    ds_read_b64_tr_b16 v[114:115], v9 offset:51200
    v_mfma_f32_16x16x32_bf16 v[52:55], v[32:35], v[196:199], v[52:55]
    ds_read_b64_tr_b16 v[24:25], v5 offset:49152
    s_waitcnt lgkmcnt(13)
    v_mfma_f32_16x16x32_bf16 v[96:99], v[16:19], v[108:111], v[96:99]
    ds_read_b64_tr_b16 v[26:27], v5 offset:51200
    ds_read_b64_tr_b16 v[28:29], v6 offset:49152
    s_waitcnt lgkmcnt(13)
    v_mfma_f32_16x16x32_bf16 v[40:43], v[180:183], v[120:123], v[40:43]
    ds_read_b64_tr_b16 v[30:31], v6 offset:51200
    v_mfma_f32_16x16x32_bf16 v[44:47], v[180:183], v[200:203], v[44:47]
    ds_read_b64_tr_b16 v[32:33], v10 offset:53248
    s_waitcnt lgkmcnt(13)
    v_mfma_f32_16x16x32_bf16 v[48:51], v[36:39], v[120:123], v[48:51]
    ds_read_b64_tr_b16 v[34:35], v10 offset:55296
    v_mfma_f32_16x16x32_bf16 v[52:55], v[36:39], v[200:203], v[52:55]
    ds_read_b64_tr_b16 v[116:117], v5 offset:53248
    s_waitcnt lgkmcnt(13)
    v_mfma_f32_16x16x32_bf16 v[176:179], v[16:19], v[68:71], v[176:179]
    ds_read_b64_tr_b16 v[118:119], v5 offset:55296
    ds_read_b64_tr_b16 v[108:109], v6 offset:53248
    s_waitcnt lgkmcnt(13)
    v_mfma_f32_16x16x32_bf16 v[40:43], v[20:23], v[124:127], v[40:43]
    ds_read_b64_tr_b16 v[110:111], v6 offset:55296
    v_mfma_f32_16x16x32_bf16 v[44:47], v[20:23], v[204:207], v[44:47]
    ds_read_b64_tr_b16 v[180:181], v9 offset:57344
    s_waitcnt lgkmcnt(13)
    v_mfma_f32_16x16x32_bf16 v[48:51], v[104:107], v[124:127], v[48:51]
    ds_read_b64_tr_b16 v[182:183], v9 offset:59392
    v_mfma_f32_16x16x32_bf16 v[52:55], v[104:107], v[204:207], v[52:55]
    ds_read_b64_tr_b16 v[36:37], v5 offset:57344
    s_waitcnt lgkmcnt(13)
    v_mfma_f32_16x16x32_bf16 v[96:99], v[16:19], v[112:115], v[96:99]
    ds_read_b64_tr_b16 v[38:39], v5 offset:59392
    ds_read_b64_tr_b16 v[200:201], v6 offset:57344
    s_waitcnt lgkmcnt(13)
    v_mfma_f32_16x16x32_bf16 v[40:43], v[24:27], v[128:131], v[40:43]
    ds_read_b64_tr_b16 v[202:203], v6 offset:59392
    v_mfma_f32_16x16x32_bf16 v[44:47], v[24:27], v[208:211], v[44:47]
    ds_read_b64_tr_b16 v[68:69], v10 offset:61440
    s_waitcnt lgkmcnt(13)
    v_mfma_f32_16x16x32_bf16 v[48:51], v[28:31], v[128:131], v[48:51]
    ds_read_b64_tr_b16 v[70:71], v10 offset:63488
    v_mfma_f32_16x16x32_bf16 v[52:55], v[28:31], v[208:211], v[52:55]
    ds_read_b64_tr_b16 v[20:21], v5 offset:61440
    s_waitcnt lgkmcnt(13)
    v_mfma_f32_16x16x32_bf16 v[176:179], v[16:19], v[32:35], v[176:179]
    ds_read_b64_tr_b16 v[22:23], v5 offset:63488
    ds_read_b64_tr_b16 v[104:105], v6 offset:61440
    s_waitcnt lgkmcnt(13)
    v_mfma_f32_16x16x32_bf16 v[40:43], v[116:119], v[132:135], v[40:43]
    ds_read_b64_tr_b16 v[106:107], v6 offset:63488
    v_mfma_f32_16x16x32_bf16 v[44:47], v[116:119], v[212:215], v[44:47]
    ds_read_b64_tr_b16 v[204:205], v11 offset:45056
    s_waitcnt lgkmcnt(13)
    v_mfma_f32_16x16x32_bf16 v[48:51], v[108:111], v[132:135], v[48:51]
    ds_read_b64_tr_b16 v[206:207], v11 offset:47104
    v_mfma_f32_16x16x32_bf16 v[52:55], v[108:111], v[212:215], v[52:55]
    ds_read_b64_tr_b16 v[112:113], v7 offset:45056
    s_waitcnt lgkmcnt(13)
    v_mfma_f32_16x16x32_bf16 v[96:99], v[16:19], v[180:183], v[96:99]
    ds_read_b64_tr_b16 v[114:115], v7 offset:47104
    ds_read_b64_tr_b16 v[24:25], v8 offset:45056
    s_waitcnt lgkmcnt(13)
    v_mfma_f32_16x16x32_bf16 v[40:43], v[36:39], v[136:139], v[40:43]
    ds_read_b64_tr_b16 v[26:27], v8 offset:47104
    v_mfma_f32_16x16x32_bf16 v[44:47], v[36:39], v[216:219], v[44:47]
    ds_read_b64_tr_b16 v[28:29], v12 offset:49152
    s_waitcnt lgkmcnt(13)
    v_mfma_f32_16x16x32_bf16 v[48:51], v[200:203], v[136:139], v[48:51]
    ds_read_b64_tr_b16 v[30:31], v12 offset:51200
    v_mfma_f32_16x16x32_bf16 v[52:55], v[200:203], v[216:219], v[52:55]
    ds_read_b64_tr_b16 v[208:209], v7 offset:49152
    s_waitcnt lgkmcnt(13)
    v_mfma_f32_16x16x32_bf16 v[176:179], v[16:19], v[68:71], v[176:179]
    ds_read_b64_tr_b16 v[210:211], v7 offset:51200
    ds_read_b64_tr_b16 v[32:33], v8 offset:49152
    s_waitcnt lgkmcnt(13)
    v_mfma_f32_16x16x32_bf16 v[40:43], v[20:23], v[140:143], v[40:43]
    ds_read_b64_tr_b16 v[34:35], v8 offset:51200
    v_mfma_f32_16x16x32_bf16 v[44:47], v[20:23], v[220:223], v[44:47]
    ds_read_b64_tr_b16 v[116:117], v11 offset:53248
    s_waitcnt lgkmcnt(13)
    v_mfma_f32_16x16x32_bf16 v[48:51], v[104:107], v[140:143], v[48:51]
    ds_read_b64_tr_b16 v[118:119], v11 offset:55296
    v_mfma_f32_16x16x32_bf16 v[52:55], v[104:107], v[220:223], v[52:55]
    ds_read_b64_tr_b16 v[108:109], v7 offset:53248
    s_waitcnt lgkmcnt(13)
    v_mfma_f32_16x16x32_bf16 v[96:99], v[16:19], v[204:207], v[96:99]
    ds_read_b64_tr_b16 v[110:111], v7 offset:55296
    ds_read_b64_tr_b16 v[212:213], v8 offset:53248
    s_waitcnt lgkmcnt(13)
    v_mfma_f32_16x16x32_bf16 v[40:43], v[112:115], v[144:147], v[40:43]
    ds_read_b64_tr_b16 v[214:215], v8 offset:55296
    v_mfma_f32_16x16x32_bf16 v[44:47], v[112:115], v[224:227], v[44:47]
    ds_read_b64_tr_b16 v[180:181], v12 offset:57344
    s_waitcnt lgkmcnt(13)
    v_mfma_f32_16x16x32_bf16 v[48:51], v[24:27], v[144:147], v[48:51]
    ds_read_b64_tr_b16 v[182:183], v12 offset:59392
    v_mfma_f32_16x16x32_bf16 v[52:55], v[24:27], v[224:227], v[52:55]
    ds_read_b64_tr_b16 v[36:37], v7 offset:57344
    s_waitcnt lgkmcnt(13)
    v_mfma_f32_16x16x32_bf16 v[176:179], v[16:19], v[28:31], v[176:179]
    ds_read_b64_tr_b16 v[38:39], v7 offset:59392
    ds_read_b64_tr_b16 v[200:201], v8 offset:57344
    s_waitcnt lgkmcnt(13)
    v_mfma_f32_16x16x32_bf16 v[40:43], v[208:211], v[148:151], v[40:43]
    ds_read_b64_tr_b16 v[202:203], v8 offset:59392
    v_mfma_f32_16x16x32_bf16 v[44:47], v[208:211], v[228:231], v[44:47]
    s_waitcnt lgkmcnt(12)
    v_mfma_f32_16x16x32_bf16 v[48:51], v[32:35], v[148:151], v[48:51]
    v_mfma_f32_16x16x32_bf16 v[52:55], v[32:35], v[228:231], v[52:55]
    s_waitcnt vmcnt(0)
    s_waitcnt lgkmcnt(0)
    s_barrier
    v_mfma_f32_16x16x32_bf16 v[96:99], v[16:19], v[116:119], v[96:99]
    ds_read_b64_tr_b16 v[216:217], v9 offset:0
    ds_read_b64_tr_b16 v[218:219], v9 offset:2048
    v_bfe_u32 v13, v0, 4, 4
    s_lshl_b32 s60, s15, 2
    v_mfma_f32_16x16x32_bf16 v[40:43], v[108:111], v[152:155], v[40:43]
    ds_read_b64_tr_b16 v[68:69], v5 offset:0
    ds_read_b64_tr_b16 v[70:71], v5 offset:2048
    s_add_u32 s60, s60, s59
    v_lshl_add_u32 v13, v13, 2, s60
    v_mfma_f32_16x16x32_bf16 v[44:47], v[108:111], v[232:235], v[44:47]
    ds_read_b64_tr_b16 v[20:21], v6 offset:0
    ds_read_b64_tr_b16 v[22:23], v6 offset:2048
    v_xor_b32 v14, 0x100, v13
    v_mfma_f32_16x16x32_bf16 v[48:51], v[212:215], v[152:155], v[48:51]
    ds_read_b64_tr_b16 v[104:105], v10 offset:4096
    v_mfma_f32_16x16x32_bf16 v[52:55], v[212:215], v[232:235], v[52:55]
    ds_read_b64_tr_b16 v[106:107], v10 offset:6144
    ds_read_b64_tr_b16 v[220:221], v5 offset:4096
    v_mfma_f32_16x16x32_bf16 v[176:179], v[16:19], v[180:183], v[176:179]
    ds_read_b64_tr_b16 v[222:223], v5 offset:6144
    ds_read_b64_tr_b16 v[204:205], v6 offset:4096
    v_mfma_f32_16x16x32_bf16 v[40:43], v[36:39], v[156:159], v[40:43]
    ds_read_b64_tr_b16 v[206:207], v6 offset:6144
    v_mfma_f32_16x16x32_bf16 v[44:47], v[36:39], v[236:239], v[44:47]
    ds_read_b64_tr_b16 v[112:113], v9 offset:8192
    v_mfma_f32_16x16x32_bf16 v[48:51], v[200:203], v[156:159], v[48:51]
    ds_read_b64_tr_b16 v[114:115], v9 offset:10240
    v_mfma_f32_16x16x32_bf16 v[52:55], v[200:203], v[236:239], v[52:55]
    ds_read_b64_tr_b16 v[24:25], v5 offset:8192
    s_waitcnt lgkmcnt(13)
    v_mfma_f32_16x16x32_bf16 v[96:99], v[16:19], v[216:219], v[96:99]
    ds_read_b64_tr_b16 v[26:27], v5 offset:10240
    ds_read_b64_tr_b16 v[224:225], v6 offset:8192
    s_waitcnt lgkmcnt(13)
    v_mfma_f32_16x16x32_bf16 v[40:43], v[68:71], v[160:163], v[40:43]
    ds_read_b64_tr_b16 v[226:227], v6 offset:10240
    v_mfma_f32_16x16x32_bf16 v[44:47], v[68:71], v[240:243], v[44:47]
    ds_read_b64_tr_b16 v[28:29], v10 offset:12288
    s_waitcnt lgkmcnt(13)
    v_mfma_f32_16x16x32_bf16 v[48:51], v[20:23], v[160:163], v[48:51]
    ds_read_b64_tr_b16 v[30:31], v10 offset:14336
    v_mfma_f32_16x16x32_bf16 v[52:55], v[20:23], v[240:243], v[52:55]
    ds_read_b64_tr_b16 v[208:209], v5 offset:12288
    s_waitcnt lgkmcnt(13)
    v_mfma_f32_16x16x32_bf16 v[176:179], v[16:19], v[104:107], v[176:179]
    ds_read_b64_tr_b16 v[210:211], v5 offset:14336
    ds_read_b64_tr_b16 v[32:33], v6 offset:12288
    s_waitcnt lgkmcnt(13)
    v_mfma_f32_16x16x32_bf16 v[40:43], v[220:223], v[164:167], v[40:43]
    ds_read_b64_tr_b16 v[34:35], v6 offset:14336
    v_mfma_f32_16x16x32_bf16 v[44:47], v[220:223], v[244:247], v[44:47]
    s_waitcnt lgkmcnt(12)
    v_mfma_f32_16x16x32_bf16 v[48:51], v[204:207], v[164:167], v[48:51]
    v_mfma_f32_16x16x32_bf16 v[52:55], v[204:207], v[244:247], v[52:55]
    s_waitcnt lgkmcnt(10)
    v_mfma_f32_16x16x32_bf16 v[96:99], v[16:19], v[112:115], v[96:99]
    s_waitcnt lgkmcnt(8)
    v_mfma_f32_16x16x32_bf16 v[40:43], v[24:27], v[168:171], v[40:43]
    v_mfma_f32_16x16x32_bf16 v[44:47], v[24:27], v[248:251], v[44:47]
    s_waitcnt lgkmcnt(6)
    v_mfma_f32_16x16x32_bf16 v[48:51], v[224:227], v[168:171], v[48:51]
    v_mfma_f32_16x16x32_bf16 v[52:55], v[224:227], v[248:251], v[52:55]
    s_waitcnt lgkmcnt(4)
    v_mfma_f32_16x16x32_bf16 v[176:179], v[16:19], v[28:31], v[176:179]
    ds_read2st64_b32 v[120:121], v1 offset0:4 offset1:6
    ds_read2st64_b32 v[122:123], v2 offset0:4 offset1:6
    s_waitcnt lgkmcnt(4)
    v_mfma_f32_16x16x32_bf16 v[40:43], v[208:211], v[172:175], v[40:43]
    ds_read_b128 v[136:139], v3
    ds_read_b128 v[140:143], v3 offset:2560
    v_mfma_f32_16x16x32_bf16 v[44:47], v[208:211], v[252:255], v[44:47]
    ds_read2st64_b32 v[124:125], v1 offset0:0 offset1:2
    s_waitcnt lgkmcnt(5)
    v_mfma_f32_16x16x32_bf16 v[48:51], v[32:35], v[172:175], v[48:51]
    v_mfma_f32_16x16x32_bf16 v[52:55], v[32:35], v[252:255], v[52:55]
    ds_write_b32 v13, v96 offset:4096
    ds_write_b32 v14, v176 offset:4160
    s_setprio 1
    v_xor_b32 v4, 64, v3
    ds_read_b128 v[144:147], v4
    ds_read_b128 v[148:151], v4 offset:2560
    s_waitcnt lgkmcnt(5)
    v_mov_b32 v132, v121
    v_pk_fma_f32 v[128:129], v[136:137], v[132:133], v[140:141] op_sel:[0,0,0] op_sel_hi:[1,0,1] neg_lo:[0,1,0] neg_hi:[0,1,0]
    v_lshrrev_b32 v13, 7, v0
    v_pk_fma_f32 v[130:131], v[138:139], v[132:133], v[142:143] op_sel:[0,0,0] op_sel_hi:[1,0,1] neg_lo:[0,1,0] neg_hi:[0,1,0]
    v_pk_fma_f32 v[56:57], v[56:57], v[120:121], v[128:129] op_sel:[0,0,0] op_sel_hi:[1,0,1]
    v_pk_fma_f32 v[58:59], v[58:59], v[120:121], v[130:131] op_sel:[0,0,0] op_sel_hi:[1,0,1]
    v_mul_u32_u24 v13, 1280, v13
    v_pk_fma_f32 v[132:133], v[56:57], v[56:57], s[86:87]
    v_pk_fma_f32 v[134:135], v[58:59], v[58:59], s[86:87]
    v_pk_mul_f32 v[132:133], v[132:133], v[56:57] neg_lo:[0,1] neg_hi:[0,1]
    v_and_b32 v14, 0x70, v0
    v_pk_mul_f32 v[134:135], v[134:135], v[58:59] neg_lo:[0,1] neg_hi:[0,1]
    v_exp_f32 v132, v132
    v_exp_f32 v133, v133
    v_add_u32 v13, v13, v14
    v_exp_f32 v134, v134
    v_exp_f32 v135, v135
    v_pk_fma_f32 v[132:133], v[132:133], s[98:99], s[98:99]
    s_add_u32 m0, s19, 0
    s_nop 0
    buffer_load_dwordx4 v13, s[64:67], s3 offen lds
    v_pk_fma_f32 v[134:135], v[134:135], s[98:99], s[98:99]
    v_rcp_f32 v132, v132
    v_rcp_f32 v133, v133
    s_add_u32 m0, s19, 1024
    s_add_u32 s3, s3, s88
    buffer_load_dwordx4 v13, s[64:67], s3 offen lds
    v_rcp_f32 v134, v134
    v_rcp_f32 v135, v135
    v_pk_mul_f32 v[56:57], v[56:57], v[132:133]
    s_add_u32 m0, s19, 2048
    s_add_u32 s3, s3, s88
    buffer_load_dwordx4 v13, s[64:67], s3 offen lds
    v_pk_mul_f32 v[58:59], v[58:59], v[134:135]
    v_cvt_pk_bf16_f32 v56, v56, v57
    v_cvt_pk_bf16_f32 v57, v58, v59
    v_mov_b32 v132, v123
    v_pk_fma_f32 v[128:129], v[136:137], v[132:133], v[140:141] op_sel:[0,0,0] op_sel_hi:[1,0,1] neg_lo:[0,1,0] neg_hi:[0,1,0]
    s_add_u32 m0, s19, 3072
    s_add_u32 s3, s3, s88
    buffer_load_dwordx4 v13, s[64:67], s3 offen lds
    v_pk_fma_f32 v[130:131], v[138:139], v[132:133], v[142:143] op_sel:[0,0,0] op_sel_hi:[1,0,1] neg_lo:[0,1,0] neg_hi:[0,1,0]
    v_pk_fma_f32 v[60:61], v[60:61], v[122:123], v[128:129] op_sel:[0,0,0] op_sel_hi:[1,0,1]
    v_pk_fma_f32 v[62:63], v[62:63], v[122:123], v[130:131] op_sel:[0,0,0] op_sel_hi:[1,0,1]
    v_pk_fma_f32 v[132:133], v[60:61], v[60:61], s[86:87]
    v_pk_fma_f32 v[134:135], v[62:63], v[62:63], s[86:87]
    v_pk_mul_f32 v[132:133], v[132:133], v[60:61] neg_lo:[0,1] neg_hi:[0,1]
    v_pk_mul_f32 v[134:135], v[134:135], v[62:63] neg_lo:[0,1] neg_hi:[0,1]
    v_exp_f32 v132, v132
    v_exp_f32 v133, v133
    v_exp_f32 v134, v134
    v_exp_f32 v135, v135
    v_pk_fma_f32 v[132:133], v[132:133], s[98:99], s[98:99]
    v_pk_fma_f32 v[134:135], v[134:135], s[98:99], s[98:99]
    v_rcp_f32 v132, v132
    v_rcp_f32 v133, v133
    v_rcp_f32 v134, v134
    v_rcp_f32 v135, v135
    v_pk_mul_f32 v[60:61], v[60:61], v[132:133]
    v_pk_mul_f32 v[62:63], v[62:63], v[134:135]
    v_cvt_pk_bf16_f32 v60, v60, v61
    v_cvt_pk_bf16_f32 v61, v62, v63
    v_xor_b32 v4, 128, v3
    ds_read_b128 v[136:139], v4
    ds_read_b128 v[140:143], v4 offset:2560
    s_waitcnt lgkmcnt(2)
    v_mov_b32 v132, v121
    v_pk_fma_f32 v[128:129], v[144:145], v[132:133], v[148:149] op_sel:[0,0,0] op_sel_hi:[1,0,1] neg_lo:[0,1,0] neg_hi:[0,1,0]
    v_pk_fma_f32 v[130:131], v[146:147], v[132:133], v[150:151] op_sel:[0,0,0] op_sel_hi:[1,0,1] neg_lo:[0,1,0] neg_hi:[0,1,0]
    v_pk_fma_f32 v[72:73], v[72:73], v[120:121], v[128:129] op_sel:[0,0,0] op_sel_hi:[1,0,1]
    v_pk_fma_f32 v[74:75], v[74:75], v[120:121], v[130:131] op_sel:[0,0,0] op_sel_hi:[1,0,1]
    v_pk_fma_f32 v[132:133], v[72:73], v[72:73], s[86:87]
    v_pk_fma_f32 v[134:135], v[74:75], v[74:75], s[86:87]
    v_pk_mul_f32 v[132:133], v[132:133], v[72:73] neg_lo:[0,1] neg_hi:[0,1]
    v_pk_mul_f32 v[134:135], v[134:135], v[74:75] neg_lo:[0,1] neg_hi:[0,1]
    v_exp_f32 v132, v132
    v_exp_f32 v133, v133
    v_exp_f32 v134, v134
    v_exp_f32 v135, v135
    v_pk_fma_f32 v[132:133], v[132:133], s[98:99], s[98:99]
    v_pk_fma_f32 v[134:135], v[134:135], s[98:99], s[98:99]
    v_rcp_f32 v132, v132
    v_rcp_f32 v133, v133
    v_rcp_f32 v134, v134
    v_rcp_f32 v135, v135
    v_pk_mul_f32 v[72:73], v[72:73], v[132:133]
    v_pk_mul_f32 v[74:75], v[74:75], v[134:135]
    v_cvt_pk_bf16_f32 v58, v72, v73
    v_cvt_pk_bf16_f32 v59, v74, v75
    s_mov_b64 exec, s[100:101]
    v_swap_b32 v56, v58
    v_swap_b32 v57, v59
    s_mov_b64 exec, -1
    s_add_u32 s60, s41, s57
    buffer_store_dwordx4 v[56:59], v0, s[32:35], s60 offen sc1
    v_fma_f32 v128, v144, -v123, v148
    v_fma_f32 v129, v145, -v123, v149
    v_fma_f32 v130, v146, -v123, v150
    v_fma_f32 v131, v147, -v123, v151
    v_fma_f32 v76, v76, v122, v128
    v_fma_f32 v77, v77, v122, v129
    v_fma_f32 v78, v78, v122, v130
    v_fma_f32 v79, v79, v122, v131
    v_fma_f32 v132, v76, v76, s86
    v_fma_f32 v133, v77, v77, s87
    v_fma_f32 v134, v78, v78, s86
    v_fma_f32 v135, v79, v79, s87
    v_mul_f32_e64 v132, v132, -v76
    v_mul_f32_e64 v133, v133, -v77
    v_mul_f32_e64 v134, v134, -v78
    v_mul_f32_e64 v135, v135, -v79
    v_exp_f32 v132, v132
    v_exp_f32 v133, v133
    v_exp_f32 v134, v134
    v_exp_f32 v135, v135
    v_fma_f32 v132, v132, s98, s98
    v_fma_f32 v133, v133, s99, s99
    v_fma_f32 v134, v134, s98, s98
    v_fma_f32 v135, v135, s99, s99
    v_rcp_f32 v132, v132
    v_rcp_f32 v133, v133
    v_rcp_f32 v134, v134
    v_rcp_f32 v135, v135
    v_mul_f32_e64 v76, v76, v132
    v_mul_f32_e64 v77, v77, v133
    v_mul_f32_e64 v78, v78, v134
    v_mul_f32_e64 v79, v79, v135
    v_cvt_pk_bf16_f32 v62, v76, v77
    v_cvt_pk_bf16_f32 v63, v78, v79
    s_mov_b64 exec, s[100:101]
    v_swap_b32 v60, v62
    v_swap_b32 v61, v63
    s_mov_b64 exec, -1
    s_add_u32 s60, s42, s57
    buffer_store_dwordx4 v[60:63], v0, s[32:35], s60 offen sc1
    v_xor_b32 v4, 192, v3
    ds_read_b128 v[144:147], v4
    ds_read_b128 v[148:151], v4 offset:2560
    s_waitcnt lgkmcnt(2)
    v_fma_f32 v128, v136, -v121, v140
    v_fma_f32 v129, v137, -v121, v141
    v_fma_f32 v130, v138, -v121, v142
    v_lshrrev_b32 v13, 6, v0
    v_fma_f32 v131, v139, -v121, v143
    v_fma_f32 v80, v80, v120, v128
    v_fma_f32 v81, v81, v120, v129
    v_lshlrev_b32 v13, 7, v13
    v_fma_f32 v82, v82, v120, v130
    v_fma_f32 v83, v83, v120, v131
    v_fma_f32 v132, v80, v80, s86
    v_bfe_u32 v14, v0, 4, 2
    v_fma_f32 v133, v81, v81, s87
    v_fma_f32 v134, v82, v82, s86
    v_fma_f32 v135, v83, v83, s87
    v_lshl_add_u32 v13, v14, 4, v13
    v_mul_f32_e64 v132, v132, -v80
    v_mul_f32_e64 v133, v133, -v81
    v_mul_f32_e64 v134, v134, -v82
    v_add_u32 v13, s19, v13
    v_mul_f32_e64 v135, v135, -v83
    v_exp_f32 v132, v132
    v_exp_f32 v133, v133
    s_waitcnt vmcnt(2)
    v_exp_f32 v134, v134
    v_exp_f32 v135, v135
    v_fma_f32 v132, v132, s98, s98
    ds_read_b64_tr_b16 v[184:185], v13 offset:0
    v_fma_f32 v133, v133, s99, s99
    v_fma_f32 v134, v134, s98, s98
    v_fma_f32 v135, v135, s99, s99
    ds_read_b64_tr_b16 v[186:187], v13 offset:2048
    v_rcp_f32 v132, v132
    v_rcp_f32 v133, v133
    v_rcp_f32 v134, v134
    ds_read_b64_tr_b16 v[188:189], v13 offset:8
    v_rcp_f32 v135, v135
    v_mul_f32_e64 v80, v80, v132
    v_mul_f32_e64 v81, v81, v133
    ds_read_b64_tr_b16 v[190:191], v13 offset:2056
    v_mul_f32_e64 v82, v82, v134
    v_mul_f32_e64 v83, v83, v135
    v_cvt_pk_bf16_f32 v80, v80, v81
    v_cvt_pk_bf16_f32 v81, v82, v83
    v_fma_f32 v128, v136, -v123, v140
    ds_read_b64_tr_b16 v[192:193], v13 offset:64
    v_fma_f32 v129, v137, -v123, v141
    v_fma_f32 v130, v138, -v123, v142
    v_fma_f32 v131, v139, -v123, v143
    ds_read_b64_tr_b16 v[194:195], v13 offset:2112
    v_fma_f32 v84, v84, v122, v128
    v_fma_f32 v85, v85, v122, v129
    v_fma_f32 v86, v86, v122, v130
    ds_read_b64_tr_b16 v[196:197], v13 offset:72
    v_fma_f32 v87, v87, v122, v131
    v_fma_f32 v132, v84, v84, s86
    v_fma_f32 v133, v85, v85, s87
    ds_read_b64_tr_b16 v[198:199], v13 offset:2120
    v_fma_f32 v134, v86, v86, s86
    v_fma_f32 v135, v87, v87, s87
    v_mul_f32_e64 v132, v132, -v84
    s_waitcnt lgkmcnt(6)
    v_mul_f32_e64 v133, v133, -v85
    v_mul_f32_e64 v134, v134, -v86
    v_mul_f32_e64 v135, v135, -v87
    buffer_store_dwordx4 v[184:187], v0, s[68:71], s36 offen sc1
    v_exp_f32 v132, v132
    v_exp_f32 v133, v133
    v_exp_f32 v134, v134
    s_waitcnt lgkmcnt(4)
    v_exp_f32 v135, v135
    v_fma_f32 v132, v132, s98, s98
    v_fma_f32 v133, v133, s99, s99
    buffer_store_dwordx4 v[188:191], v0, s[68:71], s37 offen sc1
    v_fma_f32 v134, v134, s98, s98
    v_fma_f32 v135, v135, s99, s99
    v_rcp_f32 v132, v132
    s_waitcnt lgkmcnt(2)
    v_rcp_f32 v133, v133
    v_rcp_f32 v134, v134
    v_rcp_f32 v135, v135
    buffer_store_dwordx4 v[192:195], v0, s[68:71], s38 offen sc1
    v_mul_f32_e64 v84, v84, v132
    v_mul_f32_e64 v85, v85, v133
    v_mul_f32_e64 v86, v86, v134
    s_waitcnt lgkmcnt(0)
    v_mul_f32_e64 v87, v87, v135
    v_cvt_pk_bf16_f32 v84, v84, v85
    v_cvt_pk_bf16_f32 v85, v86, v87
    v_lshrrev_b32 v4, 8, v0
    v_lshl_add_u32 v4, v4, 4, s59
    ds_read_b128 v[136:139], v4 offset:2560
    ds_read_b128 v[140:143], v4 offset:2624
    ds_read_b128 v[68:71], v4 offset:2688
    ds_read_b128 v[152:155], v4 offset:2752
    v_fma_f32 v128, v144, -v121, v148
    v_fma_f32 v129, v145, -v121, v149
    buffer_store_dwordx4 v[196:199], v0, s[68:71], s39 offen sc1
    v_fma_f32 v130, v146, -v121, v150
    v_fma_f32 v131, v147, -v121, v151
    v_fma_f32 v88, v88, v120, v128
    v_fma_f32 v89, v89, v120, v129
    v_fma_f32 v90, v90, v120, v130
    v_fma_f32 v91, v91, v120, v131
    v_fma_f32 v132, v88, v88, s86
    v_fma_f32 v133, v89, v89, s87
    v_fma_f32 v134, v90, v90, s86
    v_fma_f32 v135, v91, v91, s87
    v_mul_f32_e64 v132, v132, -v88
    v_mul_f32_e64 v133, v133, -v89
    v_mul_f32_e64 v134, v134, -v90
    v_mul_f32_e64 v135, v135, -v91
    v_exp_f32 v132, v132
    v_exp_f32 v133, v133
    v_exp_f32 v134, v134
    v_exp_f32 v135, v135
    v_fma_f32 v132, v132, s98, s98
    v_fma_f32 v133, v133, s99, s99
    v_fma_f32 v134, v134, s98, s98
    v_fma_f32 v135, v135, s99, s99
    v_rcp_f32 v132, v132
    v_rcp_f32 v133, v133
    v_rcp_f32 v134, v134
    v_rcp_f32 v135, v135
    v_mul_f32_e64 v88, v88, v132
    v_mul_f32_e64 v89, v89, v133
    v_mul_f32_e64 v90, v90, v134
    v_mul_f32_e64 v91, v91, v135
    v_cvt_pk_bf16_f32 v82, v88, v89
    v_cvt_pk_bf16_f32 v83, v90, v91
    s_mov_b64 exec, s[100:101]
    v_swap_b32 v80, v82
    v_swap_b32 v81, v83
    s_mov_b64 exec, -1
    s_xor_b32 s60, s57, 1024
    s_add_u32 s60, s41, s60
    buffer_store_dwordx4 v[80:83], v0, s[32:35], s60 offen sc1
    v_fma_f32 v128, v144, -v123, v148
    v_fma_f32 v129, v145, -v123, v149
    v_fma_f32 v130, v146, -v123, v150
    v_fma_f32 v131, v147, -v123, v151
    v_fma_f32 v92, v92, v122, v128
    v_fma_f32 v93, v93, v122, v129
    v_fma_f32 v94, v94, v122, v130
    v_fma_f32 v95, v95, v122, v131
    v_fma_f32 v132, v92, v92, s86
    v_fma_f32 v133, v93, v93, s87
    v_fma_f32 v134, v94, v94, s86
    v_fma_f32 v135, v95, v95, s87
    v_mul_f32_e64 v132, v132, -v92
    v_mul_f32_e64 v133, v133, -v93
    v_mul_f32_e64 v134, v134, -v94
    v_mul_f32_e64 v135, v135, -v95
    v_exp_f32 v132, v132
    v_exp_f32 v133, v133
    v_exp_f32 v134, v134
    v_exp_f32 v135, v135
    v_fma_f32 v132, v132, s98, s98
    v_fma_f32 v133, v133, s99, s99
    v_fma_f32 v134, v134, s98, s98
    v_fma_f32 v135, v135, s99, s99
    v_rcp_f32 v132, v132
    v_rcp_f32 v133, v133
    v_rcp_f32 v134, v134
    v_rcp_f32 v135, v135
    v_mul_f32_e64 v92, v92, v132
    v_mul_f32_e64 v93, v93, v133
    v_mul_f32_e64 v94, v94, v134
    v_mul_f32_e64 v95, v95, v135
    v_cvt_pk_bf16_f32 v86, v92, v93
    v_cvt_pk_bf16_f32 v87, v94, v95
    s_mov_b64 exec, s[100:101]
    v_swap_b32 v84, v86
    v_swap_b32 v85, v87
    s_mov_b64 exec, -1
    s_xor_b32 s60, s57, 1024
    s_add_u32 s60, s42, s60
    buffer_store_dwordx4 v[84:87], v0, s[32:35], s60 offen sc1
    s_waitcnt lgkmcnt(0)
    s_barrier
    v_lshrrev_b32 v9, 9, v0
    v_add_u32 v9, s91, v9
    v_mul_u32_u24 v10, 205, v9
    v_lshrrev_b32 v10, 10, v10
    v_mul_u32_u24 v11, 5, v10
    v_sub_u32 v9, v9, v11
    v_cmp_eq_u32 vcc, 4, v9
    v_and_b32 v11, 3, v10
    s_nop 0
    v_cndmask_b32 v9, v9, v11, vcc
    v_lshrrev_b32 v11, 2, v10
    v_add_u32 v11, 16, v11
    v_cndmask_b32 v10, v10, v11, vcc
    v_and_b32 v11, 0x1f0, v0
    v_lshl_add_u32 v10, v10, 10, v11
    v_and_b32 v11, 1, v9
    v_lshl_add_u32 v10, v11, 9, v10
    v_lshrrev_b32 v9, 1, v9
    v_lshl_add_u32 v9, v9, 3, v10
    v_pk_add_f32 v[136:137], v[136:137], v[140:141]
    v_pk_add_f32 v[152:153], v[152:153], v[68:69]
    v_pk_add_f32 v[138:139], v[138:139], v[142:143]
    v_pk_add_f32 v[154:155], v[154:155], v[70:71]
    v_pk_add_f32 v[136:137], v[136:137], v[152:153]
    v_pk_add_f32 v[138:139], v[138:139], v[154:155]
    v_mov_b32 v132, v125
    v_pk_fma_f32 v[128:129], v[136:137], v[132:133], s[82:83] op_sel:[0,0,0] op_sel_hi:[1,0,1] neg_lo:[0,1,0] neg_hi:[0,1,0]
    v_pk_fma_f32 v[130:131], v[138:139], v[132:133], s[82:83] op_sel:[0,0,0] op_sel_hi:[1,0,1] neg_lo:[0,1,0] neg_hi:[0,1,0]
    v_pk_fma_f32 v[64:65], v[64:65], v[124:125], v[128:129] op_sel:[0,0,0] op_sel_hi:[1,0,1]
    v_pk_fma_f32 v[66:67], v[66:67], v[124:125], v[130:131] op_sel:[0,0,0] op_sel_hi:[1,0,1]
    v_exp_f32_e64 v132, v64 clamp
    v_exp_f32_e64 v133, v65 clamp
    v_max_f32 v64, s82, v64
    v_max_f32 v65, s82, v65
    v_pk_fma_f32 v[64:65], v[64:65], s[84:85], v[132:133]
    v_exp_f32_e64 v134, v66 clamp
    v_exp_f32_e64 v135, v67 clamp
    v_max_f32 v66, s82, v66
    v_max_f32 v67, s82, v67
    v_pk_fma_f32 v[66:67], v[66:67], s[84:85], v[134:135]
    v_cvt_pk_bf16_f32 v124, v64, v65
    v_cvt_pk_bf16_f32 v125, v66, v67
    s_add_u32 s60, s41, 49152
    buffer_store_dwordx2 v[124:125], v9, s[32:35], s60 offen sc1
    v_bfe_u32 v4, v0, 4, 4
    v_lshl_add_u32 v1, v4, 2, s56
    v_xor_b32 v2, 64, v1
    v_lshrrev_b32 v3, 8, v0
    s_lshl_b32 s60, s14, 2
    s_add_u32 s60, s60, s59
    v_lshl_add_u32 v3, v3, 4, s60
    v_xor_b32 v4, 128, v3
    v_lshrrev_b32 v10, 8, v0
    s_lshl_b32 s60, s14, 1
    s_add_u32 s60, s60, s59
    v_lshl_add_u32 v10, v10, 4, s60
    v_xor_b32 v11, 64, v10
    ds_read2st64_b32 v[160:161], v1 offset0:4 offset1:6
    ds_read2st64_b32 v[162:163], v2 offset0:4 offset1:6
    ds_read_b128 v[180:183], v10 offset:5120
    ds_read_b128 v[184:187], v11 offset:5120
    ds_read_b128 v[164:167], v3 offset:4096
    ds_read_b128 v[168:171], v3 offset:4160
    ds_read_b128 v[172:175], v4 offset:4096
    ds_read_b128 v[176:179], v4 offset:4160
    s_waitcnt lgkmcnt(2)
    v_pk_add_f32 v[164:165], v[164:165], v[168:169]
    v_pk_add_f32 v[166:167], v[166:167], v[170:171]
    v_mov_b32 v144, v161
    v_pk_fma_f32 v[140:141], v[164:165], v[144:145], v[180:181] op_sel:[0,0,0] op_sel_hi:[1,0,1] neg_lo:[0,1,0] neg_hi:[0,1,0]
    v_pk_fma_f32 v[142:143], v[166:167], v[144:145], v[182:183] op_sel:[0,0,0] op_sel_hi:[1,0,1] neg_lo:[0,1,0] neg_hi:[0,1,0]
    v_pk_fma_f32 v[40:41], v[40:41], v[160:161], v[140:141] op_sel:[0,0,0] op_sel_hi:[1,0,1]
    v_pk_fma_f32 v[42:43], v[42:43], v[160:161], v[142:143] op_sel:[0,0,0] op_sel_hi:[1,0,1]
    v_pk_fma_f32 v[144:145], v[40:41], v[40:41], s[86:87]
    v_pk_fma_f32 v[146:147], v[42:43], v[42:43], s[86:87]
    v_pk_mul_f32 v[144:145], v[144:145], v[40:41] neg_lo:[0,1] neg_hi:[0,1]
    v_pk_mul_f32 v[146:147], v[146:147], v[42:43] neg_lo:[0,1] neg_hi:[0,1]
    v_exp_f32 v144, v144
    v_exp_f32 v145, v145
    v_exp_f32 v146, v146
    v_exp_f32 v147, v147
    v_pk_fma_f32 v[144:145], v[144:145], s[98:99], s[98:99]
    v_pk_fma_f32 v[146:147], v[146:147], s[98:99], s[98:99]
    v_rcp_f32 v144, v144
    v_rcp_f32 v145, v145
    v_rcp_f32 v146, v146
    v_rcp_f32 v147, v147
    v_pk_mul_f32 v[40:41], v[40:41], v[144:145]
    v_pk_mul_f32 v[42:43], v[42:43], v[146:147]
    v_cvt_pk_bf16_f32 v40, v40, v41
    v_cvt_pk_bf16_f32 v41, v42, v43
    v_mov_b32 v144, v163
    v_pk_fma_f32 v[140:141], v[164:165], v[144:145], v[180:181] op_sel:[0,0,0] op_sel_hi:[1,0,1] neg_lo:[0,1,0] neg_hi:[0,1,0]
    v_pk_fma_f32 v[142:143], v[166:167], v[144:145], v[182:183] op_sel:[0,0,0] op_sel_hi:[1,0,1] neg_lo:[0,1,0] neg_hi:[0,1,0]
    v_pk_fma_f32 v[44:45], v[44:45], v[162:163], v[140:141] op_sel:[0,0,0] op_sel_hi:[1,0,1]
    v_pk_fma_f32 v[46:47], v[46:47], v[162:163], v[142:143] op_sel:[0,0,0] op_sel_hi:[1,0,1]
    v_pk_fma_f32 v[144:145], v[44:45], v[44:45], s[86:87]
    v_pk_fma_f32 v[146:147], v[46:47], v[46:47], s[86:87]
    v_pk_mul_f32 v[144:145], v[144:145], v[44:45] neg_lo:[0,1] neg_hi:[0,1]
    v_pk_mul_f32 v[146:147], v[146:147], v[46:47] neg_lo:[0,1] neg_hi:[0,1]
    v_exp_f32 v144, v144
    v_exp_f32 v145, v145
    v_exp_f32 v146, v146
    v_exp_f32 v147, v147
    v_pk_fma_f32 v[144:145], v[144:145], s[98:99], s[98:99]
    v_pk_fma_f32 v[146:147], v[146:147], s[98:99], s[98:99]
    v_rcp_f32 v144, v144
    v_rcp_f32 v145, v145
    v_rcp_f32 v146, v146
    v_rcp_f32 v147, v147
    v_pk_mul_f32 v[44:45], v[44:45], v[144:145]
    v_pk_mul_f32 v[46:47], v[46:47], v[146:147]
    v_cvt_pk_bf16_f32 v44, v44, v45
    v_cvt_pk_bf16_f32 v45, v46, v47
    s_waitcnt lgkmcnt(0)
    v_pk_add_f32 v[172:173], v[172:173], v[176:177]
    v_pk_add_f32 v[174:175], v[174:175], v[178:179]
    v_mov_b32 v144, v161
    v_pk_fma_f32 v[140:141], v[172:173], v[144:145], v[184:185] op_sel:[0,0,0] op_sel_hi:[1,0,1] neg_lo:[0,1,0] neg_hi:[0,1,0]
    v_pk_fma_f32 v[142:143], v[174:175], v[144:145], v[186:187] op_sel:[0,0,0] op_sel_hi:[1,0,1] neg_lo:[0,1,0] neg_hi:[0,1,0]
    v_pk_fma_f32 v[48:49], v[48:49], v[160:161], v[140:141] op_sel:[0,0,0] op_sel_hi:[1,0,1]
    v_pk_fma_f32 v[50:51], v[50:51], v[160:161], v[142:143] op_sel:[0,0,0] op_sel_hi:[1,0,1]
    v_pk_fma_f32 v[144:145], v[48:49], v[48:49], s[86:87]
    v_pk_fma_f32 v[146:147], v[50:51], v[50:51], s[86:87]
    v_pk_mul_f32 v[144:145], v[144:145], v[48:49] neg_lo:[0,1] neg_hi:[0,1]
    v_pk_mul_f32 v[146:147], v[146:147], v[50:51] neg_lo:[0,1] neg_hi:[0,1]
    v_exp_f32 v144, v144
    v_exp_f32 v145, v145
    v_exp_f32 v146, v146
    v_exp_f32 v147, v147
    v_pk_fma_f32 v[144:145], v[144:145], s[98:99], s[98:99]
    v_pk_fma_f32 v[146:147], v[146:147], s[98:99], s[98:99]
    v_rcp_f32 v144, v144
    v_rcp_f32 v145, v145
    v_rcp_f32 v146, v146
    v_rcp_f32 v147, v147
    v_pk_mul_f32 v[48:49], v[48:49], v[144:145]
    v_pk_mul_f32 v[50:51], v[50:51], v[146:147]
    v_cvt_pk_bf16_f32 v42, v48, v49
    v_cvt_pk_bf16_f32 v43, v50, v51
    s_mov_b64 exec, s[52:53]
    v_swap_b32 v40, v42
    v_swap_b32 v41, v43
    s_mov_b64 exec, -1
    s_add_u32 s60, s41, s54
    buffer_store_dwordx4 v[40:43], v0, s[32:35], s60 offen sc1
    v_mov_b32 v144, v163
    v_pk_fma_f32 v[140:141], v[172:173], v[144:145], v[184:185] op_sel:[0,0,0] op_sel_hi:[1,0,1] neg_lo:[0,1,0] neg_hi:[0,1,0]
    v_pk_fma_f32 v[142:143], v[174:175], v[144:145], v[186:187] op_sel:[0,0,0] op_sel_hi:[1,0,1] neg_lo:[0,1,0] neg_hi:[0,1,0]
    v_pk_fma_f32 v[52:53], v[52:53], v[162:163], v[140:141] op_sel:[0,0,0] op_sel_hi:[1,0,1]
    v_pk_fma_f32 v[54:55], v[54:55], v[162:163], v[142:143] op_sel:[0,0,0] op_sel_hi:[1,0,1]
    v_pk_fma_f32 v[144:145], v[52:53], v[52:53], s[86:87]
    v_pk_fma_f32 v[146:147], v[54:55], v[54:55], s[86:87]
    v_pk_mul_f32 v[144:145], v[144:145], v[52:53] neg_lo:[0,1] neg_hi:[0,1]
    v_pk_mul_f32 v[146:147], v[146:147], v[54:55] neg_lo:[0,1] neg_hi:[0,1]
    v_exp_f32 v144, v144
    v_exp_f32 v145, v145
    v_exp_f32 v146, v146
    v_exp_f32 v147, v147
    v_pk_fma_f32 v[144:145], v[144:145], s[98:99], s[98:99]
    v_pk_fma_f32 v[146:147], v[146:147], s[98:99], s[98:99]
    v_rcp_f32 v144, v144
    v_rcp_f32 v145, v145
    v_rcp_f32 v146, v146
    v_rcp_f32 v147, v147
    v_pk_mul_f32 v[52:53], v[52:53], v[144:145]
    v_pk_mul_f32 v[54:55], v[54:55], v[146:147]
    v_cvt_pk_bf16_f32 v46, v52, v53
    v_cvt_pk_bf16_f32 v47, v54, v55
    s_mov_b64 exec, s[52:53]
    v_swap_b32 v44, v46
    v_swap_b32 v45, v47
    s_mov_b64 exec, -1
    s_add_u32 s60, s42, s54
    buffer_store_dwordx4 v[44:47], v0, s[32:35], s60 offen sc1
    s_endpgm
K1_END:
    s_endpgm
.globl k2_kernel
.p2align 8
.type k2_kernel,@function
k2_kernel:
    s_cmp_ge_u32 s2, 256
    s_cbranch_scc1 K2_END
    s_load_dwordx2 s[16:17], s[0:1], 80
    s_load_dwordx2 s[4:5], s[0:1], 0
    s_load_dwordx4 s[8:11], s[0:1], 56
    v_and_b32 v1, 63, v0
    v_lshrrev_b32 v2, 6, v0
    v_lshlrev_b32 v0, 4, v1
    v_readfirstlane_b32 s40, v2
    s_getpc_b64 s[62:63]
K2_PC:
    s_bitcmp1_b32 s2, 3
    s_cselect_b32 s60, K2_H-K2_PC, 0
    s_lshl_b32 s61, s40, 10
    s_add_u32 s60, s60, s61
    s_mov_b32 s61, K2_END-K2_PC
    v_and_b32 v254, 7, v1
    v_lshl_add_u32 v254, v254, 7, s60
    v_min_u32 v254, s61, v254
    global_load_dword v255, v254, s[62:63]
    v_lshlrev_b32 v1, 3, v1
    s_bfe_u32 s41, s2, 0x20001
    s_lshl_b32 s41, s41, 2
    s_bfe_u32 s60, s2, 0x20004
    s_add_u32 s41, s41, s60
    s_and_b32 s54, s2, 1
    s_lshl_b32 s54, s54, 2
    s_lshr_b32 s60, s2, 6
    s_add_u32 s54, s54, s60
    s_mul_i32 s45, s54, 348160
    s_mul_i32 s44, s41, 557056
    s_and_b32 s50, s40, 3
    s_lshr_b32 s62, s40, 2
    s_bfe_u32 s63, s2, 0x10003
    s_lshl_b32 s53, s50, 1
    s_add_u32 s53, s53, s62
    s_xor_b32 s61, s53, 1
    s_mul_i32 s61, s61, 69632
    s_add_u32 s47, s44, s61
    s_mul_i32 s61, s53, 69632
    s_add_u32 s44, s44, s61
    s_lshl_b32 s61, s50, 10
    s_add_u32 s45, s45, s61
    s_mul_i32 s51, s62, 81920
    s_add_u32 s51, s51, s61
    s_cmp_eq_u32 s63, 0
    s_cselect_b32 s66, 9, 15
    s_cselect_b32 s67, 0, 18
    s_mul_i32 s66, s66, s62
    s_add_u32 s60, s66, s67
    s_lshl_b32 s60, s60, 10
    s_add_u32 s66, s44, s60
    s_add_u32 s67, s47, s60
    s_mul_i32 s60, s60, 5
    s_add_u32 s94, s45, s60
    s_add_u32 s94, s94, 102400
    s_lshl_b32 s63, s63, 1
    s_add_u32 s63, s63, s62
    s_mul_i32 s95, s63, 14336
    s_mul_i32 s60, s50, 1680
    s_add_u32 s95, s95, s60
    s_lshl_b32 s60, s63, 10
    s_add_u32 s60, s60, 65536
    s_add_u32 s64, s44, s60
    s_add_u32 s65, s47, s60
    s_mul_i32 s60, s63, 25600
    s_add_u32 s45, s45, s60
    s_lshl_b32 s60, s63, 12
    s_add_u32 s60, s60, 49152
    s_add_u32 s44, s44, s60
    s_add_u32 s47, s47, s60
    s_waitcnt lgkmcnt(0)
    s_add_u32 s36, s16, 0xd00000
    s_addc_u32 s37, s17, 0
    s_mov_b32 s38, 0xe000
    s_mov_b32 s39, 0x00020000
    s_mov_b32 s20, s16
    s_mov_b32 s21, s17
    s_mov_b32 s22, 0x880000
    s_mov_b32 s23, 0x00020000
    s_add_u32 s24, s16, 0x900000
    s_addc_u32 s25, s17, 0
    s_mov_b32 s26, 0x2a8000
    s_mov_b32 s27, 0x00020000
    s_bitcmp1_b32 s2, 3
    s_cbranch_scc1 K2_H
    s_lshr_b32 s55, s54, 1
    s_mul_i32 s55, s55, 320
    s_and_b32 s60, s54, 1
    s_lshl_b32 s82, s60, 3
    s_add_u32 s82, s82, s55
    s_add_u32 s82, s82, 128
    s_mul_i32 s60, s60, 192
    s_add_u32 s55, s55, s60
    s_mov_b32 s96, s4
    s_mov_b32 s97, s5
    s_mov_b32 s98, 0x280000
    s_mov_b32 s99, 0x00020000
    s_mov_b32 s68, s8
    s_mov_b32 s69, s9
    s_mov_b32 s70, 0x500
    s_mov_b32 s71, 0x00020000
    s_setprio 3
    buffer_load_dwordx4 v[92:95], v0, s[36:39], s95 offen offset:0
    buffer_load_dwordx4 v[96:99], v0, s[36:39], s95 offen offset:1024
    s_setprio 2
    s_add_u32 m0, s51, 16384
    s_add_u32 s83, s94, 0
    buffer_load_dwordx4 v0, s[24:27], s83 offen lds
    s_lshr_b32 s60, s40, 2
    s_mul_i32 s3, s60, 81920
    v_bfe_u32 v9, v0, 4, 2
    v_lshrrev_b32 v165, 8, v0
    v_min_u32 v164, 1, v165
    v_lshl_add_u32 v8, v165, 4, s3
    s_add_u32 s60, s3, 7816
    v_mov_b32 v7, s60
    v_cmp_eq_u32 s[60:61], 0, v9
    v_cmp_eq_u32 s[62:63], v164, v9
    v_cmp_eq_u32 s[88:89], 2, v9
    v_add_u32 v164, 2, v164
    v_cmp_eq_u32 s[90:91], v164, v9
    v_or_b32 v164, 1, v165
    s_add_u32 m0, s51, 20480
    s_add_u32 s83, s94, 4096
    buffer_load_dwordx4 v0, s[24:27], s83 offen lds
    v_cmp_eq_u32 s[92:93], v164, v9
    v_cmp_eq_u32 s[84:85], 0, v165
    v_cmp_gt_u32 s[86:87], 2, v165
    v_add_u32 v2, 7680, v8
    v_add_u32 v3, 7688, v8
    v_add_u32 v4, 7744, v8
    v_add_u32 v5, 7752, v8
    v_add_u32 v6, 7808, v8
    v_cndmask_b32 v2, v7, v2, s[60:61]
    v_cndmask_b32 v3, v7, v3, s[62:63]
    v_cndmask_b32 v4, v7, v4, s[88:89]
    v_cndmask_b32 v5, v7, v5, s[90:91]
    v_cndmask_b32 v6, v7, v6, s[92:93]
    v_add_u32 v7, s3, v0
    buffer_load_dwordx4 v[20:23], v0, s[20:23], s65 offen offset:0
    v_add_u32 v8, 0x10000, v7
    v_add_u32 v1, s3, v1
    v_mov_b32 v134, 0
    v_mov_b32 v135, 0
    v_mov_b32 v140, 0
    v_mov_b32 v141, 0
    v_mov_b32 v146, 0
    v_mov_b32 v147, 0
    v_mov_b32 v160, 0
    v_mov_b32 v161, 0
    v_mov_b32 v132, 0
    v_mov_b32 v133, 0
    v_add_u32 v164, s51, v0
    ds_write_b128 v164, v[132:135] offset:0
    buffer_load_dwordx4 v[24:27], v0, s[20:23], s47 offen offset:0
    ds_write_b128 v164, v[132:135] offset:4096
    ds_write_b128 v164, v[132:135] offset:8192
    ds_write_b128 v164, v[132:135] offset:12288
    s_lshr_b32 s60, s50, 1
    s_and_b32 s61, s50, 1
    s_mul_i32 s62, s61, 5
    s_mul_i32 s61, s61, 20
    s_lshl_b32 s63, s60, 3
    v_mov_b32 v172, s63
    s_mul_i32 s63, s60, -504
    v_mov_b32 v173, s63
    s_lshl_b32 s63, s60, 12
    s_add_u32 s63, s63, s3
    v_lshrrev_b32 v164, 4, v0
    buffer_load_dwordx4 v[28:31], v0, s[20:23], s47 offen offset:1024
    s_setprio 1
    v_mul_u32_u24 v165, 205, v164
    v_lshrrev_b32 v165, 10, v165
    v_mad_i32_i24 v166, v165, -5, v164
    v_add_u32 v166, s62, v166
    v_cmp_le_u32 s[88:89], 8, v166
    v_and_b32 v167, 3, v166
    v_lshl_add_u32 v174, s60, 1, v167
    v_cndmask_b32 v167, v167, v174, s[88:89]
    v_bfe_u32 v166, v166, 2, 1
    v_add_u32 v174, s61, v165
    v_cmp_le_u32 vcc, 32, v174
    v_and_b32 v116, 15, v174
    v_lshrrev_b32 v174, 4, v174
    v_lshl_add_u32 v116, v174, 6, v116
    s_add_u32 m0, s51, 24576
    s_add_u32 s83, s94, 8192
    buffer_load_dwordx4 v0, s[24:27], s83 offen lds
    v_lshl_add_u32 v116, v167, 4, v116
    v_cndmask_b32 v174, 0, v172, vcc
    v_cndmask_b32 v175, 0, v173, vcc
    v_add_lshl_u32 v174, v174, v116, 4
    v_add_lshl_u32 v175, v175, v116, 3
    v_lshl_add_u32 v174, v166, 3, v174
    v_add_u32 v175, 2560, v175
    v_cndmask_b32 v116, v174, v175, s[88:89]
    v_add_u32 v116, s63, v116
    v_add_u32 v164, 64, v164
    v_mul_u32_u24 v165, 205, v164
    v_lshrrev_b32 v165, 10, v165
    v_mad_i32_i24 v166, v165, -5, v164
    v_add_u32 v166, s62, v166
    buffer_load_dwordx4 v[32:35], v0, s[20:23], s64 offen offset:0
    v_cmp_le_u32 s[88:89], 8, v166
    v_and_b32 v167, 3, v166
    v_lshl_add_u32 v174, s60, 1, v167
    v_cndmask_b32 v167, v167, v174, s[88:89]
    v_bfe_u32 v166, v166, 2, 1
    v_add_u32 v174, s61, v165
    v_cmp_le_u32 vcc, 32, v174
    v_and_b32 v117, 15, v174
    v_lshrrev_b32 v174, 4, v174
    v_lshl_add_u32 v117, v174, 6, v117
    v_lshl_add_u32 v117, v167, 4, v117
    v_cndmask_b32 v174, 0, v172, vcc
    v_cndmask_b32 v175, 0, v173, vcc
    v_add_lshl_u32 v174, v174, v117, 4
    buffer_load_dwordx4 v[36:39], v0, s[20:23], s44 offen offset:0
    s_setprio 0
    v_add_lshl_u32 v175, v175, v117, 3
    v_lshl_add_u32 v174, v166, 3, v174
    v_add_u32 v175, 2560, v175
    v_cndmask_b32 v117, v174, v175, s[88:89]
    v_add_u32 v117, s63, v117
    s_lshl_b32 s60, s60, 6
    v_lshl_add_u32 v174, v166, 3, s60
    v_cmp_eq_u32 vcc, 20, v165
    v_cndmask_b32 v174, v174, 64, s[88:89]
    v_cmp_lt_u32 s[90:91], 20, v165
    v_cndmask_b32 v175, 0, 64, s[88:89]
    v_add_u32 v174, v174, v175
    v_lshl_add_u32 v174, v167, 4, v174
    v_lshl_add_u32 v175, v164, 3, s3
    s_add_u32 s60, s3, 7680
    v_add_u32 v174, s60, v174
    v_add_u32 v175, 7168, v175
    v_cndmask_b32 v117, v117, v174, vcc
    v_cndmask_b32 v117, v117, v175, s[90:91]
    s_waitcnt lgkmcnt(0)
    s_barrier
    s_waitcnt vmcnt(9)
    v_cvt_pk_bf16_f32 v92, v92, v93
    v_cvt_pk_bf16_f32 v93, v94, v95
    ds_write_b64 v116, v[92:93] offset:0
    s_waitcnt vmcnt(8)
    v_cvt_pk_bf16_f32 v96, v96, v97
    v_cvt_pk_bf16_f32 v97, v98, v99
    ds_write_b64 v117, v[96:97] offset:0
    s_lshl_b32 s60, s41, 3
    s_add_u32 s61, s60, s53
    s_waitcnt lgkmcnt(0)
    s_waitcnt vmcnt(6)
    buffer_load_dwordx4 v[40:43], v0, s[20:23], s44 offen offset:1024
    s_add_u32 s95, s95, 7168
    buffer_load_dwordx4 v[104:107], v0, s[36:39], s95 offen offset:0
    buffer_load_dwordx4 v[108:111], v0, s[36:39], s95 offen offset:1024
    buffer_load_dwordx4 v[44:47], v0, s[20:23], s67 offen offset:0
    s_barrier
    ds_read_b64 v[158:159], v6 offset:0
    ds_read_b64 v[132:133], v1 offset:3072
    ds_read_b64 v[138:139], v1 offset:7168
    ds_read_b64 v[144:145], v1 offset:3584
    ds_read_b64 v[150:151], v2 offset:0
    ds_read_b64 v[152:153], v3 offset:0
    ds_read_b128 v[212:215], v7 offset:0
    ds_read_b128 v[216:219], v7 offset:4096
    s_waitcnt vmcnt(9)
    s_waitcnt lgkmcnt(7)
    v_mfma_f32_16x16x32_bf16 v[184:187], v[158:161], v[20:23], 0
    ds_read_b64 v[154:155], v4 offset:0
    ds_read_b64 v[156:157], v5 offset:0
    s_mul_i32 s42, s61, 20480
    s_lshr_b32 s61, s54, 1
    s_mul_i32 s61, s61, 320
    s_add_u32 s42, s42, s61
    s_waitcnt lgkmcnt(8)
    v_mfma_f32_16x16x32_bf16 v[168:171], v[132:135], v[20:23], 0
    ds_read_b128 v[220:223], v7 offset:1024
    ds_read_b128 v[224:227], v7 offset:5120
    s_and_b32 s61, s54, 1
    s_lshl_b32 s43, s61, 3
    s_add_u32 s43, s43, s42
    s_add_u32 s43, s43, 128
    s_waitcnt lgkmcnt(9)
    v_mfma_f32_16x16x32_bf16 v[176:179], v[138:141], v[20:23], 0
    ds_read_b128 v[228:231], v7 offset:2048
    ds_read_b128 v[232:235], v7 offset:6144
    s_mul_i32 s61, s61, 192
    s_add_u32 s42, s42, s61
    s_add_u32 s60, s60, s54
    s_lshl_b32 s60, s60, 3
    s_waitcnt lgkmcnt(10)
    v_mfma_f32_16x16x32_bf16 v[180:183], v[144:147], v[20:23], 0
    buffer_load_dwordx4 v[48:51], v0, s[20:23], s66 offen offset:0
    s_add_u32 s60, s60, s53
    s_mul_i32 s46, s60, 2688
    s_mul_i32 s52, s60, 5120
    v_lshrrev_b32 v9, 6, v0
    s_waitcnt vmcnt(9)
    s_waitcnt lgkmcnt(8)
    v_mfma_f32_16x16x32_bf16 v[184:187], v[150:153], v[24:27], v[184:187]
    v_mul_u32_u24 v11, 1280, v9
    v_and_b32 v9, 48, v0
    v_add_u32 v11, v9, v11
    s_add_u32 s28, s16, 0x1400000
    s_addc_u32 s29, s17, 0
    s_waitcnt lgkmcnt(7)
    v_mfma_f32_16x16x32_bf16 v[164:167], v[212:215], v[24:27], 0
    s_mov_b32 s30, 0x2a0000
    s_mov_b32 s31, 0x00020000
    s_add_u32 s32, s16, 0x1800000
    s_addc_u32 s33, s17, 0
    s_waitcnt vmcnt(8)
    s_waitcnt lgkmcnt(6)
    v_mfma_f32_16x16x32_bf16 v[172:175], v[216:219], v[28:31], 0
    s_mov_b32 s34, 0x500000
    s_mov_b32 s35, 0x00020000
    s_mov_b32 s56, s10
    s_mov_b32 s57, s11
    s_waitcnt lgkmcnt(4)
    v_mfma_f32_16x16x32_bf16 v[184:187], v[154:157], v[28:31], v[184:187]
    s_add_u32 m0, s51, 28672
    s_add_u32 s83, s94, 12288
    buffer_load_dwordx4 v0, s[24:27], s83 offen lds
    s_mov_b32 s58, 0x280000
    s_mov_b32 s59, 0x00020000
    s_waitcnt lgkmcnt(3)
    v_mfma_f32_16x16x32_bf16 v[168:171], v[220:223], v[24:27], v[168:171]
    s_waitcnt lgkmcnt(2)
    v_mfma_f32_16x16x32_bf16 v[176:179], v[224:227], v[28:31], v[176:179]
    s_waitcnt lgkmcnt(1)
    v_mfma_f32_16x16x32_bf16 v[180:183], v[228:231], v[24:27], v[180:183]
    s_waitcnt lgkmcnt(0)
    v_mfma_f32_16x16x32_bf16 v[180:183], v[232:235], v[28:31], v[180:183]
    s_add_u32 m0, s51, 32768
    s_add_u32 s83, s45, 0
    buffer_load_dwordx4 v0, s[24:27], s83 offen lds
    s_waitcnt vmcnt(8)
    v_mfma_f32_16x16x32_bf16 v[208:211], v[158:161], v[32:35], 0
    ds_read_b128 v[236:239], v7 offset:16384
    ds_read_b128 v[240:243], v7 offset:17408
    s_waitcnt vmcnt(5)
    v_cvt_pk_bf16_f32 v104, v104, v105
    v_mfma_f32_16x16x32_bf16 v[192:195], v[132:135], v[32:35], 0
    ds_read_b128 v[244:247], v7 offset:18432
    ds_read_b128 v[248:251], v7 offset:19456
    v_cvt_pk_bf16_f32 v105, v106, v107
    ds_write_b64 v116, v[104:105] offset:8192
    v_mfma_f32_16x16x32_bf16 v[200:203], v[138:141], v[32:35], 0
    ds_read_b128 v[252:255], v7 offset:20480
    s_add_u32 m0, s51, 36864
    s_add_u32 s83, s45, 4096
    buffer_load_dwordx4 v0, s[24:27], s83 offen lds
    s_waitcnt vmcnt(5)
    v_cvt_pk_bf16_f32 v108, v108, v109
    v_mfma_f32_16x16x32_bf16 v[204:207], v[144:147], v[32:35], 0
    v_cvt_pk_bf16_f32 v109, v110, v111
    ds_write_b64 v117, v[108:109] offset:8192
    v_mfma_f32_16x16x32_bf16 v[208:211], v[150:153], v[36:39], v[208:211]
    s_nop 1
    v_add_f32 v184, 0x358637bd, v184
    v_mfma_f32_16x16x32_bf16 v[188:191], v[212:215], v[36:39], 0
    v_add_f32 v185, 0x358637bd, v185
    v_add_f32 v186, 0x358637bd, v186
    v_mfma_f32_16x16x32_bf16 v[196:199], v[216:219], v[40:43], 0
    buffer_load_dwordx4 v[52:55], v0, s[20:23], s67 offen offset:1024
    v_add_f32 v187, 0x358637bd, v187
    v_rcp_f32 v184, v184
    v_mfma_f32_16x16x32_bf16 v[208:211], v[154:157], v[40:43], v[208:211]
    v_rcp_f32 v185, v185
    v_mfma_f32_16x16x32_bf16 v[192:195], v[220:223], v[36:39], v[192:195]
    v_rcp_f32 v186, v186
    v_mfma_f32_16x16x32_bf16 v[200:203], v[224:227], v[40:43], v[200:203]
    v_rcp_f32 v187, v187
    v_mfma_f32_16x16x32_bf16 v[204:207], v[228:231], v[36:39], v[204:207]
    buffer_load_dwordx4 v[56:59], v0, s[20:23], s66 offen offset:1024
    v_cndmask_b32 v9, v185, v184, s[84:85]
    v_mfma_f32_16x16x32_bf16 v[204:207], v[232:235], v[40:43], v[204:207]
    v_cndmask_b32 v10, v187, v186, s[84:85]
    v_cndmask_b32 v185, v187, v185, s[86:87]
    s_waitcnt lgkmcnt(0)
    s_barrier
    ds_read_b128 v[212:215], v7 offset:21504
    ds_read_b128 v[216:219], v7 offset:22528
    s_waitcnt vmcnt(6)
    v_mfma_f32_16x16x32_bf16 v[112:115], v[236:239], v[44:47], 0
    ds_read_b128 v[220:223], v7 offset:23552
    ds_read_b128 v[224:227], v7 offset:24576
    v_mul_f32 v164, v164, v184
    v_mul_f32 v165, v165, v184
    s_waitcnt vmcnt(5)
    v_mfma_f32_16x16x32_bf16 v[92:95], v[236:239], v[48:51], 0
    ds_read_b128 v[228:231], v7 offset:25600
    buffer_load_dwordx4 v[60:63], v0, s[20:23], s47 offen offset:2048
    v_mul_f32 v166, v166, v184
    v_mul_f32 v167, v167, v184
    v_mfma_f32_16x16x32_bf16 v[116:119], v[240:243], v[44:47], 0
    v_cvt_pk_bf16_f32 v24, v164, v165
    v_cvt_pk_bf16_f32 v25, v166, v167
    v_mfma_f32_16x16x32_bf16 v[96:99], v[240:243], v[48:51], 0
    v_mul_f32 v168, v168, v9
    v_mul_f32 v169, v169, v9
    v_mfma_f32_16x16x32_bf16 v[120:123], v[244:247], v[44:47], 0
    v_mul_f32 v170, v170, v9
    v_mul_f32 v171, v171, v9
    v_mfma_f32_16x16x32_bf16 v[100:103], v[244:247], v[48:51], 0
    buffer_load_dwordx4 v[64:67], v0, s[20:23], s47 offen offset:3072
    v_cvt_pk_bf16_f32 v26, v168, v169
    v_cvt_pk_bf16_f32 v27, v170, v171
    v_mfma_f32_16x16x32_bf16 v[124:127], v[248:251], v[44:47], 0
    v_mul_f32 v172, v172, v186
    v_mul_f32 v173, v173, v186
    v_mfma_f32_16x16x32_bf16 v[104:107], v[248:251], v[48:51], 0
    v_mul_f32 v174, v174, v186
    v_mul_f32 v175, v175, v186
    v_mfma_f32_16x16x32_bf16 v[128:131], v[252:255], v[44:47], 0
    v_cvt_pk_bf16_f32 v28, v172, v173
    v_cvt_pk_bf16_f32 v29, v174, v175
    v_mfma_f32_16x16x32_bf16 v[108:111], v[252:255], v[48:51], 0
    buffer_load_dwordx4 v[68:71], v0, s[20:23], s44 offen offset:2048
    v_mul_f32 v176, v176, v10
    v_mul_f32 v177, v177, v10
    s_waitcnt vmcnt(4)
    s_waitcnt lgkmcnt(4)
    v_mfma_f32_16x16x32_bf16 v[112:115], v[212:215], v[52:55], v[112:115]
    ds_read_b64 v[162:163], v6 offset:8192
    ds_read_b64 v[136:137], v1 offset:11264
    v_mul_f32 v178, v178, v10
    v_mul_f32 v179, v179, v10
    s_waitcnt vmcnt(3)
    v_mfma_f32_16x16x32_bf16 v[92:95], v[212:215], v[56:59], v[92:95]
    ds_read_b64 v[142:143], v1 offset:15360
    ds_read_b64 v[148:149], v1 offset:11776
    v_cvt_pk_bf16_f32 v30, v176, v177
    v_cvt_pk_bf16_f32 v31, v178, v179
    s_waitcnt lgkmcnt(7)
    v_mfma_f32_16x16x32_bf16 v[116:119], v[216:219], v[52:55], v[116:119]
    ds_read_b64 v[150:151], v2 offset:8192
    ds_read_b64 v[152:153], v3 offset:8192
    buffer_load_dwordx4 v[72:75], v0, s[20:23], s44 offen offset:3072
    v_mul_f32 v180, v180, v185
    v_mul_f32 v181, v181, v185
    v_mfma_f32_16x16x32_bf16 v[96:99], v[216:219], v[56:59], v[96:99]
    ds_read_b128 v[232:235], v7 offset:8192
    ds_read_b128 v[236:239], v7 offset:12288
    v_mul_f32 v182, v182, v185
    v_mul_f32 v183, v183, v185
    s_waitcnt lgkmcnt(10)
    v_mfma_f32_16x16x32_bf16 v[120:123], v[220:223], v[52:55], v[120:123]
    ds_read_b64 v[154:155], v4 offset:8192
    ds_read_b64 v[156:157], v5 offset:8192
    v_cvt_pk_bf16_f32 v12, v180, v181
    v_cvt_pk_bf16_f32 v13, v182, v183
    v_mfma_f32_16x16x32_bf16 v[100:103], v[220:223], v[56:59], v[100:103]
    ds_read_b128 v[240:243], v7 offset:9216
    ds_read_b128 v[244:247], v7 offset:13312
    s_nop 1
    v_add_f32 v208, 0x358637bd, v208
    s_waitcnt lgkmcnt(13)
    v_mfma_f32_16x16x32_bf16 v[124:127], v[224:227], v[52:55], v[124:127]
    ds_read_b128 v[248:251], v7 offset:10240
    s_add_u32 m0, s51, 40960
    s_add_u32 s83, s45, 8192
    buffer_load_dwordx4 v0, s[24:27], s83 offen lds
    v_add_f32 v209, 0x358637bd, v209
    v_add_f32 v210, 0x358637bd, v210
    v_mfma_f32_16x16x32_bf16 v[104:107], v[224:227], v[56:59], v[104:107]
    v_add_f32 v211, 0x358637bd, v211
    v_rcp_f32 v208, v208
    s_waitcnt lgkmcnt(13)
    v_mfma_f32_16x16x32_bf16 v[128:131], v[228:231], v[52:55], v[128:131]
    ds_read_b128 v[252:255], v7 offset:14336
    v_rcp_f32 v209, v209
    v_mfma_f32_16x16x32_bf16 v[108:111], v[228:231], v[56:59], v[108:111]
    v_rcp_f32 v210, v210
    s_barrier
    s_waitcnt lgkmcnt(13)
    v_mfma_f32_16x16x32_bf16 v[184:187], v[160:163], v[20:23], 0
    s_add_u32 m0, s51, 45056
    s_add_u32 s83, s94, 16384
    buffer_load_dwordx4 v0, s[24:27], s83 offen lds
    v_rcp_f32 v211, v211
    s_waitcnt lgkmcnt(12)
    v_mfma_f32_16x16x32_bf16 v[168:171], v[134:137], v[20:23], 0
    v_cndmask_b32 v9, v209, v208, s[84:85]
    s_waitcnt lgkmcnt(11)
    v_mfma_f32_16x16x32_bf16 v[176:179], v[140:143], v[20:23], 0
    v_cndmask_b32 v10, v211, v210, s[84:85]
    v_cndmask_b32 v209, v211, v209, s[86:87]
    s_waitcnt lgkmcnt(10)
    v_mfma_f32_16x16x32_bf16 v[180:183], v[146:149], v[20:23], 0
    v_mul_f32 v188, v188, v208
    v_mul_f32 v189, v189, v208
    s_waitcnt vmcnt(5)
    s_waitcnt lgkmcnt(8)
    v_mfma_f32_16x16x32_bf16 v[184:187], v[150:153], v[60:63], v[184:187]
    s_add_u32 m0, s51, 49152
    s_add_u32 s83, s45, 12288
    buffer_load_dwordx4 v0, s[24:27], s83 offen lds
    v_mul_f32 v190, v190, v208
    v_mul_f32 v191, v191, v208
    s_waitcnt lgkmcnt(7)
    v_mfma_f32_16x16x32_bf16 v[164:167], v[232:235], v[60:63], 0
    v_cvt_pk_bf16_f32 v36, v188, v189
    v_cvt_pk_bf16_f32 v37, v190, v191
    s_waitcnt vmcnt(5)
    s_waitcnt lgkmcnt(6)
    v_mfma_f32_16x16x32_bf16 v[172:175], v[236:239], v[64:67], 0
    v_mul_f32 v192, v192, v9
    v_mul_f32 v193, v193, v9
    s_waitcnt lgkmcnt(4)
    v_mfma_f32_16x16x32_bf16 v[184:187], v[154:157], v[64:67], v[184:187]
    buffer_load_dwordx4 v[76:79], v0, s[20:23], s67 offen offset:2048
    v_mul_f32 v194, v194, v9
    v_mul_f32 v195, v195, v9
    s_waitcnt lgkmcnt(3)
    v_mfma_f32_16x16x32_bf16 v[168:171], v[240:243], v[60:63], v[168:171]
    v_cvt_pk_bf16_f32 v38, v192, v193
    v_cvt_pk_bf16_f32 v39, v194, v195
    s_waitcnt lgkmcnt(2)
    v_mfma_f32_16x16x32_bf16 v[176:179], v[244:247], v[64:67], v[176:179]
    v_mul_f32 v196, v196, v210
    v_mul_f32 v197, v197, v210
    s_waitcnt lgkmcnt(1)
    v_mfma_f32_16x16x32_bf16 v[180:183], v[248:251], v[60:63], v[180:183]
    v_mul_f32 v198, v198, v210
    v_mul_f32 v199, v199, v210
    s_waitcnt lgkmcnt(0)
    v_mfma_f32_16x16x32_bf16 v[180:183], v[252:255], v[64:67], v[180:183]
    buffer_load_dwordx4 v[80:83], v0, s[20:23], s66 offen offset:2048
    v_cvt_pk_bf16_f32 v40, v196, v197
    v_cvt_pk_bf16_f32 v41, v198, v199
    s_lshl_b32 s60, s50, 11
    s_add_u32 s60, s60, 81920
    s_sub_u32 s60, s60, s51
    v_add_u32 v4, s60, v0
    v_add_u32 v5, s51, v0
    v_lshrrev_b32 v1, 1, v0
    v_and_b32 v3, 0xf0, v0
    v_lshl_add_u32 v2, v3, 2, s51
    v_lshrrev_b32 v3, 8, v0
    v_lshl_add_u32 v2, v3, 4, v2
    v_lshlrev_b32 v3, 4, v3
    s_and_b32 s60, s43, 8
    v_add_u32 v6, s60, v2
    v_mul_f32 v200, v200, v10
    v_mul_f32 v201, v201, v10
    v_mul_f32 v202, v202, v10
    v_mul_f32 v203, v203, v10
    v_cvt_pk_bf16_f32 v42, v200, v201
    v_cvt_pk_bf16_f32 v43, v202, v203
    v_mul_f32 v204, v204, v209
    v_mul_f32 v205, v205, v209
    v_mul_f32 v206, v206, v209
    v_mul_f32 v207, v207, v209
    v_cvt_pk_bf16_f32 v16, v204, v205
    v_cvt_pk_bf16_f32 v17, v206, v207
    s_nop 1
    v_mfma_f32_16x16x32_bf16 v[208:211], v[160:163], v[32:35], 0
    ds_read_b128 v[212:215], v7 offset:26624
    ds_read_b128 v[216:219], v7 offset:27648
    v_add_f32 v184, 0x358637bd, v184
    v_add_f32 v185, 0x358637bd, v185
    v_mfma_f32_16x16x32_bf16 v[192:195], v[134:137], v[32:35], 0
    ds_read_b128 v[220:223], v7 offset:28672
    ds_read_b128 v[224:227], v7 offset:29696
    v_add_f32 v186, 0x358637bd, v186
    v_add_f32 v187, 0x358637bd, v187
    v_mfma_f32_16x16x32_bf16 v[200:203], v[140:143], v[32:35], 0
    ds_read_b128 v[228:231], v7 offset:30720
    v_rcp_f32 v184, v184
    v_mfma_f32_16x16x32_bf16 v[204:207], v[146:149], v[32:35], 0
    s_add_u32 m0, s51, 65536
    s_add_u32 s83, s45, 16384
    buffer_load_dwordx4 v0, s[24:27], s83 offen lds
    v_rcp_f32 v185, v185
    s_waitcnt vmcnt(7)
    v_mfma_f32_16x16x32_bf16 v[208:211], v[150:153], v[68:71], v[208:211]
    v_rcp_f32 v186, v186
    v_mfma_f32_16x16x32_bf16 v[188:191], v[232:235], v[68:71], 0
    v_rcp_f32 v187, v187
    s_waitcnt vmcnt(6)
    v_mfma_f32_16x16x32_bf16 v[196:199], v[236:239], v[72:75], 0
    s_add_u32 m0, s51, 69632
    s_add_u32 s83, s45, 20480
    buffer_load_dwordx4 v0, s[24:27], s83 offen lds
    v_cndmask_b32 v9, v185, v184, s[84:85]
    v_cndmask_b32 v10, v187, v186, s[84:85]
    v_mfma_f32_16x16x32_bf16 v[208:211], v[154:157], v[72:75], v[208:211]
    v_cndmask_b32 v185, v187, v185, s[86:87]
    v_mul_f32 v164, v164, v184
    v_mfma_f32_16x16x32_bf16 v[192:195], v[240:243], v[68:71], v[192:195]
    v_mul_f32 v165, v165, v184
    v_mul_f32 v166, v166, v184
    v_mfma_f32_16x16x32_bf16 v[200:203], v[244:247], v[72:75], v[200:203]
    v_mul_f32 v167, v167, v184
    v_cvt_pk_bf16_f32 v60, v164, v165
    v_mfma_f32_16x16x32_bf16 v[204:207], v[248:251], v[68:71], v[204:207]
    s_add_u32 m0, s51, 73728
    s_add_u32 s83, s45, 24576
    s_cmp_ge_u32 s50, 1
    s_cbranch_scc1 K2_POW
    buffer_load_dwordx4 v0, s[24:27], s83 offen lds
K2_POW:
    v_cvt_pk_bf16_f32 v61, v166, v167
    v_mul_f32 v168, v168, v9
    v_mfma_f32_16x16x32_bf16 v[204:207], v[252:255], v[72:75], v[204:207]
    v_mul_f32 v169, v169, v9
    v_mul_f32 v170, v170, v9
    s_waitcnt vmcnt(3)
    s_waitcnt lgkmcnt(4)
    v_mfma_f32_16x16x32_bf16 v[112:115], v[212:215], v[76:79], v[112:115]
    ds_read_b128 v[232:235], v7 offset:32768
    ds_read_b128 v[236:239], v7 offset:33792
    v_mul_f32 v171, v171, v9
    v_cvt_pk_bf16_f32 v62, v168, v169
    s_waitcnt vmcnt(2)
    v_mfma_f32_16x16x32_bf16 v[92:95], v[212:215], v[80:83], v[92:95]
    ds_read_b128 v[240:243], v7 offset:34816
    ds_read_b128 v[244:247], v7 offset:35840
    v_cvt_pk_bf16_f32 v63, v170, v171
    v_mul_f32 v172, v172, v186
    s_waitcnt lgkmcnt(7)
    v_mfma_f32_16x16x32_bf16 v[116:119], v[216:219], v[76:79], v[116:119]
    ds_read_b128 v[248:251], v7 offset:36864
    s_add_u32 m0, s51, 77824
    s_add_u32 s83, s94, 20480
    buffer_load_dwordx4 v0, s[24:27], s83 offen lds
    v_mul_f32 v173, v173, v186
    v_mul_f32 v174, v174, v186
    v_mfma_f32_16x16x32_bf16 v[96:99], v[216:219], v[80:83], v[96:99]
    v_mul_f32 v175, v175, v186
    v_cvt_pk_bf16_f32 v64, v172, v173
    s_waitcnt lgkmcnt(7)
    v_mfma_f32_16x16x32_bf16 v[120:123], v[220:223], v[76:79], v[120:123]
    v_cvt_pk_bf16_f32 v65, v174, v175
    v_mul_f32 v176, v176, v10
    v_mfma_f32_16x16x32_bf16 v[100:103], v[220:223], v[80:83], v[100:103]
    s_add_u32 m0, s51, 0
    s_add_u32 s83, s94, 24576
    buffer_load_dwordx4 v0, s[24:27], s83 offen lds
    v_mul_f32 v177, v177, v10
    v_mul_f32 v178, v178, v10
    s_waitcnt lgkmcnt(6)
    v_mfma_f32_16x16x32_bf16 v[124:127], v[224:227], v[76:79], v[124:127]
    v_mul_f32 v179, v179, v10
    v_cvt_pk_bf16_f32 v66, v176, v177
    v_mfma_f32_16x16x32_bf16 v[104:107], v[224:227], v[80:83], v[104:107]
    v_cvt_pk_bf16_f32 v67, v178, v179
    v_mul_f32 v180, v180, v185
    s_waitcnt lgkmcnt(5)
    v_mfma_f32_16x16x32_bf16 v[128:131], v[228:231], v[76:79], v[128:131]
    v_mul_f32 v181, v181, v185
    v_mul_f32 v182, v182, v185
    v_mfma_f32_16x16x32_bf16 v[108:111], v[228:231], v[80:83], v[108:111]
    buffer_load_dwordx4 v[84:87], v0, s[20:23], s67 offen offset:3072
    v_mul_f32 v183, v183, v185
    v_cvt_pk_bf16_f32 v14, v180, v181
    s_barrier
    ds_read_b128 v[252:255], v7 offset:37888
    ds_read_b128 v[212:215], v7 offset:38912
    s_waitcnt lgkmcnt(6)
    v_mfma_f32_16x16x32_bf16 v[112:115], v[232:235], v[24:27], v[112:115]
    ds_read_b128 v[216:219], v7 offset:39936
    ds_read_b128 v[220:223], v7 offset:40960
    v_cvt_pk_bf16_f32 v15, v182, v183
    s_nop 1
    v_mfma_f32_16x16x32_bf16 v[92:95], v[232:235], v[36:39], v[92:95]
    ds_read_b128 v[224:227], v7 offset:41984
    v_add_f32 v208, 0x358637bd, v208
    v_add_f32 v209, 0x358637bd, v209
    s_waitcnt lgkmcnt(8)
    v_mfma_f32_16x16x32_bf16 v[116:119], v[236:239], v[24:27], v[116:119]
    v_add_f32 v210, 0x358637bd, v210
    v_add_f32 v211, 0x358637bd, v211
    v_mfma_f32_16x16x32_bf16 v[96:99], v[236:239], v[36:39], v[96:99]
    buffer_load_dwordx4 v[88:91], v0, s[20:23], s66 offen offset:3072
    v_rcp_f32 v208, v208
    s_waitcnt lgkmcnt(7)
    v_mfma_f32_16x16x32_bf16 v[120:123], v[240:243], v[24:27], v[120:123]
    v_rcp_f32 v209, v209
    v_mfma_f32_16x16x32_bf16 v[100:103], v[240:243], v[36:39], v[100:103]
    v_rcp_f32 v210, v210
    s_waitcnt lgkmcnt(6)
    v_mfma_f32_16x16x32_bf16 v[124:127], v[244:247], v[24:27], v[124:127]
    v_rcp_f32 v211, v211
    v_mfma_f32_16x16x32_bf16 v[104:107], v[244:247], v[36:39], v[104:107]
    s_add_u32 m0, s51, 53248
    s_add_u32 s61, s42, 0
    buffer_load_dwordx4 v11, s[96:99], s61 offen lds
    v_cndmask_b32 v9, v209, v208, s[84:85]
    v_cndmask_b32 v10, v211, v210, s[84:85]
    s_waitcnt lgkmcnt(5)
    v_mfma_f32_16x16x32_bf16 v[128:131], v[248:251], v[24:27], v[128:131]
    v_cndmask_b32 v209, v211, v209, s[86:87]
    v_mul_f32 v188, v188, v208
    v_mfma_f32_16x16x32_bf16 v[108:111], v[248:251], v[36:39], v[108:111]
    v_mul_f32 v189, v189, v208
    v_mul_f32 v190, v190, v208
    s_waitcnt lgkmcnt(4)
    v_mfma_f32_16x16x32_bf16 v[112:115], v[252:255], v[28:31], v[112:115]
    ds_read_b128 v[228:231], v7 offset:31744
    ds_read_b128 v[232:235], v7 offset:45056
    s_add_u32 m0, s51, 57344
    s_add_u32 s61, s42, 64
    buffer_load_dwordx4 v11, s[96:99], s61 offen lds
    v_mul_f32 v191, v191, v208
    v_cvt_pk_bf16_f32 v68, v188, v189
    v_mfma_f32_16x16x32_bf16 v[92:95], v[252:255], v[40:43], v[92:95]
    ds_read_b128 v[236:239], v7 offset:46080
    ds_read_b128 v[240:243], v7 offset:47104
    v_cvt_pk_bf16_f32 v69, v190, v191
    v_mul_f32 v192, v192, v9
    s_waitcnt lgkmcnt(7)
    v_mfma_f32_16x16x32_bf16 v[116:119], v[212:215], v[28:31], v[116:119]
    ds_read_b128 v[244:247], v7 offset:48128
    v_mul_f32 v193, v193, v9
    v_mul_f32 v194, v194, v9
    v_mfma_f32_16x16x32_bf16 v[96:99], v[212:215], v[40:43], v[96:99]
    v_mul_f32 v195, v195, v9
    v_cvt_pk_bf16_f32 v70, v192, v193
    s_waitcnt lgkmcnt(7)
    v_mfma_f32_16x16x32_bf16 v[120:123], v[216:219], v[28:31], v[120:123]
    s_add_u32 m0, s51, 61440
    s_and_b32 s61, s43, -16
    buffer_load_dwordx4 v11, s[96:99], s61 offen lds
    v_cvt_pk_bf16_f32 v71, v194, v195
    v_mul_f32 v196, v196, v210
    v_mfma_f32_16x16x32_bf16 v[100:103], v[216:219], v[40:43], v[100:103]
    v_mul_f32 v197, v197, v210
    v_mul_f32 v198, v198, v210
    s_waitcnt lgkmcnt(6)
    v_mfma_f32_16x16x32_bf16 v[124:127], v[220:223], v[28:31], v[124:127]
    v_mul_f32 v199, v199, v210
    v_cvt_pk_bf16_f32 v72, v196, v197
    v_mfma_f32_16x16x32_bf16 v[104:107], v[220:223], v[40:43], v[104:107]
    v_cvt_pk_bf16_f32 v73, v198, v199
    v_mul_f32 v200, v200, v10
    s_waitcnt lgkmcnt(5)
    v_mfma_f32_16x16x32_bf16 v[128:131], v[224:227], v[28:31], v[128:131]
    buffer_load_dwordx4 v[142:145], v3, s[68:71], s55 offen offset:0
    v_mul_f32 v201, v201, v10
    v_mul_f32 v202, v202, v10
    v_mfma_f32_16x16x32_bf16 v[108:111], v[224:227], v[40:43], v[108:111]
    v_mul_f32 v203, v203, v10
    v_cvt_pk_bf16_f32 v74, v200, v201
    s_waitcnt vmcnt(5)
    s_waitcnt lgkmcnt(4)
    v_mfma_f32_16x16x32_bf16 v[112:115], v[228:231], v[84:87], v[112:115]
    ds_read_b128 v[248:251], v7 offset:43008
    ds_read_b128 v[252:255], v7 offset:44032
    v_cvt_pk_bf16_f32 v75, v202, v203
    v_mul_f32 v204, v204, v209
    s_waitcnt vmcnt(4)
    v_mfma_f32_16x16x32_bf16 v[92:95], v[228:231], v[88:91], v[92:95]
    ds_read_b128 v[212:215], v7 offset:49152
    ds_read_b128 v[216:219], v7 offset:50176
    buffer_load_dwordx4 v[146:149], v3, s[68:71], s55 offen offset:64
    v_mul_f32 v205, v205, v209
    v_mul_f32 v206, v206, v209
    s_waitcnt lgkmcnt(7)
    v_mfma_f32_16x16x32_bf16 v[116:119], v[232:235], v[84:87], v[116:119]
    ds_read_b128 v[220:223], v7 offset:51200
    v_mul_f32 v207, v207, v209
    v_cvt_pk_bf16_f32 v18, v204, v205
    v_mfma_f32_16x16x32_bf16 v[96:99], v[232:235], v[88:91], v[96:99]
    v_cvt_pk_bf16_f32 v19, v206, v207
    s_waitcnt lgkmcnt(7)
    v_mfma_f32_16x16x32_bf16 v[120:123], v[236:239], v[84:87], v[120:123]
    v_mfma_f32_16x16x32_bf16 v[100:103], v[236:239], v[88:91], v[100:103]
    buffer_load_dwordx2 v[150:151], v3, s[68:71], s82 offen
    s_waitcnt lgkmcnt(6)
    v_mfma_f32_16x16x32_bf16 v[124:127], v[240:243], v[84:87], v[124:127]
    v_mfma_f32_16x16x32_bf16 v[104:107], v[240:243], v[88:91], v[104:107]
    s_waitcnt lgkmcnt(5)
    v_mfma_f32_16x16x32_bf16 v[128:131], v[244:247], v[84:87], v[128:131]
    v_mfma_f32_16x16x32_bf16 v[108:111], v[244:247], v[88:91], v[108:111]
    s_add_u32 m0, s51, 4096
    s_add_u32 s83, s94, 28672
    buffer_load_dwordx4 v0, s[24:27], s83 offen lds
    s_barrier
    ds_read_b128 v[224:227], v7 offset:52224
    ds_read_b128 v[228:231], v8 offset:0
    s_waitcnt lgkmcnt(6)
    v_mfma_f32_16x16x32_bf16 v[112:115], v[248:251], v[60:63], v[112:115]
    ds_read_b128 v[232:235], v8 offset:1024
    ds_read_b128 v[236:239], v8 offset:2048
    v_mfma_f32_16x16x32_bf16 v[92:95], v[248:251], v[68:71], v[92:95]
    ds_read_b128 v[240:243], v8 offset:3072
    s_waitcnt lgkmcnt(8)
    v_mfma_f32_16x16x32_bf16 v[116:119], v[252:255], v[60:63], v[116:119]
    s_add_u32 m0, s51, 16384
    s_add_u32 s83, s94, 32768
    buffer_load_dwordx4 v0, s[24:27], s83 offen lds
    v_mfma_f32_16x16x32_bf16 v[96:99], v[252:255], v[68:71], v[96:99]
    s_waitcnt lgkmcnt(7)
    v_mfma_f32_16x16x32_bf16 v[120:123], v[212:215], v[60:63], v[120:123]
    v_mfma_f32_16x16x32_bf16 v[100:103], v[212:215], v[68:71], v[100:103]
    s_waitcnt lgkmcnt(6)
    v_mfma_f32_16x16x32_bf16 v[124:127], v[216:219], v[60:63], v[124:127]
    s_add_u32 m0, s51, 20480
    s_add_u32 s83, s94, 36864
    buffer_load_dwordx4 v0, s[24:27], s83 offen lds
    v_mfma_f32_16x16x32_bf16 v[104:107], v[216:219], v[68:71], v[104:107]
    s_waitcnt lgkmcnt(5)
    v_mfma_f32_16x16x32_bf16 v[128:131], v[220:223], v[60:63], v[128:131]
    v_mfma_f32_16x16x32_bf16 v[108:111], v[220:223], v[68:71], v[108:111]
    s_waitcnt lgkmcnt(4)
    v_mfma_f32_16x16x32_bf16 v[112:115], v[224:227], v[64:67], v[112:115]
    ds_read_b128 v[244:247], v8 offset:4096
    ds_read_b128 v[248:251], v8 offset:5120
    s_add_u32 s77, s67, 4096
    buffer_load_dwordx4 v[44:47], v0, s[20:23], s77 offen offset:0
    s_waitcnt vmcnt(4)
    ds_read_b128 v[132:135], v2 offset:53248
    v_mfma_f32_16x16x32_bf16 v[92:95], v[224:227], v[72:75], v[92:95]
    ds_read_b128 v[252:255], v8 offset:6144
    ds_read_b128 v[212:215], v8 offset:7168
    ds_read_b128 v[136:139], v2 offset:57344
    ds_read_b64 v[140:141], v6 offset:61440
    s_waitcnt lgkmcnt(10)
    v_mfma_f32_16x16x32_bf16 v[116:119], v[228:231], v[64:67], v[116:119]
    ds_read_b128 v[216:219], v8 offset:8192
    v_lshlrev_b32 v164, 16, v142
    v_and_b32 v165, 0xffff0000, v142
    v_mfma_f32_16x16x32_bf16 v[96:99], v[228:231], v[72:75], v[96:99]
    v_lshlrev_b32 v166, 16, v143
    v_and_b32 v167, 0xffff0000, v143
    s_waitcnt lgkmcnt(10)
    v_mfma_f32_16x16x32_bf16 v[120:123], v[232:235], v[64:67], v[120:123]
    s_add_u32 s77, s67, 4096
    buffer_load_dwordx4 v[48:51], v0, s[20:23], s77 offen offset:1024
    v_lshlrev_b32 v168, 16, v144
    v_and_b32 v169, 0xffff0000, v144
    v_mfma_f32_16x16x32_bf16 v[100:103], v[232:235], v[72:75], v[100:103]
    s_waitcnt lgkmcnt(1)
    v_lshlrev_b32 v170, 16, v145
    v_mfma_f32_16x16x32_bf16 v[124:127], v[236:239], v[64:67], v[124:127]
    v_and_b32 v171, 0xffff0000, v145
    v_lshlrev_b32 v172, 16, v146
    v_mfma_f32_16x16x32_bf16 v[104:107], v[236:239], v[72:75], v[104:107]
    s_add_u32 m0, s51, 8192
    s_add_u32 s83, s94, 40960
    buffer_load_dwordx4 v0, s[24:27], s83 offen lds
    v_and_b32 v173, 0xffff0000, v146
    v_lshlrev_b32 v174, 16, v147
    v_mfma_f32_16x16x32_bf16 v[128:131], v[240:243], v[64:67], v[128:131]
    v_and_b32 v175, 0xffff0000, v147
    v_lshlrev_b32 v176, 16, v148
    v_mfma_f32_16x16x32_bf16 v[108:111], v[240:243], v[72:75], v[108:111]
    v_and_b32 v177, 0xffff0000, v148
    v_lshlrev_b32 v178, 16, v149
    v_mfma_f32_16x16x32_bf16 v[112:115], v[244:247], v[12:15], v[112:115]
    ds_read_b128 v[220:223], v8 offset:12288
    ds_read_b128 v[224:227], v8 offset:13312
    v_and_b32 v179, 0xffff0000, v149
    v_lshlrev_b32 v180, 16, v150
    v_mfma_f32_16x16x32_bf16 v[92:95], v[244:247], v[16:19], v[92:95]
    ds_read_b128 v[228:231], v8 offset:14336
    ds_read_b128 v[232:235], v8 offset:15360
    s_add_u32 m0, s51, 12288
    s_add_u32 s83, s94, 45056
    s_cmp_ge_u32 s50, 1
    s_cbranch_scc1 K2_POX
    buffer_load_dwordx4 v0, s[24:27], s83 offen lds
K2_POX:
    v_and_b32 v181, 0xffff0000, v150
    v_lshlrev_b32 v182, 16, v151
    v_mfma_f32_16x16x32_bf16 v[116:119], v[248:251], v[12:15], v[116:119]
    ds_read_b128 v[236:239], v7 offset:0
    v_and_b32 v183, 0xffff0000, v151
    v_lshlrev_b32 v9, 16, v132
    v_mfma_f32_16x16x32_bf16 v[96:99], v[248:251], v[16:19], v[96:99]
    v_and_b32 v10, 0xffff0000, v132
    v_add_f32 v164, v164, v9
    v_mfma_f32_16x16x32_bf16 v[120:123], v[252:255], v[12:15], v[120:123]
    v_add_f32 v165, v165, v10
    v_lshlrev_b32 v9, 16, v133
    v_mfma_f32_16x16x32_bf16 v[100:103], v[252:255], v[16:19], v[100:103]
    s_add_u32 s77, s67, 4096
    buffer_load_dwordx4 v[52:55], v0, s[20:23], s77 offen offset:2048
    v_and_b32 v10, 0xffff0000, v133
    v_add_f32 v166, v166, v9
    v_mfma_f32_16x16x32_bf16 v[124:127], v[212:215], v[12:15], v[124:127]
    v_add_f32 v167, v167, v10
    v_lshlrev_b32 v9, 16, v134
    v_mfma_f32_16x16x32_bf16 v[104:107], v[212:215], v[16:19], v[104:107]
    v_and_b32 v10, 0xffff0000, v134
    v_add_f32 v168, v168, v9
    s_waitcnt lgkmcnt(5)
    v_mfma_f32_16x16x32_bf16 v[128:131], v[216:219], v[12:15], v[128:131]
    s_add_u32 s77, s67, 4096
    buffer_load_dwordx4 v[56:59], v0, s[20:23], s77 offen offset:3072
    v_add_f32 v169, v169, v10
    v_lshlrev_b32 v9, 16, v135
    v_mfma_f32_16x16x32_bf16 v[108:111], v[216:219], v[16:19], v[108:111]
    v_and_b32 v10, 0xffff0000, v135
    v_add_f32 v170, v170, v9
    s_waitcnt vmcnt(5)
    s_barrier
    ds_read_b128 v[240:243], v7 offset:1024
    ds_read_b128 v[244:247], v7 offset:2048
    s_waitcnt vmcnt(4)
    s_waitcnt lgkmcnt(6)
    v_mfma_f32_16x16x32_bf16 v[112:115], v[220:223], v[44:47], v[112:115]
    ds_read_b128 v[248:251], v7 offset:3072
    ds_read_b128 v[252:255], v7 offset:4096
    v_add_f32 v171, v171, v10
    v_lshlrev_b32 v9, 16, v136
    s_waitcnt lgkmcnt(7)
    v_mfma_f32_16x16x32_bf16 v[116:119], v[224:227], v[44:47], v[116:119]
    ds_read_b128 v[212:215], v7 offset:5120
    v_and_b32 v10, 0xffff0000, v136
    v_add_f32 v172, v172, v9
    s_waitcnt lgkmcnt(7)
    v_mfma_f32_16x16x32_bf16 v[120:123], v[228:231], v[44:47], v[120:123]
    s_add_u32 s77, s67, 8192
    buffer_load_dwordx4 v[20:23], v0, s[20:23], s77 offen offset:0
    v_add_f32 v173, v173, v10
    v_lshlrev_b32 v9, 16, v137
    s_waitcnt lgkmcnt(6)
    v_mfma_f32_16x16x32_bf16 v[124:127], v[232:235], v[44:47], v[124:127]
    v_and_b32 v10, 0xffff0000, v137
    v_add_f32 v174, v174, v9
    s_waitcnt lgkmcnt(5)
    v_mfma_f32_16x16x32_bf16 v[128:131], v[236:239], v[44:47], v[128:131]
    v_add_f32 v175, v175, v10
    v_lshlrev_b32 v9, 16, v138
    s_waitcnt vmcnt(4)
    s_waitcnt lgkmcnt(4)
    v_mfma_f32_16x16x32_bf16 v[112:115], v[240:243], v[48:51], v[112:115]
    ds_read_b128 v[216:219], v7 offset:6144
    ds_read_b128 v[220:223], v7 offset:7168
    v_and_b32 v10, 0xffff0000, v138
    v_add_f32 v176, v176, v9
    s_waitcnt lgkmcnt(5)
    v_mfma_f32_16x16x32_bf16 v[116:119], v[244:247], v[48:51], v[116:119]
    ds_read_b128 v[224:227], v7 offset:16384
    ds_read_b128 v[228:231], v7 offset:17408
    s_add_u32 s77, s66, 4096
    buffer_load_dwordx4 v[32:35], v0, s[20:23], s77 offen offset:0
    v_add_f32 v177, v177, v10
    v_lshlrev_b32 v9, 16, v139
    s_waitcnt lgkmcnt(6)
    v_mfma_f32_16x16x32_bf16 v[120:123], v[248:251], v[48:51], v[120:123]
    ds_read_b128 v[232:235], v7 offset:18432
    v_and_b32 v10, 0xffff0000, v139
    v_add_f32 v178, v178, v9
    s_waitcnt lgkmcnt(6)
    v_mfma_f32_16x16x32_bf16 v[124:127], v[252:255], v[48:51], v[124:127]
    v_add_f32 v179, v179, v10
    v_lshlrev_b32 v9, 16, v140
    s_waitcnt lgkmcnt(5)
    v_mfma_f32_16x16x32_bf16 v[128:131], v[212:215], v[48:51], v[128:131]
    s_add_u32 s77, s66, 4096
    buffer_load_dwordx4 v[152:155], v0, s[20:23], s77 offen offset:1024
    v_and_b32 v10, 0xffff0000, v140
    v_add_f32 v180, v180, v9
    s_waitcnt vmcnt(4)
    s_waitcnt lgkmcnt(4)
    v_mfma_f32_16x16x32_bf16 v[112:115], v[216:219], v[52:55], v[112:115]
    ds_read_b128 v[236:239], v7 offset:19456
    ds_read_b128 v[240:243], v7 offset:20480
    v_add_f32 v181, v181, v10
    v_lshlrev_b32 v9, 16, v141
    s_waitcnt lgkmcnt(5)
    v_mfma_f32_16x16x32_bf16 v[116:119], v[220:223], v[52:55], v[116:119]
    ds_read_b128 v[244:247], v7 offset:21504
    ds_read_b128 v[248:251], v7 offset:22528
    v_and_b32 v10, 0xffff0000, v141
    v_add_f32 v182, v182, v9
    s_waitcnt lgkmcnt(6)
    v_mfma_f32_16x16x32_bf16 v[120:123], v[224:227], v[52:55], v[120:123]
    ds_read_b128 v[252:255], v7 offset:23552
    v_add_f32 v183, v183, v10
    s_waitcnt lgkmcnt(6)
    v_mfma_f32_16x16x32_bf16 v[124:127], v[228:231], v[52:55], v[124:127]
    s_add_u32 s77, s66, 4096
    buffer_load_dwordx4 v[156:159], v0, s[20:23], s77 offen offset:2048
    s_waitcnt lgkmcnt(5)
    v_mfma_f32_16x16x32_bf16 v[128:131], v[232:235], v[52:55], v[128:131]
    s_barrier
    ds_read_b128 v[212:215], v7 offset:8192
    ds_read_b128 v[216:219], v7 offset:9216
    s_waitcnt vmcnt(4)
    s_waitcnt lgkmcnt(6)
    v_mfma_f32_16x16x32_bf16 v[112:115], v[236:239], v[56:59], v[112:115]
    ds_read_b128 v[220:223], v7 offset:10240
    ds_read_b128 v[224:227], v7 offset:11264
    s_waitcnt lgkmcnt(7)
    v_mfma_f32_16x16x32_bf16 v[116:119], v[240:243], v[56:59], v[116:119]
    ds_read_b128 v[228:231], v7 offset:12288
    s_waitcnt lgkmcnt(7)
    v_mfma_f32_16x16x32_bf16 v[120:123], v[244:247], v[56:59], v[120:123]
    s_add_u32 s77, s66, 4096
    buffer_load_dwordx4 v[160:163], v0, s[20:23], s77 offen offset:3072
    s_waitcnt lgkmcnt(6)
    v_mfma_f32_16x16x32_bf16 v[124:127], v[248:251], v[56:59], v[124:127]
    s_waitcnt lgkmcnt(5)
    v_mfma_f32_16x16x32_bf16 v[128:131], v[252:255], v[56:59], v[128:131]
    s_waitcnt vmcnt(4)
    s_waitcnt lgkmcnt(4)
    v_mfma_f32_16x16x32_bf16 v[112:115], v[212:215], v[20:23], v[112:115]
    ds_read_b128 v[232:235], v8 offset:12288
    ds_read_b128 v[236:239], v8 offset:13312
    s_waitcnt lgkmcnt(5)
    v_mfma_f32_16x16x32_bf16 v[116:119], v[216:219], v[20:23], v[116:119]
    ds_read_b128 v[240:243], v8 offset:14336
    ds_read_b128 v[244:247], v8 offset:15360
    s_add_u32 s77, s66, 8192
    buffer_load_dwordx4 v[76:79], v0, s[20:23], s77 offen offset:0
    s_waitcnt lgkmcnt(6)
    v_mfma_f32_16x16x32_bf16 v[120:123], v[220:223], v[20:23], v[120:123]
    ds_read_b128 v[248:251], v7 offset:0
    s_waitcnt lgkmcnt(6)
    v_mfma_f32_16x16x32_bf16 v[124:127], v[224:227], v[20:23], v[124:127]
    s_waitcnt lgkmcnt(5)
    v_mfma_f32_16x16x32_bf16 v[128:131], v[228:231], v[20:23], v[128:131]
    s_waitcnt vmcnt(4)
    s_waitcnt lgkmcnt(4)
    v_mfma_f32_16x16x32_bf16 v[92:95], v[232:235], v[32:35], v[92:95]
    ds_read_b128 v[252:255], v7 offset:1024
    ds_read_b128 v[212:215], v7 offset:2048
    s_waitcnt lgkmcnt(5)
    v_mfma_f32_16x16x32_bf16 v[96:99], v[236:239], v[32:35], v[96:99]
    ds_read_b128 v[216:219], v7 offset:3072
    ds_read_b128 v[220:223], v7 offset:4096
    s_waitcnt lgkmcnt(6)
    v_mfma_f32_16x16x32_bf16 v[100:103], v[240:243], v[32:35], v[100:103]
    ds_read_b128 v[224:227], v7 offset:5120
    s_waitcnt lgkmcnt(6)
    v_mfma_f32_16x16x32_bf16 v[104:107], v[244:247], v[32:35], v[104:107]
    s_waitcnt lgkmcnt(5)
    v_mfma_f32_16x16x32_bf16 v[108:111], v[248:251], v[32:35], v[108:111]
    s_waitcnt vmcnt(3)
    s_waitcnt lgkmcnt(4)
    v_mfma_f32_16x16x32_bf16 v[92:95], v[252:255], v[152:155], v[92:95]
    ds_write_b128 v4, v[112:115] offset:24576
    ds_read_b128 v[228:231], v7 offset:6144
    ds_read_b128 v[232:235], v7 offset:7168
    s_waitcnt lgkmcnt(6)
    v_mfma_f32_16x16x32_bf16 v[96:99], v[212:215], v[152:155], v[96:99]
    ds_write_b128 v4, v[116:119] offset:32768
    ds_read_b128 v[236:239], v7 offset:16384
    ds_read_b128 v[240:243], v7 offset:17408
    s_waitcnt lgkmcnt(8)
    v_mfma_f32_16x16x32_bf16 v[100:103], v[216:219], v[152:155], v[100:103]
    ds_write_b128 v4, v[120:123] offset:36864
    ds_read_b128 v[244:247], v7 offset:18432
    s_waitcnt lgkmcnt(9)
    v_mfma_f32_16x16x32_bf16 v[104:107], v[220:223], v[152:155], v[104:107]
    ds_write_b128 v4, v[124:127] offset:28672
    s_waitcnt lgkmcnt(9)
    v_mfma_f32_16x16x32_bf16 v[108:111], v[224:227], v[152:155], v[108:111]
    ds_write_b128 v4, v[128:131] offset:45056
    s_waitcnt vmcnt(2)
    s_waitcnt lgkmcnt(8)
    v_mfma_f32_16x16x32_bf16 v[92:95], v[228:231], v[156:159], v[92:95]
    ds_read_b128 v[248:251], v7 offset:19456
    ds_read_b128 v[252:255], v7 offset:20480
    s_waitcnt lgkmcnt(9)
    v_mfma_f32_16x16x32_bf16 v[96:99], v[232:235], v[156:159], v[96:99]
    ds_read_b128 v[212:215], v7 offset:21504
    ds_read_b128 v[216:219], v7 offset:22528
    s_waitcnt lgkmcnt(9)
    v_mfma_f32_16x16x32_bf16 v[100:103], v[236:239], v[156:159], v[100:103]
    ds_read_b128 v[220:223], v7 offset:23552
    s_waitcnt lgkmcnt(9)
    v_mfma_f32_16x16x32_bf16 v[104:107], v[240:243], v[156:159], v[104:107]
    s_waitcnt lgkmcnt(7)
    v_mfma_f32_16x16x32_bf16 v[108:111], v[244:247], v[156:159], v[108:111]
    s_waitcnt lgkmcnt(5)
    s_barrier
    ds_read_b128 v[112:115], v5 offset:24576
    ds_read_b128 v[116:119], v5 offset:32768
    ds_read_b128 v[120:123], v5 offset:36864
    ds_read_b128 v[124:127], v5 offset:28672
    ds_read_b128 v[128:131], v5 offset:45056
    s_waitcnt vmcnt(1)
    s_waitcnt lgkmcnt(9)
    v_mfma_f32_16x16x32_bf16 v[92:95], v[248:251], v[160:163], v[92:95]
    ds_read_b128 v[224:227], v7 offset:8192
    ds_read_b128 v[228:231], v7 offset:9216
    s_waitcnt lgkmcnt(2)
    v_add_f32 v164, v164, v112
    v_mfma_f32_16x16x32_bf16 v[96:99], v[252:255], v[160:163], v[96:99]
    ds_read_b128 v[232:235], v7 offset:10240
    ds_read_b128 v[236:239], v7 offset:11264
    v_add_f32 v165, v165, v113
    v_add_f32 v166, v166, v114
    v_mfma_f32_16x16x32_bf16 v[100:103], v[212:215], v[160:163], v[100:103]
    ds_read_b128 v[240:243], v7 offset:12288
    v_add_f32 v167, v167, v115
    v_add_f32 v168, v168, v116
    v_mfma_f32_16x16x32_bf16 v[104:107], v[216:219], v[160:163], v[104:107]
    v_add_f32 v169, v169, v117
    v_add_f32 v170, v170, v118
    v_mfma_f32_16x16x32_bf16 v[108:111], v[220:223], v[160:163], v[108:111]
    v_add_f32 v171, v171, v119
    v_add_f32 v172, v172, v120
    s_waitcnt vmcnt(0)
    s_waitcnt lgkmcnt(4)
    v_mfma_f32_16x16x32_bf16 v[92:95], v[224:227], v[76:79], v[92:95]
    v_add_f32 v173, v173, v121
    v_add_f32 v174, v174, v122
    s_waitcnt lgkmcnt(3)
    v_mfma_f32_16x16x32_bf16 v[96:99], v[228:231], v[76:79], v[96:99]
    v_add_f32 v175, v175, v123
    v_add_f32 v176, v176, v124
    s_waitcnt lgkmcnt(2)
    v_mfma_f32_16x16x32_bf16 v[100:103], v[232:235], v[76:79], v[100:103]
    v_add_f32 v177, v177, v125
    v_add_f32 v178, v178, v126
    s_waitcnt lgkmcnt(1)
    v_mfma_f32_16x16x32_bf16 v[104:107], v[236:239], v[76:79], v[104:107]
    v_add_f32 v179, v179, v127
    v_add_f32 v180, v180, v128
    s_waitcnt lgkmcnt(0)
    v_mfma_f32_16x16x32_bf16 v[108:111], v[240:243], v[76:79], v[108:111]
    v_add_f32 v181, v181, v129
    v_add_f32 v182, v182, v130
    v_add_f32 v183, v183, v131
    v_add_f32 v92, v92, v164
    v_add_f32 v93, v93, v165
    v_cvt_pk_bf16_f32 v12, v92, v93
    v_add_f32 v94, v94, v166
    v_add_f32 v95, v95, v167
    v_cvt_pk_bf16_f32 v13, v94, v95
    v_add_f32 v96, v96, v168
    v_add_f32 v97, v97, v169
    v_cvt_pk_bf16_f32 v14, v96, v97
    v_add_f32 v98, v98, v170
    v_add_f32 v99, v99, v171
    v_cvt_pk_bf16_f32 v15, v98, v99
    buffer_store_dwordx4 v[12:15], v0, s[28:31], s46 offen sc1
    v_add_f32 v100, v100, v172
    v_add_f32 v101, v101, v173
    v_cvt_pk_bf16_f32 v16, v100, v101
    v_add_f32 v102, v102, v174
    v_add_f32 v103, v103, v175
    v_cvt_pk_bf16_f32 v17, v102, v103
    v_add_f32 v104, v104, v176
    v_add_f32 v105, v105, v177
    v_cvt_pk_bf16_f32 v18, v104, v105
    v_add_f32 v106, v106, v178
    v_add_f32 v107, v107, v179
    v_cvt_pk_bf16_f32 v19, v106, v107
    buffer_store_dwordx4 v[16:19], v0, s[28:31], s46 offen offset:1024 sc1
    v_add_f32 v108, v108, v180
    v_add_f32 v109, v109, v181
    v_cvt_pk_bf16_f32 v20, v108, v109
    v_add_f32 v110, v110, v182
    v_add_f32 v111, v111, v183
    v_cvt_pk_bf16_f32 v21, v110, v111
    buffer_store_dwordx2 v[20:21], v1, s[28:31], s46 offen offset:2048 sc1
    s_waitcnt vmcnt(0)
    v_mov_b32 v9, 1
    s_mov_b64 exec, 1
    buffer_atomic_add v9, off, s[28:31], s46 offset:2560 sc0 sc1
    s_mov_b64 exec, -1
    s_waitcnt vmcnt(0)
    v_readfirstlane_b32 s60, v9
    s_cmp_eq_u32 s60, -1
    s_cbranch_scc1 K2_AEND
    buffer_load_dwordx4 v[92:95], v0, s[32:35], s52 offen offset:0 sc1
    buffer_load_dwordx4 v[96:99], v0, s[32:35], s52 offen offset:1024 sc1
    buffer_load_dwordx4 v[100:103], v0, s[32:35], s52 offen offset:2048 sc1
    buffer_load_dwordx4 v[104:107], v0, s[32:35], s52 offen offset:3072 sc1
    s_add_u32 s52, s52, 4096
    buffer_load_dwordx4 v[108:111], v0, s[32:35], s52 offen offset:0 sc1
    s_waitcnt vmcnt(0)
    v_lshlrev_b32 v9, 16, v12
    v_and_b32 v10, 0xffff0000, v12
    v_add_f32 v92, v92, v9
    v_add_f32 v93, v93, v10
    v_cvt_pk_bf16_f32 v112, v92, v93
    v_lshlrev_b32 v9, 16, v13
    v_and_b32 v10, 0xffff0000, v13
    v_add_f32 v94, v94, v9
    v_add_f32 v95, v95, v10
    v_cvt_pk_bf16_f32 v113, v94, v95
    v_lshlrev_b32 v9, 16, v14
    v_and_b32 v10, 0xffff0000, v14
    v_add_f32 v96, v96, v9
    v_add_f32 v97, v97, v10
    v_cvt_pk_bf16_f32 v114, v96, v97
    v_lshlrev_b32 v9, 16, v15
    v_and_b32 v10, 0xffff0000, v15
    v_add_f32 v98, v98, v9
    v_add_f32 v99, v99, v10
    v_cvt_pk_bf16_f32 v115, v98, v99
    ds_write_b128 v2, v[112:115] offset:24576
    ds_read_b128 v[122:125], v5 offset:24576
    v_lshlrev_b32 v9, 16, v16
    v_and_b32 v10, 0xffff0000, v16
    v_add_f32 v100, v100, v9
    v_add_f32 v101, v101, v10
    v_cvt_pk_bf16_f32 v116, v100, v101
    v_lshlrev_b32 v9, 16, v17
    v_and_b32 v10, 0xffff0000, v17
    v_add_f32 v102, v102, v9
    v_add_f32 v103, v103, v10
    v_cvt_pk_bf16_f32 v117, v102, v103
    v_lshlrev_b32 v9, 16, v18
    v_and_b32 v10, 0xffff0000, v18
    v_add_f32 v104, v104, v9
    v_add_f32 v105, v105, v10
    v_cvt_pk_bf16_f32 v118, v104, v105
    v_lshlrev_b32 v9, 16, v19
    v_and_b32 v10, 0xffff0000, v19
    v_add_f32 v106, v106, v9
    v_add_f32 v107, v107, v10
    v_cvt_pk_bf16_f32 v119, v106, v107
    ds_write_b128 v2, v[116:119] offset:32768
    ds_read_b128 v[126:129], v5 offset:32768
    v_lshlrev_b32 v9, 16, v20
    v_and_b32 v10, 0xffff0000, v20
    v_add_f32 v108, v108, v9
    v_add_f32 v109, v109, v10
    v_cvt_pk_bf16_f32 v120, v108, v109
    v_lshlrev_b32 v9, 16, v21
    v_and_b32 v10, 0xffff0000, v21
    v_add_f32 v110, v110, v9
    v_add_f32 v111, v111, v10
    v_cvt_pk_bf16_f32 v121, v110, v111
    ds_write_b64 v2, v[120:121] offset:36864
    ds_read_b64 v[130:131], v5 offset:36864
    s_waitcnt lgkmcnt(4)
    buffer_store_dwordx4 v[122:125], v11, s[56:59], s42 offen
    s_waitcnt lgkmcnt(2)
    buffer_store_dwordx4 v[126:129], v11, s[56:59], s42 offen offset:64
    s_waitcnt lgkmcnt(0)
    buffer_store_dwordx2 v[130:131], v11, s[56:59], s43 offen
K2_AEND:
    s_endpgm
K2_H:
    s_setprio 3
    buffer_load_dwordx4 v[92:95], v0, s[36:39], s95 offen offset:0
    buffer_load_dwordx4 v[96:99], v0, s[36:39], s95 offen offset:1024
    s_setprio 2
    s_add_u32 m0, s51, 16384
    s_add_u32 s83, s94, 0
    buffer_load_dwordx4 v0, s[24:27], s83 offen lds
    s_lshr_b32 s60, s40, 2
    s_mul_i32 s3, s60, 81920
    v_bfe_u32 v9, v0, 4, 2
    v_lshrrev_b32 v165, 8, v0
    v_min_u32 v164, 1, v165
    v_lshl_add_u32 v8, v165, 4, s3
    s_add_u32 s60, s3, 7816
    v_mov_b32 v7, s60
    v_cmp_eq_u32 s[60:61], 0, v9
    v_cmp_eq_u32 s[62:63], v164, v9
    v_cmp_eq_u32 s[88:89], 2, v9
    v_add_u32 v164, 2, v164
    v_cmp_eq_u32 s[90:91], v164, v9
    v_or_b32 v164, 1, v165
    s_add_u32 m0, s51, 20480
    s_add_u32 s83, s94, 4096
    buffer_load_dwordx4 v0, s[24:27], s83 offen lds
    v_cmp_eq_u32 s[92:93], v164, v9
    v_cmp_eq_u32 s[84:85], 0, v165
    v_cmp_gt_u32 s[86:87], 2, v165
    v_add_u32 v2, 7680, v8
    v_add_u32 v3, 7688, v8
    v_add_u32 v4, 7744, v8
    v_add_u32 v5, 7752, v8
    v_add_u32 v6, 7808, v8
    v_cndmask_b32 v2, v7, v2, s[60:61]
    v_cndmask_b32 v3, v7, v3, s[62:63]
    v_cndmask_b32 v4, v7, v4, s[88:89]
    v_cndmask_b32 v5, v7, v5, s[90:91]
    v_cndmask_b32 v6, v7, v6, s[92:93]
    v_add_u32 v7, s3, v0
    buffer_load_dwordx4 v[20:23], v0, s[20:23], s65 offen offset:0
    v_add_u32 v8, 0x10000, v7
    v_add_u32 v1, s3, v1
    v_mov_b32 v134, 0
    v_mov_b32 v135, 0
    v_mov_b32 v140, 0
    v_mov_b32 v141, 0
    v_mov_b32 v146, 0
    v_mov_b32 v147, 0
    v_mov_b32 v160, 0
    v_mov_b32 v161, 0
    v_mov_b32 v132, 0
    v_mov_b32 v133, 0
    v_add_u32 v164, s51, v0
    ds_write_b128 v164, v[132:135] offset:0
    buffer_load_dwordx4 v[24:27], v0, s[20:23], s47 offen offset:0
    ds_write_b128 v164, v[132:135] offset:4096
    ds_write_b128 v164, v[132:135] offset:8192
    ds_write_b128 v164, v[132:135] offset:12288
    s_lshr_b32 s60, s50, 1
    s_and_b32 s61, s50, 1
    s_mul_i32 s62, s61, 5
    s_mul_i32 s61, s61, 20
    s_lshl_b32 s63, s60, 3
    v_mov_b32 v172, s63
    s_mul_i32 s63, s60, -504
    v_mov_b32 v173, s63
    s_lshl_b32 s63, s60, 12
    s_add_u32 s63, s63, s3
    v_lshrrev_b32 v164, 4, v0
    buffer_load_dwordx4 v[28:31], v0, s[20:23], s47 offen offset:1024
    s_setprio 1
    v_mul_u32_u24 v165, 205, v164
    v_lshrrev_b32 v165, 10, v165
    v_mad_i32_i24 v166, v165, -5, v164
    v_add_u32 v166, s62, v166
    v_cmp_le_u32 s[88:89], 8, v166
    v_and_b32 v167, 3, v166
    v_lshl_add_u32 v174, s60, 1, v167
    v_cndmask_b32 v167, v167, v174, s[88:89]
    v_bfe_u32 v166, v166, 2, 1
    v_add_u32 v174, s61, v165
    v_cmp_le_u32 vcc, 32, v174
    v_and_b32 v116, 15, v174
    v_lshrrev_b32 v174, 4, v174
    v_lshl_add_u32 v116, v174, 6, v116
    s_add_u32 m0, s51, 24576
    s_add_u32 s83, s94, 8192
    buffer_load_dwordx4 v0, s[24:27], s83 offen lds
    v_lshl_add_u32 v116, v167, 4, v116
    v_cndmask_b32 v174, 0, v172, vcc
    v_cndmask_b32 v175, 0, v173, vcc
    v_add_lshl_u32 v174, v174, v116, 4
    v_add_lshl_u32 v175, v175, v116, 3
    v_lshl_add_u32 v174, v166, 3, v174
    v_add_u32 v175, 2560, v175
    v_cndmask_b32 v116, v174, v175, s[88:89]
    v_add_u32 v116, s63, v116
    v_add_u32 v164, 64, v164
    v_mul_u32_u24 v165, 205, v164
    v_lshrrev_b32 v165, 10, v165
    v_mad_i32_i24 v166, v165, -5, v164
    v_add_u32 v166, s62, v166
    buffer_load_dwordx4 v[32:35], v0, s[20:23], s64 offen offset:0
    v_cmp_le_u32 s[88:89], 8, v166
    v_and_b32 v167, 3, v166
    v_lshl_add_u32 v174, s60, 1, v167
    v_cndmask_b32 v167, v167, v174, s[88:89]
    v_bfe_u32 v166, v166, 2, 1
    v_add_u32 v174, s61, v165
    v_cmp_le_u32 vcc, 32, v174
    v_and_b32 v117, 15, v174
    v_lshrrev_b32 v174, 4, v174
    v_lshl_add_u32 v117, v174, 6, v117
    v_lshl_add_u32 v117, v167, 4, v117
    v_cndmask_b32 v174, 0, v172, vcc
    v_cndmask_b32 v175, 0, v173, vcc
    v_add_lshl_u32 v174, v174, v117, 4
    buffer_load_dwordx4 v[36:39], v0, s[20:23], s44 offen offset:0
    s_setprio 0
    v_add_lshl_u32 v175, v175, v117, 3
    v_lshl_add_u32 v174, v166, 3, v174
    v_add_u32 v175, 2560, v175
    v_cndmask_b32 v117, v174, v175, s[88:89]
    v_add_u32 v117, s63, v117
    s_lshl_b32 s60, s60, 6
    v_lshl_add_u32 v174, v166, 3, s60
    v_cmp_eq_u32 vcc, 20, v165
    v_cndmask_b32 v174, v174, 64, s[88:89]
    v_cmp_lt_u32 s[90:91], 20, v165
    v_cndmask_b32 v175, 0, 64, s[88:89]
    v_add_u32 v174, v174, v175
    v_lshl_add_u32 v174, v167, 4, v174
    v_lshl_add_u32 v175, v164, 3, s3
    s_add_u32 s60, s3, 7680
    v_add_u32 v174, s60, v174
    v_add_u32 v175, 7168, v175
    v_cndmask_b32 v117, v117, v174, vcc
    v_cndmask_b32 v117, v117, v175, s[90:91]
    s_waitcnt lgkmcnt(0)
    s_barrier
    s_waitcnt vmcnt(9)
    v_cvt_pk_bf16_f32 v92, v92, v93
    v_cvt_pk_bf16_f32 v93, v94, v95
    ds_write_b64 v116, v[92:93] offset:0
    s_waitcnt vmcnt(8)
    v_cvt_pk_bf16_f32 v96, v96, v97
    v_cvt_pk_bf16_f32 v97, v98, v99
    ds_write_b64 v117, v[96:97] offset:0
    s_lshl_b32 s60, s41, 3
    s_add_u32 s61, s60, s53
    s_waitcnt lgkmcnt(0)
    s_waitcnt vmcnt(6)
    buffer_load_dwordx4 v[40:43], v0, s[20:23], s44 offen offset:1024
    s_add_u32 s95, s95, 7168
    buffer_load_dwordx4 v[104:107], v0, s[36:39], s95 offen offset:0
    buffer_load_dwordx4 v[108:111], v0, s[36:39], s95 offen offset:1024
    buffer_load_dwordx4 v[44:47], v0, s[20:23], s67 offen offset:0
    s_barrier
    ds_read_b64 v[158:159], v6 offset:0
    ds_read_b64 v[132:133], v1 offset:3072
    ds_read_b64 v[138:139], v1 offset:7168
    ds_read_b64 v[144:145], v1 offset:3584
    ds_read_b64 v[150:151], v2 offset:0
    ds_read_b64 v[152:153], v3 offset:0
    ds_read_b128 v[212:215], v7 offset:0
    ds_read_b128 v[216:219], v7 offset:4096
    s_waitcnt vmcnt(9)
    s_waitcnt lgkmcnt(7)
    v_mfma_f32_16x16x32_bf16 v[184:187], v[158:161], v[20:23], 0
    ds_read_b64 v[154:155], v4 offset:0
    ds_read_b64 v[156:157], v5 offset:0
    s_mul_i32 s42, s61, 20480
    s_lshr_b32 s61, s54, 1
    s_mul_i32 s61, s61, 320
    s_add_u32 s42, s42, s61
    s_waitcnt lgkmcnt(8)
    v_mfma_f32_16x16x32_bf16 v[168:171], v[132:135], v[20:23], 0
    ds_read_b128 v[220:223], v7 offset:1024
    ds_read_b128 v[224:227], v7 offset:5120
    s_and_b32 s61, s54, 1
    s_lshl_b32 s43, s61, 3
    s_add_u32 s43, s43, s42
    s_add_u32 s43, s43, 128
    s_waitcnt lgkmcnt(9)
    v_mfma_f32_16x16x32_bf16 v[176:179], v[138:141], v[20:23], 0
    ds_read_b128 v[228:231], v7 offset:2048
    ds_read_b128 v[232:235], v7 offset:6144
    s_mul_i32 s61, s61, 192
    s_add_u32 s42, s42, s61
    s_add_u32 s60, s60, s54
    s_lshl_b32 s60, s60, 3
    s_waitcnt lgkmcnt(10)
    v_mfma_f32_16x16x32_bf16 v[180:183], v[144:147], v[20:23], 0
    buffer_load_dwordx4 v[48:51], v0, s[20:23], s66 offen offset:0
    s_add_u32 s60, s60, s53
    s_mul_i32 s46, s60, 2688
    s_mul_i32 s52, s60, 5120
    v_lshrrev_b32 v9, 6, v0
    s_waitcnt vmcnt(9)
    s_waitcnt lgkmcnt(8)
    v_mfma_f32_16x16x32_bf16 v[184:187], v[150:153], v[24:27], v[184:187]
    v_mul_u32_u24 v11, 1280, v9
    v_and_b32 v9, 48, v0
    v_add_u32 v11, v9, v11
    s_add_u32 s28, s16, 0x1400000
    s_addc_u32 s29, s17, 0
    s_waitcnt lgkmcnt(7)
    v_mfma_f32_16x16x32_bf16 v[164:167], v[212:215], v[24:27], 0
    s_mov_b32 s30, 0x2a0000
    s_mov_b32 s31, 0x00020000
    s_add_u32 s32, s16, 0x1800000
    s_addc_u32 s33, s17, 0
    s_waitcnt vmcnt(8)
    s_waitcnt lgkmcnt(6)
    v_mfma_f32_16x16x32_bf16 v[172:175], v[216:219], v[28:31], 0
    s_mov_b32 s34, 0x500000
    s_mov_b32 s35, 0x00020000
    s_mov_b32 s56, s10
    s_mov_b32 s57, s11
    s_waitcnt lgkmcnt(4)
    v_mfma_f32_16x16x32_bf16 v[184:187], v[154:157], v[28:31], v[184:187]
    s_add_u32 m0, s51, 28672
    s_add_u32 s83, s94, 12288
    buffer_load_dwordx4 v0, s[24:27], s83 offen lds
    s_mov_b32 s58, 0x280000
    s_mov_b32 s59, 0x00020000
    s_waitcnt lgkmcnt(3)
    v_mfma_f32_16x16x32_bf16 v[168:171], v[220:223], v[24:27], v[168:171]
    s_waitcnt lgkmcnt(2)
    v_mfma_f32_16x16x32_bf16 v[176:179], v[224:227], v[28:31], v[176:179]
    s_waitcnt lgkmcnt(1)
    v_mfma_f32_16x16x32_bf16 v[180:183], v[228:231], v[24:27], v[180:183]
    s_waitcnt lgkmcnt(0)
    v_mfma_f32_16x16x32_bf16 v[180:183], v[232:235], v[28:31], v[180:183]
    s_add_u32 m0, s51, 32768
    s_add_u32 s83, s45, 0
    buffer_load_dwordx4 v0, s[24:27], s83 offen lds
    s_waitcnt vmcnt(8)
    v_mfma_f32_16x16x32_bf16 v[208:211], v[158:161], v[32:35], 0
    ds_read_b128 v[236:239], v7 offset:16384
    ds_read_b128 v[240:243], v7 offset:17408
    s_waitcnt vmcnt(5)
    v_cvt_pk_bf16_f32 v104, v104, v105
    v_mfma_f32_16x16x32_bf16 v[192:195], v[132:135], v[32:35], 0
    ds_read_b128 v[244:247], v7 offset:18432
    ds_read_b128 v[248:251], v7 offset:19456
    v_cvt_pk_bf16_f32 v105, v106, v107
    ds_write_b64 v116, v[104:105] offset:8192
    v_mfma_f32_16x16x32_bf16 v[200:203], v[138:141], v[32:35], 0
    ds_read_b128 v[252:255], v7 offset:20480
    s_add_u32 m0, s51, 36864
    s_add_u32 s83, s45, 4096
    buffer_load_dwordx4 v0, s[24:27], s83 offen lds
    s_waitcnt vmcnt(5)
    v_cvt_pk_bf16_f32 v108, v108, v109
    v_mfma_f32_16x16x32_bf16 v[204:207], v[144:147], v[32:35], 0
    v_cvt_pk_bf16_f32 v109, v110, v111
    ds_write_b64 v117, v[108:109] offset:8192
    v_mfma_f32_16x16x32_bf16 v[208:211], v[150:153], v[36:39], v[208:211]
    s_nop 1
    v_add_f32 v184, 0x358637bd, v184
    v_mfma_f32_16x16x32_bf16 v[188:191], v[212:215], v[36:39], 0
    v_add_f32 v185, 0x358637bd, v185
    v_add_f32 v186, 0x358637bd, v186
    v_mfma_f32_16x16x32_bf16 v[196:199], v[216:219], v[40:43], 0
    buffer_load_dwordx4 v[52:55], v0, s[20:23], s67 offen offset:1024
    v_add_f32 v187, 0x358637bd, v187
    v_rcp_f32 v184, v184
    v_mfma_f32_16x16x32_bf16 v[208:211], v[154:157], v[40:43], v[208:211]
    v_rcp_f32 v185, v185
    v_mfma_f32_16x16x32_bf16 v[192:195], v[220:223], v[36:39], v[192:195]
    v_rcp_f32 v186, v186
    v_mfma_f32_16x16x32_bf16 v[200:203], v[224:227], v[40:43], v[200:203]
    v_rcp_f32 v187, v187
    v_mfma_f32_16x16x32_bf16 v[204:207], v[228:231], v[36:39], v[204:207]
    buffer_load_dwordx4 v[56:59], v0, s[20:23], s66 offen offset:1024
    v_cndmask_b32 v9, v185, v184, s[84:85]
    v_mfma_f32_16x16x32_bf16 v[204:207], v[232:235], v[40:43], v[204:207]
    v_cndmask_b32 v10, v187, v186, s[84:85]
    v_cndmask_b32 v185, v187, v185, s[86:87]
    s_waitcnt lgkmcnt(0)
    s_barrier
    ds_read_b128 v[212:215], v7 offset:21504
    ds_read_b128 v[216:219], v7 offset:22528
    s_waitcnt vmcnt(6)
    v_mfma_f32_16x16x32_bf16 v[112:115], v[236:239], v[44:47], 0
    ds_read_b128 v[220:223], v7 offset:23552
    ds_read_b128 v[224:227], v7 offset:24576
    v_mul_f32 v164, v164, v184
    v_mul_f32 v165, v165, v184
    s_waitcnt vmcnt(5)
    v_mfma_f32_16x16x32_bf16 v[92:95], v[236:239], v[48:51], 0
    ds_read_b128 v[228:231], v7 offset:25600
    buffer_load_dwordx4 v[60:63], v0, s[20:23], s47 offen offset:2048
    v_mul_f32 v166, v166, v184
    v_mul_f32 v167, v167, v184
    v_mfma_f32_16x16x32_bf16 v[116:119], v[240:243], v[44:47], 0
    v_cvt_pk_bf16_f32 v24, v164, v165
    v_cvt_pk_bf16_f32 v25, v166, v167
    v_mfma_f32_16x16x32_bf16 v[96:99], v[240:243], v[48:51], 0
    v_mul_f32 v168, v168, v9
    v_mul_f32 v169, v169, v9
    v_mfma_f32_16x16x32_bf16 v[120:123], v[244:247], v[44:47], 0
    v_mul_f32 v170, v170, v9
    v_mul_f32 v171, v171, v9
    v_mfma_f32_16x16x32_bf16 v[100:103], v[244:247], v[48:51], 0
    buffer_load_dwordx4 v[64:67], v0, s[20:23], s47 offen offset:3072
    v_cvt_pk_bf16_f32 v26, v168, v169
    v_cvt_pk_bf16_f32 v27, v170, v171
    v_mfma_f32_16x16x32_bf16 v[124:127], v[248:251], v[44:47], 0
    v_mul_f32 v172, v172, v186
    v_mul_f32 v173, v173, v186
    v_mfma_f32_16x16x32_bf16 v[104:107], v[248:251], v[48:51], 0
    v_mul_f32 v174, v174, v186
    v_mul_f32 v175, v175, v186
    v_mfma_f32_16x16x32_bf16 v[128:131], v[252:255], v[44:47], 0
    v_cvt_pk_bf16_f32 v28, v172, v173
    v_cvt_pk_bf16_f32 v29, v174, v175
    v_mfma_f32_16x16x32_bf16 v[108:111], v[252:255], v[48:51], 0
    buffer_load_dwordx4 v[68:71], v0, s[20:23], s44 offen offset:2048
    v_mul_f32 v176, v176, v10
    v_mul_f32 v177, v177, v10
    s_waitcnt vmcnt(4)
    s_waitcnt lgkmcnt(4)
    v_mfma_f32_16x16x32_bf16 v[112:115], v[212:215], v[52:55], v[112:115]
    ds_read_b64 v[162:163], v6 offset:8192
    ds_read_b64 v[136:137], v1 offset:11264
    v_mul_f32 v178, v178, v10
    v_mul_f32 v179, v179, v10
    s_waitcnt vmcnt(3)
    v_mfma_f32_16x16x32_bf16 v[92:95], v[212:215], v[56:59], v[92:95]
    ds_read_b64 v[142:143], v1 offset:15360
    ds_read_b64 v[148:149], v1 offset:11776
    v_cvt_pk_bf16_f32 v30, v176, v177
    v_cvt_pk_bf16_f32 v31, v178, v179
    s_waitcnt lgkmcnt(7)
    v_mfma_f32_16x16x32_bf16 v[116:119], v[216:219], v[52:55], v[116:119]
    ds_read_b64 v[150:151], v2 offset:8192
    ds_read_b64 v[152:153], v3 offset:8192
    buffer_load_dwordx4 v[72:75], v0, s[20:23], s44 offen offset:3072
    v_mul_f32 v180, v180, v185
    v_mul_f32 v181, v181, v185
    v_mfma_f32_16x16x32_bf16 v[96:99], v[216:219], v[56:59], v[96:99]
    ds_read_b128 v[232:235], v7 offset:8192
    ds_read_b128 v[236:239], v7 offset:12288
    v_mul_f32 v182, v182, v185
    v_mul_f32 v183, v183, v185
    s_waitcnt lgkmcnt(10)
    v_mfma_f32_16x16x32_bf16 v[120:123], v[220:223], v[52:55], v[120:123]
    ds_read_b64 v[154:155], v4 offset:8192
    ds_read_b64 v[156:157], v5 offset:8192
    v_cvt_pk_bf16_f32 v12, v180, v181
    v_cvt_pk_bf16_f32 v13, v182, v183
    v_mfma_f32_16x16x32_bf16 v[100:103], v[220:223], v[56:59], v[100:103]
    ds_read_b128 v[240:243], v7 offset:9216
    ds_read_b128 v[244:247], v7 offset:13312
    s_nop 1
    v_add_f32 v208, 0x358637bd, v208
    s_waitcnt lgkmcnt(13)
    v_mfma_f32_16x16x32_bf16 v[124:127], v[224:227], v[52:55], v[124:127]
    ds_read_b128 v[248:251], v7 offset:10240
    s_add_u32 m0, s51, 40960
    s_add_u32 s83, s45, 8192
    buffer_load_dwordx4 v0, s[24:27], s83 offen lds
    v_add_f32 v209, 0x358637bd, v209
    v_add_f32 v210, 0x358637bd, v210
    v_mfma_f32_16x16x32_bf16 v[104:107], v[224:227], v[56:59], v[104:107]
    v_add_f32 v211, 0x358637bd, v211
    v_rcp_f32 v208, v208
    s_waitcnt lgkmcnt(13)
    v_mfma_f32_16x16x32_bf16 v[128:131], v[228:231], v[52:55], v[128:131]
    ds_read_b128 v[252:255], v7 offset:14336
    v_rcp_f32 v209, v209
    v_mfma_f32_16x16x32_bf16 v[108:111], v[228:231], v[56:59], v[108:111]
    v_rcp_f32 v210, v210
    s_barrier
    s_waitcnt lgkmcnt(13)
    v_mfma_f32_16x16x32_bf16 v[184:187], v[160:163], v[20:23], 0
    s_add_u32 m0, s51, 45056
    s_add_u32 s83, s94, 16384
    buffer_load_dwordx4 v0, s[24:27], s83 offen lds
    v_rcp_f32 v211, v211
    s_waitcnt lgkmcnt(12)
    v_mfma_f32_16x16x32_bf16 v[168:171], v[134:137], v[20:23], 0
    v_cndmask_b32 v9, v209, v208, s[84:85]
    s_waitcnt lgkmcnt(11)
    v_mfma_f32_16x16x32_bf16 v[176:179], v[140:143], v[20:23], 0
    v_cndmask_b32 v10, v211, v210, s[84:85]
    v_cndmask_b32 v209, v211, v209, s[86:87]
    s_waitcnt lgkmcnt(10)
    v_mfma_f32_16x16x32_bf16 v[180:183], v[146:149], v[20:23], 0
    v_mul_f32 v188, v188, v208
    v_mul_f32 v189, v189, v208
    s_waitcnt vmcnt(5)
    s_waitcnt lgkmcnt(8)
    v_mfma_f32_16x16x32_bf16 v[184:187], v[150:153], v[60:63], v[184:187]
    s_add_u32 m0, s51, 49152
    s_add_u32 s83, s45, 12288
    buffer_load_dwordx4 v0, s[24:27], s83 offen lds
    v_mul_f32 v190, v190, v208
    v_mul_f32 v191, v191, v208
    s_waitcnt lgkmcnt(7)
    v_mfma_f32_16x16x32_bf16 v[164:167], v[232:235], v[60:63], 0
    v_cvt_pk_bf16_f32 v36, v188, v189
    v_cvt_pk_bf16_f32 v37, v190, v191
    s_waitcnt vmcnt(5)
    s_waitcnt lgkmcnt(6)
    v_mfma_f32_16x16x32_bf16 v[172:175], v[236:239], v[64:67], 0
    v_mul_f32 v192, v192, v9
    v_mul_f32 v193, v193, v9
    s_waitcnt lgkmcnt(4)
    v_mfma_f32_16x16x32_bf16 v[184:187], v[154:157], v[64:67], v[184:187]
    buffer_load_dwordx4 v[76:79], v0, s[20:23], s67 offen offset:2048
    v_mul_f32 v194, v194, v9
    v_mul_f32 v195, v195, v9
    s_waitcnt lgkmcnt(3)
    v_mfma_f32_16x16x32_bf16 v[168:171], v[240:243], v[60:63], v[168:171]
    v_cvt_pk_bf16_f32 v38, v192, v193
    v_cvt_pk_bf16_f32 v39, v194, v195
    s_waitcnt lgkmcnt(2)
    v_mfma_f32_16x16x32_bf16 v[176:179], v[244:247], v[64:67], v[176:179]
    v_mul_f32 v196, v196, v210
    v_mul_f32 v197, v197, v210
    s_waitcnt lgkmcnt(1)
    v_mfma_f32_16x16x32_bf16 v[180:183], v[248:251], v[60:63], v[180:183]
    v_mul_f32 v198, v198, v210
    v_mul_f32 v199, v199, v210
    s_waitcnt lgkmcnt(0)
    v_mfma_f32_16x16x32_bf16 v[180:183], v[252:255], v[64:67], v[180:183]
    buffer_load_dwordx4 v[80:83], v0, s[20:23], s66 offen offset:2048
    v_cvt_pk_bf16_f32 v40, v196, v197
    v_cvt_pk_bf16_f32 v41, v198, v199
    s_lshl_b32 s60, s50, 11
    s_add_u32 s60, s60, 81920
    s_sub_u32 s60, s60, s51
    v_add_u32 v4, s60, v0
    v_add_u32 v5, s51, v0
    v_lshrrev_b32 v1, 1, v0
    v_and_b32 v3, 0xf0, v0
    v_lshl_add_u32 v2, v3, 2, s51
    v_lshrrev_b32 v3, 8, v0
    v_lshl_add_u32 v2, v3, 4, v2
    v_lshlrev_b32 v3, 4, v3
    s_and_b32 s60, s43, 8
    v_add_u32 v6, s60, v2
    v_mul_f32 v200, v200, v10
    v_mul_f32 v201, v201, v10
    v_mul_f32 v202, v202, v10
    v_mul_f32 v203, v203, v10
    v_cvt_pk_bf16_f32 v42, v200, v201
    v_cvt_pk_bf16_f32 v43, v202, v203
    v_mul_f32 v204, v204, v209
    v_mul_f32 v205, v205, v209
    v_mul_f32 v206, v206, v209
    v_mul_f32 v207, v207, v209
    v_cvt_pk_bf16_f32 v16, v204, v205
    v_cvt_pk_bf16_f32 v17, v206, v207
    s_nop 1
    v_mfma_f32_16x16x32_bf16 v[208:211], v[160:163], v[32:35], 0
    ds_read_b128 v[212:215], v7 offset:26624
    ds_read_b128 v[216:219], v7 offset:27648
    v_add_f32 v184, 0x358637bd, v184
    v_add_f32 v185, 0x358637bd, v185
    v_mfma_f32_16x16x32_bf16 v[192:195], v[134:137], v[32:35], 0
    ds_read_b128 v[220:223], v7 offset:28672
    ds_read_b128 v[224:227], v7 offset:29696
    v_add_f32 v186, 0x358637bd, v186
    v_add_f32 v187, 0x358637bd, v187
    v_mfma_f32_16x16x32_bf16 v[200:203], v[140:143], v[32:35], 0
    ds_read_b128 v[228:231], v7 offset:30720
    v_rcp_f32 v184, v184
    v_mfma_f32_16x16x32_bf16 v[204:207], v[146:149], v[32:35], 0
    s_add_u32 m0, s51, 53248
    s_add_u32 s83, s45, 16384
    buffer_load_dwordx4 v0, s[24:27], s83 offen lds
    v_rcp_f32 v185, v185
    s_waitcnt vmcnt(7)
    v_mfma_f32_16x16x32_bf16 v[208:211], v[150:153], v[68:71], v[208:211]
    v_rcp_f32 v186, v186
    v_mfma_f32_16x16x32_bf16 v[188:191], v[232:235], v[68:71], 0
    v_rcp_f32 v187, v187
    s_waitcnt vmcnt(6)
    v_mfma_f32_16x16x32_bf16 v[196:199], v[236:239], v[72:75], 0
    s_add_u32 m0, s51, 57344
    s_add_u32 s83, s45, 20480
    buffer_load_dwordx4 v0, s[24:27], s83 offen lds
    v_cndmask_b32 v9, v185, v184, s[84:85]
    v_cndmask_b32 v10, v187, v186, s[84:85]
    v_mfma_f32_16x16x32_bf16 v[208:211], v[154:157], v[72:75], v[208:211]
    v_cndmask_b32 v185, v187, v185, s[86:87]
    v_mul_f32 v164, v164, v184
    v_mfma_f32_16x16x32_bf16 v[192:195], v[240:243], v[68:71], v[192:195]
    v_mul_f32 v165, v165, v184
    v_mul_f32 v166, v166, v184
    v_mfma_f32_16x16x32_bf16 v[200:203], v[244:247], v[72:75], v[200:203]
    v_mul_f32 v167, v167, v184
    v_cvt_pk_bf16_f32 v60, v164, v165
    v_mfma_f32_16x16x32_bf16 v[204:207], v[248:251], v[68:71], v[204:207]
    s_add_u32 m0, s51, 61440
    s_add_u32 s83, s45, 24576
    s_cmp_ge_u32 s50, 1
    s_cbranch_scc1 K2_COW
    buffer_load_dwordx4 v0, s[24:27], s83 offen lds
K2_COW:
    v_cvt_pk_bf16_f32 v61, v166, v167
    v_mul_f32 v168, v168, v9
    v_mfma_f32_16x16x32_bf16 v[204:207], v[252:255], v[72:75], v[204:207]
    v_mul_f32 v169, v169, v9
    v_mul_f32 v170, v170, v9
    s_waitcnt vmcnt(3)
    s_waitcnt lgkmcnt(4)
    v_mfma_f32_16x16x32_bf16 v[112:115], v[212:215], v[76:79], v[112:115]
    ds_read_b128 v[232:235], v7 offset:32768
    ds_read_b128 v[236:239], v7 offset:33792
    v_mul_f32 v171, v171, v9
    v_cvt_pk_bf16_f32 v62, v168, v169
    s_waitcnt vmcnt(2)
    v_mfma_f32_16x16x32_bf16 v[92:95], v[212:215], v[80:83], v[92:95]
    ds_read_b128 v[240:243], v7 offset:34816
    ds_read_b128 v[244:247], v7 offset:35840
    v_cvt_pk_bf16_f32 v63, v170, v171
    v_mul_f32 v172, v172, v186
    s_waitcnt lgkmcnt(7)
    v_mfma_f32_16x16x32_bf16 v[116:119], v[216:219], v[76:79], v[116:119]
    ds_read_b128 v[248:251], v7 offset:36864
    s_add_u32 m0, s51, 65536
    s_add_u32 s83, s94, 20480
    buffer_load_dwordx4 v0, s[24:27], s83 offen lds
    v_mul_f32 v173, v173, v186
    v_mul_f32 v174, v174, v186
    v_mfma_f32_16x16x32_bf16 v[96:99], v[216:219], v[80:83], v[96:99]
    v_mul_f32 v175, v175, v186
    v_cvt_pk_bf16_f32 v64, v172, v173
    s_waitcnt lgkmcnt(7)
    v_mfma_f32_16x16x32_bf16 v[120:123], v[220:223], v[76:79], v[120:123]
    v_cvt_pk_bf16_f32 v65, v174, v175
    v_mul_f32 v176, v176, v10
    v_mfma_f32_16x16x32_bf16 v[100:103], v[220:223], v[80:83], v[100:103]
    s_add_u32 m0, s51, 69632
    s_add_u32 s83, s94, 24576
    buffer_load_dwordx4 v0, s[24:27], s83 offen lds
    v_mul_f32 v177, v177, v10
    v_mul_f32 v178, v178, v10
    s_waitcnt lgkmcnt(6)
    v_mfma_f32_16x16x32_bf16 v[124:127], v[224:227], v[76:79], v[124:127]
    v_mul_f32 v179, v179, v10
    v_cvt_pk_bf16_f32 v66, v176, v177
    v_mfma_f32_16x16x32_bf16 v[104:107], v[224:227], v[80:83], v[104:107]
    v_cvt_pk_bf16_f32 v67, v178, v179
    v_mul_f32 v180, v180, v185
    s_waitcnt lgkmcnt(5)
    v_mfma_f32_16x16x32_bf16 v[128:131], v[228:231], v[76:79], v[128:131]
    v_mul_f32 v181, v181, v185
    v_mul_f32 v182, v182, v185
    v_mfma_f32_16x16x32_bf16 v[108:111], v[228:231], v[80:83], v[108:111]
    buffer_load_dwordx4 v[84:87], v0, s[20:23], s67 offen offset:3072
    v_mul_f32 v183, v183, v185
    v_cvt_pk_bf16_f32 v14, v180, v181
    s_barrier
    ds_read_b128 v[252:255], v7 offset:37888
    ds_read_b128 v[212:215], v7 offset:38912
    s_waitcnt lgkmcnt(6)
    v_mfma_f32_16x16x32_bf16 v[112:115], v[232:235], v[24:27], v[112:115]
    ds_read_b128 v[216:219], v7 offset:39936
    ds_read_b128 v[220:223], v7 offset:40960
    v_cvt_pk_bf16_f32 v15, v182, v183
    s_nop 1
    v_mfma_f32_16x16x32_bf16 v[92:95], v[232:235], v[36:39], v[92:95]
    ds_read_b128 v[224:227], v7 offset:41984
    v_add_f32 v208, 0x358637bd, v208
    v_add_f32 v209, 0x358637bd, v209
    s_waitcnt lgkmcnt(8)
    v_mfma_f32_16x16x32_bf16 v[116:119], v[236:239], v[24:27], v[116:119]
    v_add_f32 v210, 0x358637bd, v210
    v_add_f32 v211, 0x358637bd, v211
    v_mfma_f32_16x16x32_bf16 v[96:99], v[236:239], v[36:39], v[96:99]
    buffer_load_dwordx4 v[88:91], v0, s[20:23], s66 offen offset:3072
    v_rcp_f32 v208, v208
    s_waitcnt lgkmcnt(7)
    v_mfma_f32_16x16x32_bf16 v[120:123], v[240:243], v[24:27], v[120:123]
    v_rcp_f32 v209, v209
    v_mfma_f32_16x16x32_bf16 v[100:103], v[240:243], v[36:39], v[100:103]
    v_rcp_f32 v210, v210
    s_waitcnt lgkmcnt(6)
    v_mfma_f32_16x16x32_bf16 v[124:127], v[244:247], v[24:27], v[124:127]
    v_rcp_f32 v211, v211
    v_mfma_f32_16x16x32_bf16 v[104:107], v[244:247], v[36:39], v[104:107]
    s_add_u32 m0, s51, 73728
    s_add_u32 s83, s94, 28672
    buffer_load_dwordx4 v0, s[24:27], s83 offen lds
    v_cndmask_b32 v9, v209, v208, s[84:85]
    v_cndmask_b32 v10, v211, v210, s[84:85]
    s_waitcnt lgkmcnt(5)
    v_mfma_f32_16x16x32_bf16 v[128:131], v[248:251], v[24:27], v[128:131]
    v_cndmask_b32 v209, v211, v209, s[86:87]
    v_mul_f32 v188, v188, v208
    v_mfma_f32_16x16x32_bf16 v[108:111], v[248:251], v[36:39], v[108:111]
    v_mul_f32 v189, v189, v208
    v_mul_f32 v190, v190, v208
    s_waitcnt lgkmcnt(4)
    v_mfma_f32_16x16x32_bf16 v[112:115], v[252:255], v[28:31], v[112:115]
    ds_read_b128 v[228:231], v7 offset:31744
    ds_read_b128 v[232:235], v7 offset:45056
    s_add_u32 m0, s51, 77824
    s_add_u32 s83, s94, 32768
    buffer_load_dwordx4 v0, s[24:27], s83 offen lds
    v_mul_f32 v191, v191, v208
    v_cvt_pk_bf16_f32 v68, v188, v189
    v_mfma_f32_16x16x32_bf16 v[92:95], v[252:255], v[40:43], v[92:95]
    ds_read_b128 v[236:239], v7 offset:46080
    ds_read_b128 v[240:243], v7 offset:47104
    v_cvt_pk_bf16_f32 v69, v190, v191
    v_mul_f32 v192, v192, v9
    s_waitcnt lgkmcnt(7)
    v_mfma_f32_16x16x32_bf16 v[116:119], v[212:215], v[28:31], v[116:119]
    ds_read_b128 v[244:247], v7 offset:48128
    v_mul_f32 v193, v193, v9
    v_mul_f32 v194, v194, v9
    v_mfma_f32_16x16x32_bf16 v[96:99], v[212:215], v[40:43], v[96:99]
    v_mul_f32 v195, v195, v9
    v_cvt_pk_bf16_f32 v70, v192, v193
    s_waitcnt lgkmcnt(7)
    v_mfma_f32_16x16x32_bf16 v[120:123], v[216:219], v[28:31], v[120:123]
    s_add_u32 m0, s51, 0
    s_add_u32 s83, s94, 36864
    buffer_load_dwordx4 v0, s[24:27], s83 offen lds
    v_cvt_pk_bf16_f32 v71, v194, v195
    v_mul_f32 v196, v196, v210
    v_mfma_f32_16x16x32_bf16 v[100:103], v[216:219], v[40:43], v[100:103]
    v_mul_f32 v197, v197, v210
    v_mul_f32 v198, v198, v210
    s_waitcnt lgkmcnt(6)
    v_mfma_f32_16x16x32_bf16 v[124:127], v[220:223], v[28:31], v[124:127]
    v_mul_f32 v199, v199, v210
    v_cvt_pk_bf16_f32 v72, v196, v197
    v_mfma_f32_16x16x32_bf16 v[104:107], v[220:223], v[40:43], v[104:107]
    v_cvt_pk_bf16_f32 v73, v198, v199
    v_mul_f32 v200, v200, v10
    s_waitcnt lgkmcnt(5)
    v_mfma_f32_16x16x32_bf16 v[128:131], v[224:227], v[28:31], v[128:131]
    s_add_u32 s77, s67, 4096
    buffer_load_dwordx4 v[44:47], v0, s[20:23], s77 offen offset:0
    v_mul_f32 v201, v201, v10
    v_mul_f32 v202, v202, v10
    v_mfma_f32_16x16x32_bf16 v[108:111], v[224:227], v[40:43], v[108:111]
    v_mul_f32 v203, v203, v10
    v_cvt_pk_bf16_f32 v74, v200, v201
    s_waitcnt vmcnt(5)
    s_waitcnt lgkmcnt(4)
    v_mfma_f32_16x16x32_bf16 v[112:115], v[228:231], v[84:87], v[112:115]
    ds_read_b128 v[248:251], v7 offset:43008
    ds_read_b128 v[252:255], v7 offset:44032
    v_cvt_pk_bf16_f32 v75, v202, v203
    v_mul_f32 v204, v204, v209
    s_waitcnt vmcnt(4)
    v_mfma_f32_16x16x32_bf16 v[92:95], v[228:231], v[88:91], v[92:95]
    ds_read_b128 v[212:215], v7 offset:49152
    ds_read_b128 v[216:219], v7 offset:50176
    s_add_u32 s77, s66, 4096
    buffer_load_dwordx4 v[48:51], v0, s[20:23], s77 offen offset:0
    v_mul_f32 v205, v205, v209
    v_mul_f32 v206, v206, v209
    s_waitcnt lgkmcnt(7)
    v_mfma_f32_16x16x32_bf16 v[116:119], v[232:235], v[84:87], v[116:119]
    ds_read_b128 v[220:223], v7 offset:51200
    v_mul_f32 v207, v207, v209
    v_cvt_pk_bf16_f32 v18, v204, v205
    v_mfma_f32_16x16x32_bf16 v[96:99], v[232:235], v[88:91], v[96:99]
    v_cvt_pk_bf16_f32 v19, v206, v207
    s_waitcnt lgkmcnt(7)
    v_mfma_f32_16x16x32_bf16 v[120:123], v[236:239], v[84:87], v[120:123]
    v_mfma_f32_16x16x32_bf16 v[100:103], v[236:239], v[88:91], v[100:103]
    s_add_u32 s77, s67, 4096
    buffer_load_dwordx4 v[52:55], v0, s[20:23], s77 offen offset:1024
    s_waitcnt lgkmcnt(6)
    v_mfma_f32_16x16x32_bf16 v[124:127], v[240:243], v[84:87], v[124:127]
    v_mfma_f32_16x16x32_bf16 v[104:107], v[240:243], v[88:91], v[104:107]
    s_waitcnt lgkmcnt(5)
    v_mfma_f32_16x16x32_bf16 v[128:131], v[244:247], v[84:87], v[128:131]
    v_mfma_f32_16x16x32_bf16 v[108:111], v[244:247], v[88:91], v[108:111]
    s_add_u32 s77, s66, 4096
    buffer_load_dwordx4 v[56:59], v0, s[20:23], s77 offen offset:1024
    s_barrier
    ds_read_b128 v[224:227], v7 offset:52224
    ds_read_b128 v[228:231], v7 offset:53248
    s_waitcnt lgkmcnt(6)
    v_mfma_f32_16x16x32_bf16 v[112:115], v[248:251], v[60:63], v[112:115]
    ds_read_b128 v[232:235], v7 offset:54272
    ds_read_b128 v[236:239], v7 offset:55296
    v_mfma_f32_16x16x32_bf16 v[92:95], v[248:251], v[68:71], v[92:95]
    ds_read_b128 v[240:243], v7 offset:56320
    s_waitcnt lgkmcnt(8)
    v_mfma_f32_16x16x32_bf16 v[116:119], v[252:255], v[60:63], v[116:119]
    s_add_u32 m0, s51, 4096
    s_add_u32 s83, s94, 40960
    buffer_load_dwordx4 v0, s[24:27], s83 offen lds
    v_mfma_f32_16x16x32_bf16 v[96:99], v[252:255], v[68:71], v[96:99]
    s_waitcnt lgkmcnt(7)
    v_mfma_f32_16x16x32_bf16 v[120:123], v[212:215], v[60:63], v[120:123]
    v_mfma_f32_16x16x32_bf16 v[100:103], v[212:215], v[68:71], v[100:103]
    s_waitcnt lgkmcnt(6)
    v_mfma_f32_16x16x32_bf16 v[124:127], v[216:219], v[60:63], v[124:127]
    s_add_u32 m0, s51, 16384
    s_add_u32 s83, s94, 45056
    buffer_load_dwordx4 v0, s[24:27], s83 offen lds
    v_mfma_f32_16x16x32_bf16 v[104:107], v[216:219], v[68:71], v[104:107]
    s_waitcnt lgkmcnt(5)
    v_mfma_f32_16x16x32_bf16 v[128:131], v[220:223], v[60:63], v[128:131]
    v_mfma_f32_16x16x32_bf16 v[108:111], v[220:223], v[68:71], v[108:111]
    s_waitcnt lgkmcnt(4)
    v_mfma_f32_16x16x32_bf16 v[112:115], v[224:227], v[64:67], v[112:115]
    ds_read_b128 v[244:247], v7 offset:57344
    ds_read_b128 v[248:251], v7 offset:58368
    s_add_u32 m0, s51, 20480
    s_add_u32 s83, s94, 49152
    buffer_load_dwordx4 v0, s[24:27], s83 offen lds
    v_mfma_f32_16x16x32_bf16 v[92:95], v[224:227], v[72:75], v[92:95]
    ds_read_b128 v[252:255], v7 offset:59392
    ds_read_b128 v[212:215], v7 offset:60416
    s_waitcnt lgkmcnt(7)
    v_mfma_f32_16x16x32_bf16 v[116:119], v[228:231], v[64:67], v[116:119]
    ds_read_b128 v[216:219], v7 offset:61440
    v_mfma_f32_16x16x32_bf16 v[96:99], v[228:231], v[72:75], v[96:99]
    s_waitcnt lgkmcnt(7)
    v_mfma_f32_16x16x32_bf16 v[120:123], v[232:235], v[64:67], v[120:123]
    s_add_u32 m0, s51, 8192
    s_add_u32 s83, s94, 53248
    buffer_load_dwordx4 v0, s[24:27], s83 offen lds
    v_mfma_f32_16x16x32_bf16 v[100:103], v[232:235], v[72:75], v[100:103]
    s_waitcnt lgkmcnt(6)
    v_mfma_f32_16x16x32_bf16 v[124:127], v[236:239], v[64:67], v[124:127]
    v_mfma_f32_16x16x32_bf16 v[104:107], v[236:239], v[72:75], v[104:107]
    s_add_u32 s77, s67, 4096
    buffer_load_dwordx4 v[20:23], v0, s[20:23], s77 offen offset:2048
    s_waitcnt lgkmcnt(5)
    v_mfma_f32_16x16x32_bf16 v[128:131], v[240:243], v[64:67], v[128:131]
    v_mfma_f32_16x16x32_bf16 v[108:111], v[240:243], v[72:75], v[108:111]
    s_waitcnt lgkmcnt(4)
    v_mfma_f32_16x16x32_bf16 v[112:115], v[244:247], v[12:15], v[112:115]
    ds_read_b128 v[220:223], v8 offset:0
    ds_read_b128 v[224:227], v8 offset:1024
    v_mfma_f32_16x16x32_bf16 v[92:95], v[244:247], v[16:19], v[92:95]
    ds_read_b128 v[228:231], v8 offset:2048
    ds_read_b128 v[232:235], v8 offset:3072
    s_add_u32 s77, s66, 4096
    buffer_load_dwordx4 v[32:35], v0, s[20:23], s77 offen offset:2048
    s_waitcnt lgkmcnt(7)
    v_mfma_f32_16x16x32_bf16 v[116:119], v[248:251], v[12:15], v[116:119]
    ds_read_b128 v[236:239], v8 offset:4096
    v_mfma_f32_16x16x32_bf16 v[96:99], v[248:251], v[16:19], v[96:99]
    s_waitcnt lgkmcnt(7)
    v_mfma_f32_16x16x32_bf16 v[120:123], v[252:255], v[12:15], v[120:123]
    v_mfma_f32_16x16x32_bf16 v[100:103], v[252:255], v[16:19], v[100:103]
    s_add_u32 s77, s67, 4096
    buffer_load_dwordx4 v[144:147], v0, s[20:23], s77 offen offset:3072
    s_waitcnt lgkmcnt(6)
    v_mfma_f32_16x16x32_bf16 v[124:127], v[212:215], v[12:15], v[124:127]
    v_mfma_f32_16x16x32_bf16 v[104:107], v[212:215], v[16:19], v[104:107]
    s_waitcnt lgkmcnt(5)
    v_mfma_f32_16x16x32_bf16 v[128:131], v[216:219], v[12:15], v[128:131]
    s_add_u32 s77, s66, 4096
    buffer_load_dwordx4 v[148:151], v0, s[20:23], s77 offen offset:3072
    v_mfma_f32_16x16x32_bf16 v[108:111], v[216:219], v[16:19], v[108:111]
    s_waitcnt vmcnt(12)
    s_barrier
    ds_read_b128 v[240:243], v8 offset:5120
    ds_read_b128 v[244:247], v8 offset:6144
    s_waitcnt vmcnt(11)
    s_waitcnt lgkmcnt(6)
    v_mfma_f32_16x16x32_bf16 v[112:115], v[220:223], v[44:47], v[112:115]
    ds_read_b128 v[248:251], v8 offset:7168
    ds_read_b128 v[252:255], v8 offset:8192
    s_waitcnt vmcnt(10)
    v_mfma_f32_16x16x32_bf16 v[92:95], v[220:223], v[48:51], v[92:95]
    ds_read_b128 v[212:215], v8 offset:9216
    s_waitcnt lgkmcnt(8)
    v_mfma_f32_16x16x32_bf16 v[116:119], v[224:227], v[44:47], v[116:119]
    s_add_u32 s77, s67, 8192
    buffer_load_dwordx4 v[152:155], v0, s[20:23], s77 offen offset:0
    v_mfma_f32_16x16x32_bf16 v[96:99], v[224:227], v[48:51], v[96:99]
    s_waitcnt lgkmcnt(7)
    v_mfma_f32_16x16x32_bf16 v[120:123], v[228:231], v[44:47], v[120:123]
    v_mfma_f32_16x16x32_bf16 v[100:103], v[228:231], v[48:51], v[100:103]
    s_waitcnt lgkmcnt(6)
    v_mfma_f32_16x16x32_bf16 v[124:127], v[232:235], v[44:47], v[124:127]
    s_add_u32 s77, s66, 8192
    buffer_load_dwordx4 v[156:159], v0, s[20:23], s77 offen offset:0
    v_mfma_f32_16x16x32_bf16 v[104:107], v[232:235], v[48:51], v[104:107]
    s_waitcnt lgkmcnt(5)
    v_mfma_f32_16x16x32_bf16 v[128:131], v[236:239], v[44:47], v[128:131]
    v_mfma_f32_16x16x32_bf16 v[108:111], v[236:239], v[48:51], v[108:111]
    s_add_u32 m0, s51, 12288
    s_add_u32 s83, s94, 57344
    buffer_load_dwordx4 v0, s[24:27], s83 offen lds
    s_waitcnt vmcnt(12)
    s_waitcnt lgkmcnt(4)
    v_mfma_f32_16x16x32_bf16 v[112:115], v[240:243], v[52:55], v[112:115]
    ds_read_b128 v[216:219], v8 offset:10240
    ds_read_b128 v[220:223], v8 offset:11264
    s_waitcnt vmcnt(11)
    v_mfma_f32_16x16x32_bf16 v[92:95], v[240:243], v[56:59], v[92:95]
    ds_read_b128 v[224:227], v8 offset:12288
    ds_read_b128 v[228:231], v8 offset:13312
    s_waitcnt lgkmcnt(7)
    v_mfma_f32_16x16x32_bf16 v[116:119], v[244:247], v[52:55], v[116:119]
    ds_read_b128 v[232:235], v8 offset:14336
    v_mfma_f32_16x16x32_bf16 v[96:99], v[244:247], v[56:59], v[96:99]
    s_add_u32 m0, s51, 24576
    s_add_u32 s83, s94, 61440
    buffer_load_dwordx4 v0, s[24:27], s83 offen lds
    s_waitcnt lgkmcnt(7)
    v_mfma_f32_16x16x32_bf16 v[120:123], v[248:251], v[52:55], v[120:123]
    v_mfma_f32_16x16x32_bf16 v[100:103], v[248:251], v[56:59], v[100:103]
    s_waitcnt lgkmcnt(6)
    v_mfma_f32_16x16x32_bf16 v[124:127], v[252:255], v[52:55], v[124:127]
    v_mfma_f32_16x16x32_bf16 v[104:107], v[252:255], v[56:59], v[104:107]
    s_add_u32 m0, s51, 32768
    s_add_u32 s83, s94, 65536
    buffer_load_dwordx4 v0, s[24:27], s83 offen lds
    s_waitcnt lgkmcnt(5)
    v_mfma_f32_16x16x32_bf16 v[128:131], v[212:215], v[52:55], v[128:131]
    v_mfma_f32_16x16x32_bf16 v[108:111], v[212:215], v[56:59], v[108:111]
    s_waitcnt vmcnt(8)
    s_waitcnt lgkmcnt(4)
    v_mfma_f32_16x16x32_bf16 v[112:115], v[216:219], v[20:23], v[112:115]
    ds_read_b128 v[236:239], v8 offset:15360
    ds_read_b128 v[240:243], v7 offset:0
    s_waitcnt vmcnt(7)
    v_mfma_f32_16x16x32_bf16 v[92:95], v[216:219], v[32:35], v[92:95]
    ds_read_b128 v[244:247], v7 offset:1024
    ds_read_b128 v[248:251], v7 offset:2048
    s_add_u32 m0, s51, 36864
    s_add_u32 s83, s94, 69632
    buffer_load_dwordx4 v0, s[24:27], s83 offen lds
    s_waitcnt lgkmcnt(7)
    v_mfma_f32_16x16x32_bf16 v[116:119], v[220:223], v[20:23], v[116:119]
    ds_read_b128 v[252:255], v7 offset:3072
    v_mfma_f32_16x16x32_bf16 v[96:99], v[220:223], v[32:35], v[96:99]
    s_waitcnt lgkmcnt(7)
    v_mfma_f32_16x16x32_bf16 v[120:123], v[224:227], v[20:23], v[120:123]
    s_add_u32 s77, s67, 8192
    buffer_load_dwordx4 v[160:163], v0, s[20:23], s77 offen offset:1024
    v_mfma_f32_16x16x32_bf16 v[100:103], v[224:227], v[32:35], v[100:103]
    s_waitcnt lgkmcnt(6)
    v_mfma_f32_16x16x32_bf16 v[124:127], v[228:231], v[20:23], v[124:127]
    v_mfma_f32_16x16x32_bf16 v[104:107], v[228:231], v[32:35], v[104:107]
    s_waitcnt lgkmcnt(5)
    v_mfma_f32_16x16x32_bf16 v[128:131], v[232:235], v[20:23], v[128:131]
    s_add_u32 s77, s66, 8192
    buffer_load_dwordx4 v[76:79], v0, s[20:23], s77 offen offset:1024
    v_mfma_f32_16x16x32_bf16 v[108:111], v[232:235], v[32:35], v[108:111]
    s_barrier
    ds_read_b128 v[212:215], v7 offset:4096
    ds_read_b128 v[216:219], v7 offset:5120
    s_waitcnt vmcnt(9)
    s_waitcnt lgkmcnt(6)
    v_mfma_f32_16x16x32_bf16 v[112:115], v[236:239], v[144:147], v[112:115]
    ds_read_b128 v[220:223], v7 offset:6144
    ds_read_b128 v[224:227], v7 offset:7168
    s_waitcnt vmcnt(8)
    v_mfma_f32_16x16x32_bf16 v[92:95], v[236:239], v[148:151], v[92:95]
    ds_read_b128 v[228:231], v7 offset:16384
    s_waitcnt lgkmcnt(8)
    v_mfma_f32_16x16x32_bf16 v[116:119], v[240:243], v[144:147], v[116:119]
    s_add_u32 s77, s67, 8192
    buffer_load_dwordx4 v[80:83], v0, s[20:23], s77 offen offset:2048
    v_mfma_f32_16x16x32_bf16 v[96:99], v[240:243], v[148:151], v[96:99]
    s_waitcnt lgkmcnt(7)
    v_mfma_f32_16x16x32_bf16 v[120:123], v[244:247], v[144:147], v[120:123]
    v_mfma_f32_16x16x32_bf16 v[100:103], v[244:247], v[148:151], v[100:103]
    s_add_u32 s77, s67, 8192
    buffer_load_dwordx4 v[24:27], v0, s[20:23], s77 offen offset:3072
    s_waitcnt lgkmcnt(6)
    v_mfma_f32_16x16x32_bf16 v[124:127], v[248:251], v[144:147], v[124:127]
    v_mfma_f32_16x16x32_bf16 v[104:107], v[248:251], v[148:151], v[104:107]
    s_waitcnt lgkmcnt(5)
    v_mfma_f32_16x16x32_bf16 v[128:131], v[252:255], v[144:147], v[128:131]
    v_mfma_f32_16x16x32_bf16 v[108:111], v[252:255], v[148:151], v[108:111]
    s_add_u32 m0, s51, 28672
    s_add_u32 s83, s94, 73728
    s_cmp_ge_u32 s50, 3
    s_cbranch_scc1 K2_COX
    buffer_load_dwordx4 v0, s[24:27], s83 offen lds
K2_COX:
    s_waitcnt vmcnt(9)
    s_waitcnt lgkmcnt(4)
    v_mfma_f32_16x16x32_bf16 v[112:115], v[212:215], v[152:155], v[112:115]
    ds_read_b128 v[232:235], v7 offset:17408
    ds_read_b128 v[236:239], v7 offset:18432
    s_waitcnt vmcnt(8)
    v_mfma_f32_16x16x32_bf16 v[92:95], v[212:215], v[156:159], v[92:95]
    ds_read_b128 v[240:243], v7 offset:19456
    ds_read_b128 v[244:247], v7 offset:20480
    s_waitcnt lgkmcnt(7)
    v_mfma_f32_16x16x32_bf16 v[116:119], v[216:219], v[152:155], v[116:119]
    ds_read_b128 v[248:251], v7 offset:21504
    v_mfma_f32_16x16x32_bf16 v[96:99], v[216:219], v[156:159], v[96:99]
    s_add_u32 s77, s67, 12288
    buffer_load_dwordx4 v[36:39], v0, s[20:23], s77 offen offset:0
    s_waitcnt lgkmcnt(7)
    v_mfma_f32_16x16x32_bf16 v[120:123], v[220:223], v[152:155], v[120:123]
    v_mfma_f32_16x16x32_bf16 v[100:103], v[220:223], v[156:159], v[100:103]
    s_waitcnt lgkmcnt(6)
    v_mfma_f32_16x16x32_bf16 v[124:127], v[224:227], v[152:155], v[124:127]
    s_add_u32 s77, s67, 12288
    buffer_load_dwordx4 v[28:31], v0, s[20:23], s77 offen offset:1024
    v_mfma_f32_16x16x32_bf16 v[104:107], v[224:227], v[156:159], v[104:107]
    s_waitcnt lgkmcnt(5)
    v_mfma_f32_16x16x32_bf16 v[128:131], v[228:231], v[152:155], v[128:131]
    v_mfma_f32_16x16x32_bf16 v[108:111], v[228:231], v[156:159], v[108:111]
    s_waitcnt vmcnt(5)
    s_waitcnt lgkmcnt(4)
    v_mfma_f32_16x16x32_bf16 v[112:115], v[232:235], v[160:163], v[112:115]
    ds_read_b128 v[252:255], v7 offset:22528
    ds_read_b128 v[212:215], v7 offset:23552
    s_add_u32 s77, s67, 12288
    buffer_load_dwordx4 v[40:43], v0, s[20:23], s77 offen offset:2048
    s_waitcnt vmcnt(5)
    v_mfma_f32_16x16x32_bf16 v[92:95], v[232:235], v[76:79], v[92:95]
    ds_read_b128 v[216:219], v7 offset:8192
    ds_read_b128 v[220:223], v7 offset:9216
    s_waitcnt lgkmcnt(7)
    v_mfma_f32_16x16x32_bf16 v[116:119], v[236:239], v[160:163], v[116:119]
    ds_read_b128 v[224:227], v7 offset:10240
    v_mfma_f32_16x16x32_bf16 v[96:99], v[236:239], v[76:79], v[96:99]
    s_waitcnt lgkmcnt(7)
    v_mfma_f32_16x16x32_bf16 v[120:123], v[240:243], v[160:163], v[120:123]
    s_add_u32 s77, s66, 8192
    buffer_load_dwordx4 v[84:87], v0, s[20:23], s77 offen offset:2048
    v_mfma_f32_16x16x32_bf16 v[100:103], v[240:243], v[76:79], v[100:103]
    s_waitcnt lgkmcnt(6)
    v_mfma_f32_16x16x32_bf16 v[124:127], v[244:247], v[160:163], v[124:127]
    v_mfma_f32_16x16x32_bf16 v[104:107], v[244:247], v[76:79], v[104:107]
    s_waitcnt lgkmcnt(5)
    v_mfma_f32_16x16x32_bf16 v[128:131], v[248:251], v[160:163], v[128:131]
    s_add_u32 s77, s66, 8192
    buffer_load_dwordx4 v[88:91], v0, s[20:23], s77 offen offset:3072
    v_mfma_f32_16x16x32_bf16 v[108:111], v[248:251], v[76:79], v[108:111]
    s_barrier
    ds_read_b128 v[228:231], v7 offset:11264
    ds_read_b128 v[232:235], v7 offset:12288
    s_waitcnt vmcnt(6)
    s_waitcnt lgkmcnt(6)
    v_mfma_f32_16x16x32_bf16 v[112:115], v[252:255], v[80:83], v[112:115]
    ds_read_b128 v[236:239], v7 offset:13312
    ds_read_b128 v[240:243], v7 offset:14336
    s_waitcnt lgkmcnt(7)
    v_mfma_f32_16x16x32_bf16 v[116:119], v[212:215], v[80:83], v[116:119]
    ds_read_b128 v[244:247], v7 offset:15360
    s_add_u32 s77, s66, 12288
    buffer_load_dwordx4 v[164:167], v0, s[20:23], s77 offen offset:0
    s_waitcnt lgkmcnt(7)
    v_mfma_f32_16x16x32_bf16 v[120:123], v[216:219], v[80:83], v[120:123]
    s_waitcnt lgkmcnt(6)
    v_mfma_f32_16x16x32_bf16 v[124:127], v[220:223], v[80:83], v[124:127]
    s_waitcnt lgkmcnt(5)
    v_mfma_f32_16x16x32_bf16 v[128:131], v[224:227], v[80:83], v[128:131]
    s_waitcnt vmcnt(6)
    s_waitcnt lgkmcnt(4)
    v_mfma_f32_16x16x32_bf16 v[112:115], v[228:231], v[24:27], v[112:115]
    ds_read_b128 v[248:251], v7 offset:24576
    ds_read_b128 v[252:255], v7 offset:25600
    s_add_u32 s77, s66, 12288
    buffer_load_dwordx4 v[168:171], v0, s[20:23], s77 offen offset:1024
    s_waitcnt lgkmcnt(5)
    v_mfma_f32_16x16x32_bf16 v[116:119], v[232:235], v[24:27], v[116:119]
    ds_read_b128 v[212:215], v7 offset:26624
    ds_read_b128 v[216:219], v7 offset:27648
    s_waitcnt lgkmcnt(6)
    v_mfma_f32_16x16x32_bf16 v[120:123], v[236:239], v[24:27], v[120:123]
    ds_read_b128 v[220:223], v7 offset:32768
    s_waitcnt lgkmcnt(6)
    v_mfma_f32_16x16x32_bf16 v[124:127], v[240:243], v[24:27], v[124:127]
    s_waitcnt lgkmcnt(5)
    v_mfma_f32_16x16x32_bf16 v[128:131], v[244:247], v[24:27], v[128:131]
    s_add_u32 s77, s66, 12288
    buffer_load_dwordx4 v[172:175], v0, s[20:23], s77 offen offset:2048
    s_waitcnt vmcnt(7)
    s_waitcnt lgkmcnt(4)
    v_mfma_f32_16x16x32_bf16 v[112:115], v[248:251], v[36:39], v[112:115]
    ds_read_b128 v[224:227], v7 offset:33792
    ds_read_b128 v[228:231], v7 offset:34816
    s_waitcnt lgkmcnt(5)
    v_mfma_f32_16x16x32_bf16 v[116:119], v[252:255], v[36:39], v[116:119]
    ds_read_b128 v[232:235], v7 offset:35840
    ds_read_b128 v[236:239], v7 offset:36864
    s_waitcnt lgkmcnt(6)
    v_mfma_f32_16x16x32_bf16 v[120:123], v[212:215], v[36:39], v[120:123]
    ds_read_b128 v[240:243], v7 offset:37888
    s_waitcnt lgkmcnt(6)
    v_mfma_f32_16x16x32_bf16 v[124:127], v[216:219], v[36:39], v[124:127]
    s_waitcnt lgkmcnt(5)
    v_mfma_f32_16x16x32_bf16 v[128:131], v[220:223], v[36:39], v[128:131]
    s_barrier
    ds_read_b128 v[244:247], v7 offset:38912
    ds_read_b128 v[248:251], v7 offset:39936
    s_waitcnt vmcnt(6)
    s_waitcnt lgkmcnt(6)
    v_mfma_f32_16x16x32_bf16 v[112:115], v[224:227], v[28:31], v[112:115]
    ds_read_b128 v[252:255], v7 offset:28672
    ds_read_b128 v[212:215], v7 offset:29696
    s_waitcnt lgkmcnt(7)
    v_mfma_f32_16x16x32_bf16 v[116:119], v[228:231], v[28:31], v[116:119]
    ds_read_b128 v[216:219], v7 offset:30720
    s_waitcnt lgkmcnt(7)
    v_mfma_f32_16x16x32_bf16 v[120:123], v[232:235], v[28:31], v[120:123]
    s_waitcnt lgkmcnt(6)
    v_mfma_f32_16x16x32_bf16 v[124:127], v[236:239], v[28:31], v[124:127]
    s_waitcnt lgkmcnt(5)
    v_mfma_f32_16x16x32_bf16 v[128:131], v[240:243], v[28:31], v[128:131]
    s_waitcnt vmcnt(5)
    s_waitcnt lgkmcnt(4)
    v_mfma_f32_16x16x32_bf16 v[112:115], v[244:247], v[40:43], v[112:115]
    ds_read_b128 v[220:223], v7 offset:22528
    ds_read_b128 v[224:227], v7 offset:23552
    s_waitcnt lgkmcnt(5)
    v_mfma_f32_16x16x32_bf16 v[116:119], v[248:251], v[40:43], v[116:119]
    ds_read_b128 v[228:231], v7 offset:8192
    ds_read_b128 v[232:235], v7 offset:9216
    s_waitcnt lgkmcnt(6)
    v_mfma_f32_16x16x32_bf16 v[120:123], v[252:255], v[40:43], v[120:123]
    ds_read_b128 v[236:239], v7 offset:10240
    s_waitcnt lgkmcnt(6)
    v_mfma_f32_16x16x32_bf16 v[124:127], v[212:215], v[40:43], v[124:127]
    s_waitcnt lgkmcnt(5)
    v_mfma_f32_16x16x32_bf16 v[128:131], v[216:219], v[40:43], v[128:131]
    s_waitcnt vmcnt(4)
    s_waitcnt lgkmcnt(4)
    v_mfma_f32_16x16x32_bf16 v[92:95], v[220:223], v[84:87], v[92:95]
    ds_read_b128 v[240:243], v7 offset:11264
    ds_read_b128 v[244:247], v7 offset:12288
    s_waitcnt lgkmcnt(5)
    v_mfma_f32_16x16x32_bf16 v[96:99], v[224:227], v[84:87], v[96:99]
    ds_read_b128 v[248:251], v7 offset:13312
    ds_read_b128 v[252:255], v7 offset:14336
    s_waitcnt lgkmcnt(6)
    v_mfma_f32_16x16x32_bf16 v[100:103], v[228:231], v[84:87], v[100:103]
    ds_read_b128 v[212:215], v7 offset:15360
    s_waitcnt lgkmcnt(6)
    v_mfma_f32_16x16x32_bf16 v[104:107], v[232:235], v[84:87], v[104:107]
    s_waitcnt lgkmcnt(5)
    v_mfma_f32_16x16x32_bf16 v[108:111], v[236:239], v[84:87], v[108:111]
    s_waitcnt vmcnt(3)
    s_waitcnt lgkmcnt(4)
    v_mfma_f32_16x16x32_bf16 v[92:95], v[240:243], v[88:91], v[92:95]
    ds_write_b128 v4, v[112:115] offset:45056
    ds_read_b128 v[216:219], v7 offset:24576
    ds_read_b128 v[220:223], v7 offset:25600
    s_waitcnt lgkmcnt(6)
    v_mfma_f32_16x16x32_bf16 v[96:99], v[244:247], v[88:91], v[96:99]
    ds_write_b128 v4, v[116:119] offset:40960
    ds_read_b128 v[224:227], v7 offset:26624
    ds_read_b128 v[228:231], v7 offset:27648
    buffer_load_dwordx4 v[132:135], v0, s[28:31], s46 offen offset:0 sc1
    s_waitcnt lgkmcnt(8)
    v_mfma_f32_16x16x32_bf16 v[100:103], v[248:251], v[88:91], v[100:103]
    ds_write_b128 v4, v[120:123] offset:49152
    ds_read_b128 v[232:235], v7 offset:32768
    s_waitcnt lgkmcnt(9)
    v_mfma_f32_16x16x32_bf16 v[104:107], v[252:255], v[88:91], v[104:107]
    ds_write_b128 v4, v[124:127] offset:53248
    s_waitcnt lgkmcnt(9)
    v_mfma_f32_16x16x32_bf16 v[108:111], v[212:215], v[88:91], v[108:111]
    ds_write_b128 v4, v[128:131] offset:57344
    s_waitcnt vmcnt(3)
    s_waitcnt lgkmcnt(8)
    v_mfma_f32_16x16x32_bf16 v[92:95], v[216:219], v[164:167], v[92:95]
    ds_read_b128 v[236:239], v7 offset:33792
    ds_read_b128 v[240:243], v7 offset:34816
    buffer_load_dwordx4 v[136:139], v0, s[28:31], s46 offen offset:1024 sc1
    s_waitcnt lgkmcnt(9)
    v_mfma_f32_16x16x32_bf16 v[96:99], v[220:223], v[164:167], v[96:99]
    ds_read_b128 v[244:247], v7 offset:35840
    ds_read_b128 v[248:251], v7 offset:36864
    s_waitcnt lgkmcnt(9)
    v_mfma_f32_16x16x32_bf16 v[100:103], v[224:227], v[164:167], v[100:103]
    ds_read_b128 v[252:255], v7 offset:37888
    s_waitcnt lgkmcnt(9)
    v_mfma_f32_16x16x32_bf16 v[104:107], v[228:231], v[164:167], v[104:107]
    buffer_load_dwordx2 v[140:141], v1, s[28:31], s46 offen offset:2048 sc1
    s_waitcnt lgkmcnt(7)
    v_mfma_f32_16x16x32_bf16 v[108:111], v[232:235], v[164:167], v[108:111]
    s_waitcnt lgkmcnt(5)
    s_barrier
    ds_read_b128 v[112:115], v5 offset:45056
    ds_read_b128 v[116:119], v5 offset:40960
    ds_read_b128 v[120:123], v5 offset:49152
    ds_read_b128 v[124:127], v5 offset:53248
    ds_read_b128 v[128:131], v5 offset:57344
    s_waitcnt vmcnt(4)
    s_waitcnt lgkmcnt(9)
    v_mfma_f32_16x16x32_bf16 v[92:95], v[236:239], v[168:171], v[92:95]
    ds_read_b128 v[212:215], v7 offset:38912
    ds_read_b128 v[216:219], v7 offset:39936
    s_waitcnt lgkmcnt(10)
    v_mfma_f32_16x16x32_bf16 v[96:99], v[240:243], v[168:171], v[96:99]
    ds_read_b128 v[220:223], v7 offset:28672
    ds_read_b128 v[224:227], v7 offset:29696
    s_waitcnt lgkmcnt(11)
    v_mfma_f32_16x16x32_bf16 v[100:103], v[244:247], v[168:171], v[100:103]
    ds_read_b128 v[228:231], v7 offset:30720
    s_waitcnt lgkmcnt(11)
    v_mfma_f32_16x16x32_bf16 v[104:107], v[248:251], v[168:171], v[104:107]
    s_waitcnt lgkmcnt(10)
    v_mfma_f32_16x16x32_bf16 v[108:111], v[252:255], v[168:171], v[108:111]
    s_waitcnt vmcnt(3)
    s_waitcnt lgkmcnt(4)
    v_mfma_f32_16x16x32_bf16 v[92:95], v[212:215], v[172:175], v[92:95]
    s_waitcnt lgkmcnt(3)
    v_mfma_f32_16x16x32_bf16 v[96:99], v[216:219], v[172:175], v[96:99]
    s_waitcnt lgkmcnt(2)
    v_mfma_f32_16x16x32_bf16 v[100:103], v[220:223], v[172:175], v[100:103]
    s_waitcnt lgkmcnt(1)
    v_mfma_f32_16x16x32_bf16 v[104:107], v[224:227], v[172:175], v[104:107]
    s_waitcnt lgkmcnt(0)
    v_mfma_f32_16x16x32_bf16 v[108:111], v[228:231], v[172:175], v[108:111]
    v_add_f32 v92, v92, v112
    v_add_f32 v93, v93, v113
    v_add_f32 v94, v94, v114
    v_add_f32 v95, v95, v115
    v_add_f32 v96, v96, v116
    v_add_f32 v97, v97, v117
    v_add_f32 v98, v98, v118
    v_add_f32 v99, v99, v119
    v_add_f32 v100, v100, v120
    v_add_f32 v101, v101, v121
    v_add_f32 v102, v102, v122
    v_add_f32 v103, v103, v123
    v_add_f32 v104, v104, v124
    v_add_f32 v105, v105, v125
    v_add_f32 v106, v106, v126
    v_add_f32 v107, v107, v127
    v_add_f32 v108, v108, v128
    v_add_f32 v109, v109, v129
    v_add_f32 v110, v110, v130
    v_add_f32 v111, v111, v131
    s_waitcnt vmcnt(0)
    s_movk_i32 s61, 6
K2_HCHK:
    v_max3_u32 v9, v132, v133, v134
    v_max3_u32 v10, v135, v136, v137
    v_max3_u32 v9, v9, v138, v139
    v_max3_u32 v10, v10, v140, v141
    v_max_u32 v9, v9, v10
    v_cmp_eq_u32 vcc, -1, v9
    s_cbranch_vccnz K2_HSLOW
K2_HFIN:
    v_lshlrev_b32 v9, 16, v132
    v_and_b32 v10, 0xffff0000, v132
    v_add_f32 v92, v92, v9
    v_add_f32 v93, v93, v10
    v_cvt_pk_bf16_f32 v112, v92, v93
    v_lshlrev_b32 v9, 16, v133
    v_and_b32 v10, 0xffff0000, v133
    v_add_f32 v94, v94, v9
    v_add_f32 v95, v95, v10
    v_cvt_pk_bf16_f32 v113, v94, v95
    v_lshlrev_b32 v9, 16, v134
    v_and_b32 v10, 0xffff0000, v134
    v_add_f32 v96, v96, v9
    v_add_f32 v97, v97, v10
    v_cvt_pk_bf16_f32 v114, v96, v97
    v_lshlrev_b32 v9, 16, v135
    v_and_b32 v10, 0xffff0000, v135
    v_add_f32 v98, v98, v9
    v_add_f32 v99, v99, v10
    v_cvt_pk_bf16_f32 v115, v98, v99
    ds_write_b128 v2, v[112:115] offset:45056
    ds_read_b128 v[122:125], v5 offset:45056
    v_lshlrev_b32 v9, 16, v136
    v_and_b32 v10, 0xffff0000, v136
    v_add_f32 v100, v100, v9
    v_add_f32 v101, v101, v10
    v_cvt_pk_bf16_f32 v116, v100, v101
    v_lshlrev_b32 v9, 16, v137
    v_and_b32 v10, 0xffff0000, v137
    v_add_f32 v102, v102, v9
    v_add_f32 v103, v103, v10
    v_cvt_pk_bf16_f32 v117, v102, v103
    v_lshlrev_b32 v9, 16, v138
    v_and_b32 v10, 0xffff0000, v138
    v_add_f32 v104, v104, v9
    v_add_f32 v105, v105, v10
    v_cvt_pk_bf16_f32 v118, v104, v105
    v_lshlrev_b32 v9, 16, v139
    v_and_b32 v10, 0xffff0000, v139
    v_add_f32 v106, v106, v9
    v_add_f32 v107, v107, v10
    v_cvt_pk_bf16_f32 v119, v106, v107
    ds_write_b128 v2, v[116:119] offset:40960
    ds_read_b128 v[126:129], v5 offset:40960
    v_lshlrev_b32 v9, 16, v140
    v_and_b32 v10, 0xffff0000, v140
    v_add_f32 v108, v108, v9
    v_add_f32 v109, v109, v10
    v_cvt_pk_bf16_f32 v120, v108, v109
    v_lshlrev_b32 v9, 16, v141
    v_and_b32 v10, 0xffff0000, v141
    v_add_f32 v110, v110, v9
    v_add_f32 v111, v111, v10
    v_cvt_pk_bf16_f32 v121, v110, v111
    ds_write_b64 v2, v[120:121] offset:49152
    ds_read_b64 v[130:131], v5 offset:49152
    s_waitcnt lgkmcnt(4)
    buffer_store_dwordx4 v[122:125], v11, s[56:59], s42 offen
    s_waitcnt lgkmcnt(2)
    buffer_store_dwordx4 v[126:129], v11, s[56:59], s42 offen offset:64
    s_waitcnt lgkmcnt(0)
    buffer_store_dwordx2 v[130:131], v11, s[56:59], s43 offen
K2_CEND:
    s_endpgm
K2_HSLOW:
    s_sub_u32 s61, s61, 1
    s_cbranch_scc1 K2_HSL2
    buffer_load_dwordx4 v[132:135], v0, s[28:31], s46 offen sc1
    buffer_load_dwordx4 v[136:139], v0, s[28:31], s46 offen offset:1024 sc1
    buffer_load_dwordx2 v[140:141], v1, s[28:31], s46 offen offset:2048 sc1
    s_waitcnt vmcnt(0)
    s_branch K2_HCHK
K2_HSL2:
    buffer_store_dwordx4 v[92:95], v0, s[32:35], s52 offen offset:0 sc1
    buffer_store_dwordx4 v[96:99], v0, s[32:35], s52 offen offset:1024 sc1
    buffer_store_dwordx4 v[100:103], v0, s[32:35], s52 offen offset:2048 sc1
    buffer_store_dwordx4 v[104:107], v0, s[32:35], s52 offen offset:3072 sc1
    s_add_u32 s52, s52, 4096
    buffer_store_dwordx4 v[108:111], v0, s[32:35], s52 offen offset:0 sc1
    s_waitcnt vmcnt(0)
    v_mov_b32 v9, 1
    s_mov_b64 exec, 1
    buffer_atomic_add v9, off, s[28:31], s46 offset:2560 sc0 sc1
    s_mov_b64 exec, -1
    s_waitcnt vmcnt(0)
    v_readfirstlane_b32 s60, v9
    s_cmp_eq_u32 s60, -1
    s_cbranch_scc1 K2_CEND
    buffer_load_dwordx4 v[132:135], v0, s[28:31], s46 offen sc1
    buffer_load_dwordx4 v[136:139], v0, s[28:31], s46 offen offset:1024 sc1
    buffer_load_dwordx2 v[140:141], v1, s[28:31], s46 offen offset:2048 sc1
    s_waitcnt vmcnt(0)
    s_branch K2_HFIN
K2_END:
    s_endpgm
.section .rodata,"a"
.p2align 6

.amdhsa_kernel k1_kernel
  .amdhsa_next_free_vgpr 256
  .amdhsa_next_free_sgpr 102
  .amdhsa_accum_offset 256
  .amdhsa_group_segment_fixed_size 0
  .amdhsa_kernarg_size 88
  .amdhsa_user_sgpr_count 2
  .amdhsa_user_sgpr_kernarg_segment_ptr 1
  .amdhsa_system_sgpr_workgroup_id_x 1
.end_amdhsa_kernel

.p2align 6

.amdhsa_kernel k2_kernel
  .amdhsa_next_free_vgpr 256
  .amdhsa_next_free_sgpr 102
  .amdhsa_accum_offset 256
  .amdhsa_group_segment_fixed_size 0
  .amdhsa_kernarg_size 88
  .amdhsa_user_sgpr_count 2
  .amdhsa_user_sgpr_kernarg_segment_ptr 1
  .amdhsa_system_sgpr_workgroup_id_x 1
.end_amdhsa_kernel
```
